```python
import torch

def _softmax(x, axis=-1):
    return torch.softmax(x, dim=axis)
def _gelu(x):
    return torch.nn.functional.gelu(x, approximate="tanh")
def _silu(x):
    return torch.nn.functional.silu(x)
def _sigmoid(x):
    return torch.sigmoid(x)
def _layernorm(x, axis=-1, eps=1e-5):
    m = x.mean(dim=axis, keepdim=True)
    v = x.var(dim=axis, keepdim=True, unbiased=False)
    return (x - m) / torch.sqrt(v + eps)
def _scatter_add(tgt, idx, src, axis=0):
    return tgt.clone().index_add_(axis, idx, src)
def _segment_sum(src, seg, n):
    out = torch.zeros((n,) + src.shape[1:], dtype=src.dtype)
    return out.index_add_(0, seg, src)
def _pad(x, pw):
    flat = tuple(v for pair in reversed(pw) for v in pair)
    return torch.nn.functional.pad(x, flat)

kernel_name = 'parallel_sum__sliding_block__mixer_token_mlp__prompt'

def setup_inputs():

    _w = (lambda a: (lambda t: t.to(torch.bfloat16) if t.is_floating_point() else t)(torch.as_tensor(a)))
    def _A_setup():
        B, S, D = 1, 2048, 640
        return {
            "x": _w((lambda *s: torch.randn(*s, dtype=torch.bfloat16) * 0.05)(B, S, D)),
            "wqkv": _w((lambda *s: torch.randn(*s, dtype=torch.bfloat16) * 0.05)(D, 3 * D)),
            "wo": _w((lambda *s: torch.randn(*s, dtype=torch.bfloat16) * 0.05)(D, D)),
        }
    _A_in = _A_setup()

    def _B_setup():
        B, S, D, F = 1, 2048, 640, 1728
        return {
            "x": _w((lambda *s: torch.randn(*s, dtype=torch.bfloat16) * 0.05)(B, S, D)),
            "w1": _w((lambda *s: torch.randn(*s, dtype=torch.bfloat16) * 0.8)(S, F) * (S ** -0.5)),
            "b1": _w((lambda *s: torch.randn(*s, dtype=torch.bfloat16) * 0.8)(F) * 0.02),
            "w2": _w((lambda *s: torch.randn(*s, dtype=torch.bfloat16) * 0.8)(F, S) * (F ** -0.5)),
            "b2": _w((lambda *s: torch.randn(*s, dtype=torch.bfloat16) * 0.8)(S) * 0.02),
        }
    _B_in = _B_setup()

    return {
        "A_x": _A_in["x"],
        "A_wqkv": _A_in["wqkv"],
        "A_wo": _A_in["wo"],
        "B_x": _B_in["x"],
        "B_w1": _B_in["w1"],
        "B_b1": _B_in["b1"],
        "B_w2": _B_in["w2"],
        "B_b2": _B_in["b2"],
    }

def reference(A_x, A_wqkv, A_wo, B_x, B_w1, B_b1, B_w2, B_b2):
    def _A_ref(x, wqkv, wo):
        B, S, D = x.shape
        H = 32; Dh = D // H; W = 256
        qkv = (lambda x, *d: x.permute(*d))((x @ wqkv).reshape(B, S, 3, H, Dh), 2, 0, 3, 1, 4)
        q, k, v = qkv[0], qkv[1], qkv[2]
        scores = torch.einsum("bhqd,bhkd->bhqk", q, k) * (Dh ** -0.5)
        idx = torch.arange(S)
        mask = (idx[:, None] - idx[None, :] >= 0) & (idx[:, None] - idx[None, :] < W)
        scores = torch.where(mask[None, None], scores, -1e9)
        p = _softmax(scores, axis=-1)
        o = torch.einsum("bhqk,bhkd->bhqd", p, v)
        return (lambda x, *d: x.permute(*d))(o, 0, 2, 1, 3).reshape(B, S, D) @ wo

    def _B_ref(x, w1, b1, w2, b2):
        B, S, D = x.shape
        h = _layernorm(x, axis=-1)
        u = torch.einsum("bsd,sf->bdf", h, w1) + b1
        u = _gelu(u)
        y = torch.einsum("bdf,fs->bds", u, w2) + b2
        return (lambda x, *d: x.permute(*d))(y, 0, 2, 1)

    x = A_x
    xn = _layernorm(x, axis=-1)
    return x + _A_ref(xn, A_wqkv, A_wo) + _B_ref(xn, B_w1, B_b1, B_w2, B_b2)
```

```asm
; @launch grid=(256,1,1) block=(512,1,1) lds=163840
.amdgcn_target "amdgcn-amd-amdhsa--gfx950"
.text
.globl parallel_sum__sliding_block__mixer_token_mlp__prompt_kernel
.p2align 8
.type parallel_sum__sliding_block__mixer_token_mlp__prompt_kernel,@function
parallel_sum__sliding_block__mixer_token_mlp__prompt_kernel:
    s_cmp_ge_u32 s2, 256
    s_cbranch_scc1 L_end
    s_load_dwordx2 s[4:5], s[0:1], 0
    s_load_dwordx2 s[8:9], s[0:1], 8
    s_load_dwordx2 s[12:13], s[0:1], 80
    s_load_dwordx2 s[40:41], s[0:1], 72
    s_load_dwordx2 s[16:17], s[0:1], 32
    s_load_dwordx2 s[20:21], s[0:1], 48
    s_load_dwordx2 s[24:25], s[0:1], 16
    s_load_dwordx2 s[28:29], s[0:1], 64
    s_load_dwordx2 s[32:33], s[0:1], 40
    s_load_dwordx2 s[36:37], s[0:1], 56
    v_lshrrev_b32 v2, 6, v0
    v_and_b32 v1, 63, v0
    v_readfirstlane_b32 s44, v2
    v_mov_b32 v2, 0
    v_mov_b32 v3, 0
    v_and_b32 v4, 3, v0
    v_lshlrev_b32 v4, 3, v4
    v_add_u32 v4, 160448, v4
    ds_write_b64 v4, v[2:3]
    s_mov_b32 s6, 2621440
    s_mov_b32 s7, 0x20000
    s_mov_b32 s10, 2457600
    s_mov_b32 s11, 0x20000
    s_mov_b32 s14, 16957440
    s_mov_b32 s15, 0x20000
    s_mov_b32 s42, 256
    s_mov_b32 s43, 0x20000
    s_mov_b32 s18, 7077888
    s_mov_b32 s19, 0x20000
    s_mov_b32 s22, 7077888
    s_mov_b32 s23, 0x20000
    s_mov_b32 s26, 819200
    s_mov_b32 s27, 0x20000
    s_mov_b32 s30, 2621440
    s_mov_b32 s31, 0x20000
    s_mov_b32 s34, 3456
    s_mov_b32 s35, 0x20000
    s_mov_b32 s38, 4096
    s_mov_b32 s39, 0x20000
    s_and_b32 s45, s2, 7
    s_lshr_b32 s46, s2, 3
    s_mul_i32 s52, s45, 17
    s_add_u32 s52, s52, s46
    s_sub_u32 s52, s52, 15
    s_lshr_b32 s55, s45, 1
    s_mul_i32 s55, s55, 34
    s_sub_u32 s56, s52, s55
    s_sub_u32 s49, s56, 6
    s_mul_i32 s57, s56, 37
    s_lshr_b32 s57, s57, 8
    s_mul_i32 s58, s57, 7
    s_sub_u32 s58, s56, s58
    s_mul_i32 s58, s58, 5
    s_add_u32 s55, s55, s57
    s_add_u32 s52, s55, s58
    s_mul_i32 s47, s52, 205
    s_lshr_b32 s47, s47, 10
    s_mul_i32 s57, s47, 5
    s_sub_u32 s48, s52, s57
    s_and_b32 s56, s45, 1
    s_mul_i32 s56, s56, 15
    s_add_u32 s56, s56, s46
    s_lshr_b32 s58, s56, 1
    s_and_b32 s56, s56, 1
    s_and_b32 s57, s45, 6
    s_add_u32 s57, s57, s56
    s_cmp_lt_u32 s46, 15
    s_cselect_b32 s47, s57, s47
    s_cselect_b32 s48, s58, s48
    s_cselect_b32 s52, 0xff, s52
    s_and_b32 s62, s44, 3
    s_mov_b32 s96, 0x3f803f80
    s_cmp_lt_u32 s52, 200
    s_cbranch_scc1 L_B
    s_cmp_ge_u32 s44, 4
    s_cbranch_scc1 L_YQ
    s_memrealtime s[84:85]
    v_lshrrev_b32 v3, 3, v1
    v_lshrrev_b32 v4, 4, v1
    v_and_b32 v5, 7, v1
    v_xor_b32 v5, v5, v4
    v_mul_u32_u24 v3, 1280, v3
    v_lshl_add_u32 v152, v5, 4, v3
    v_xor_b32 v3, 64, v152
    v_add_u32 v153, 9216, v3
    v_add_u32 v154, 18432, v152
    v_add_u32 v155, 27648, v3
    v_bfe_u32 v5, v1, 2, 2
    v_xor_b32 v5, v5, v4
    v_mul_u32_u24 v3, 3840, v4
    v_lshl_add_u32 v3, v5, 6, v3
    v_and_b32 v5, 3, v1
    v_lshl_add_u32 v156, v5, 4, v3
    v_add_u32 v157, 14336, v156
    s_lshl_b32 s56, s47, 2
    s_add_u32 s56, s56, s44
    s_mul_i32 s64, s56, 81920
    s_mul_i32 s56, s44, 61440
    s_lshl_b32 s57, s48, 8
    s_add_u32 s65, s56, s57
    s_add_u32 s66, s64, 40960
    s_add_u32 s67, s65, 30720
    s_mul_i32 s68, s44, 12288
    s_waitcnt lgkmcnt(0)
    s_cmp_lt_u32 s2, 8
    s_cselect_b32 s56, s44, 1
    s_cmp_eq_u32 s56, 0
    s_cbranch_scc0 L_1
    s_or_b32 s84, s84, 1
    v_mov_b32 v6, 0
    v_mov_b32 v7, 0
    v_mov_b32 v3, 0
    v_mov_b32 v4, s84
    v_mov_b32 v5, s85
    s_mov_b64 exec, 1
    buffer_atomic_cmpswap_x2 v[4:7], v3, s[40:43], 0 offen sc1
    s_mov_b64 exec, -1
L_1:
    s_add_u32 m0, s68, 0
    s_nop 0
    buffer_load_dwordx4 v152, s[4:7], s64 offen offset:0 lds
    buffer_load_dwordx4 v153, s[4:7], s64 offen offset:1024 lds
    buffer_load_dwordx4 v154, s[4:7], s64 offen offset:2048 lds
    buffer_load_dwordx4 v155, s[4:7], s64 offen offset:3072 lds
    s_add_u32 m0, s68, 4096
    s_add_u32 s64, s64, 128
    buffer_load_dwordx4 v156, s[8:11], s65 offen offset:0 lds
    buffer_load_dwordx4 v157, s[8:11], s65 offen offset:1024 lds
    s_add_u32 s65, s65, 245760
    s_add_u32 m0, s68, 6144
    s_nop 0
    buffer_load_dwordx4 v152, s[4:7], s66 offen offset:0 lds
    buffer_load_dwordx4 v153, s[4:7], s66 offen offset:1024 lds
    buffer_load_dwordx4 v154, s[4:7], s66 offen offset:2048 lds
    buffer_load_dwordx4 v155, s[4:7], s66 offen offset:3072 lds
    s_add_u32 m0, s68, 10240
    s_add_u32 s66, s66, 128
    buffer_load_dwordx4 v156, s[8:11], s67 offen offset:0 lds
    buffer_load_dwordx4 v157, s[8:11], s67 offen offset:1024 lds
    s_add_u32 s67, s67, 245760
    s_add_u32 m0, s68, 49152
    s_nop 0
    buffer_load_dwordx4 v152, s[4:7], s64 offen offset:0 lds
    s_lshl_b32 s57, s48, 2
    buffer_load_dwordx4 v153, s[4:7], s64 offen offset:1024 lds
    s_add_u32 s57, s57, s44
    s_lshl_b32 s57, s57, 8
    buffer_load_dwordx4 v154, s[4:7], s64 offen offset:2048 lds
    s_add_u32 s57, s57, 655360
    buffer_load_dwordx4 v155, s[4:7], s64 offen offset:3072 lds
    s_add_u32 m0, s68, 53248
    s_add_u32 s64, s64, 128
    v_and_b32 v4, 15, v1
    v_lshrrev_b32 v5, 4, v1
    buffer_load_dwordx4 v156, s[8:11], s65 offen offset:0 lds
    v_lshlrev_b32 v5, 14, v5
    buffer_load_dwordx4 v157, s[8:11], s65 offen offset:1024 lds
    s_add_u32 s65, s65, 245760
    v_lshl_add_u32 v5, v4, 4, v5
    v_add_u32 v44, s57, v5
    s_add_u32 m0, s68, 55296
    s_nop 0
    buffer_load_dwordx4 v152, s[4:7], s66 offen offset:0 lds
    v_add_u32 v95, 0x10000, v44
    s_lshl_b32 s57, s44, 7
    buffer_load_dwordx4 v153, s[4:7], s66 offen offset:1024 lds
    s_add_u32 s57, s57, 159744
    buffer_load_dwordx4 v154, s[4:7], s66 offen offset:2048 lds
    v_lshl_add_u32 v45, v4, 3, s57
    s_lshl_b32 s57, s45, 2
    buffer_load_dwordx4 v155, s[4:7], s66 offen offset:3072 lds
    s_add_u32 m0, s68, 59392
    s_add_u32 s66, s66, 128
    s_add_u32 s57, s57, s44
    buffer_load_dwordx4 v156, s[8:11], s67 offen offset:0 lds
    s_lshl_b32 s57, s57, 7
    s_add_u32 s57, s57, 36864
    buffer_load_dwordx4 v157, s[8:11], s67 offen offset:1024 lds
    s_add_u32 s67, s67, 245760
    v_min_u32 v4, 21, v1
    v_lshl_add_u32 v90, v4, 2, s57
    s_waitcnt vmcnt(12)
    s_waitcnt lgkmcnt(0)
    s_barrier
    s_add_u32 m0, s68, 98304
    s_nop 0
    buffer_load_dwordx4 v152, s[4:7], s64 offen offset:0 lds
    buffer_load_dwordx4 v153, s[4:7], s64 offen offset:1024 lds
    buffer_load_dwordx4 v154, s[4:7], s64 offen offset:2048 lds
    buffer_load_dwordx4 v155, s[4:7], s64 offen offset:3072 lds
    s_add_u32 m0, s68, 102400
    s_add_u32 s64, s64, 128
    buffer_load_dwordx4 v156, s[8:11], s65 offen offset:0 lds
    buffer_load_dwordx4 v157, s[8:11], s65 offen offset:1024 lds
    s_add_u32 s65, s65, 245760
    s_add_u32 m0, s68, 104448
    s_nop 0
    buffer_load_dwordx4 v152, s[4:7], s66 offen offset:0 lds
    buffer_load_dwordx4 v153, s[4:7], s66 offen offset:1024 lds
    buffer_load_dwordx4 v154, s[4:7], s66 offen offset:2048 lds
    buffer_load_dwordx4 v155, s[4:7], s66 offen offset:3072 lds
    s_add_u32 m0, s68, 108544
    s_add_u32 s66, s66, 128
    buffer_load_dwordx4 v156, s[8:11], s67 offen offset:0 lds
    buffer_load_dwordx4 v157, s[8:11], s67 offen offset:1024 lds
    s_add_u32 s67, s67, 245760
    s_waitcnt vmcnt(12)
    s_waitcnt lgkmcnt(0)
    s_barrier
    v_mov_b32 v254, 0
    buffer_load_dwordx2 v[250:251], v254, s[40:43], 0 offen sc1
    s_add_u32 m0, s68, 0
    s_nop 0
    buffer_load_dwordx4 v152, s[4:7], s64 offen offset:0 lds
    buffer_load_dwordx4 v153, s[4:7], s64 offen offset:1024 lds
    buffer_load_dwordx4 v154, s[4:7], s64 offen offset:2048 lds
    buffer_load_dwordx4 v155, s[4:7], s64 offen offset:3072 lds
    s_add_u32 m0, s68, 4096
    s_add_u32 s64, s64, 128
    buffer_load_dwordx4 v156, s[8:11], s65 offen offset:0 lds
    buffer_load_dwordx4 v157, s[8:11], s65 offen offset:1024 lds
    s_add_u32 s65, s65, 245760
    s_add_u32 m0, s68, 6144
    s_nop 0
    buffer_load_dwordx4 v152, s[4:7], s66 offen offset:0 lds
    buffer_load_dwordx4 v153, s[4:7], s66 offen offset:1024 lds
    buffer_load_dwordx4 v154, s[4:7], s66 offen offset:2048 lds
    buffer_load_dwordx4 v155, s[4:7], s66 offen offset:3072 lds
    s_add_u32 m0, s68, 10240
    s_add_u32 s66, s66, 128
    buffer_load_dwordx4 v156, s[8:11], s67 offen offset:0 lds
    buffer_load_dwordx4 v157, s[8:11], s67 offen offset:1024 lds
    s_add_u32 s67, s67, 245760
    s_waitcnt vmcnt(13)
    s_waitcnt lgkmcnt(0)
    s_barrier
    s_add_u32 m0, s68, 49152
    s_nop 0
    buffer_load_dwordx4 v152, s[4:7], s64 offen offset:0 lds
    buffer_load_dwordx4 v153, s[4:7], s64 offen offset:1024 lds
    buffer_load_dwordx4 v154, s[4:7], s64 offen offset:2048 lds
    buffer_load_dwordx4 v155, s[4:7], s64 offen offset:3072 lds
    s_add_u32 m0, s68, 53248
    s_add_u32 s64, s64, 128
    buffer_load_dwordx4 v156, s[8:11], s65 offen offset:0 lds
    buffer_load_dwordx4 v157, s[8:11], s65 offen offset:1024 lds
    s_add_u32 s65, s65, 245760
    s_add_u32 m0, s68, 55296
    s_nop 0
    buffer_load_dwordx4 v152, s[4:7], s66 offen offset:0 lds
    buffer_load_dwordx4 v153, s[4:7], s66 offen offset:1024 lds
    buffer_load_dwordx4 v154, s[4:7], s66 offen offset:2048 lds
    buffer_load_dwordx4 v155, s[4:7], s66 offen offset:3072 lds
    s_add_u32 m0, s68, 59392
    s_add_u32 s66, s66, 128
    buffer_load_dwordx4 v156, s[8:11], s67 offen offset:0 lds
    buffer_load_dwordx4 v157, s[8:11], s67 offen offset:1024 lds
    s_add_u32 s67, s67, 245760
    s_waitcnt vmcnt(12)
    s_waitcnt lgkmcnt(0)
    s_barrier
    v_mov_b32 v254, 0
    s_mov_b32 s97, 400000
nl_2:
    v_readfirstlane_b32 s50, v250
    v_readfirstlane_b32 s51, v251
    s_cmp_lg_u32 s50, 0
    s_cbranch_scc1 ok_3
    s_sleep 2
    buffer_load_dwordx2 v[250:251], v254, s[40:43], 0 offen sc1
    s_waitcnt vmcnt(0)
    s_sub_u32 s97, s97, 1
    s_cbranch_scc0 nl_2
    v_mov_b32 v14, 48
    v_mov_b32 v15, 232
    buffer_store_dword v15, v14, s[40:43], 0 offen
ok_3:
    s_add_u32 m0, s68, 98304
    s_nop 0
    buffer_load_dwordx4 v152, s[4:7], s64 offen offset:0 lds
    buffer_load_dwordx4 v153, s[4:7], s64 offen offset:1024 lds
    buffer_load_dwordx4 v154, s[4:7], s64 offen offset:2048 lds
    buffer_load_dwordx4 v155, s[4:7], s64 offen offset:3072 lds
    s_add_u32 m0, s68, 102400
    s_add_u32 s64, s64, 128
    buffer_load_dwordx4 v156, s[8:11], s65 offen offset:0 lds
    buffer_load_dwordx4 v157, s[8:11], s65 offen offset:1024 lds
    s_add_u32 s65, s65, 245760
    s_add_u32 m0, s68, 104448
    s_nop 0
    buffer_load_dwordx4 v152, s[4:7], s66 offen offset:0 lds
    buffer_load_dwordx4 v153, s[4:7], s66 offen offset:1024 lds
    buffer_load_dwordx4 v154, s[4:7], s66 offen offset:2048 lds
    buffer_load_dwordx4 v155, s[4:7], s66 offen offset:3072 lds
    s_add_u32 m0, s68, 108544
    s_add_u32 s66, s66, 128
    buffer_load_dwordx4 v156, s[8:11], s67 offen offset:0 lds
    buffer_load_dwordx4 v157, s[8:11], s67 offen offset:1024 lds
    s_add_u32 s67, s67, 245760
    s_waitcnt vmcnt(12)
    s_waitcnt lgkmcnt(0)
    s_barrier
    s_add_u32 m0, s68, 0
    s_nop 0
    buffer_load_dwordx4 v152, s[4:7], s64 offen offset:0 lds
    buffer_load_dwordx4 v153, s[4:7], s64 offen offset:1024 lds
    buffer_load_dwordx4 v154, s[4:7], s64 offen offset:2048 lds
    buffer_load_dwordx4 v155, s[4:7], s64 offen offset:3072 lds
    s_add_u32 m0, s68, 4096
    s_add_u32 s64, s64, 128
    buffer_load_dwordx4 v156, s[8:11], s65 offen offset:0 lds
    buffer_load_dwordx4 v157, s[8:11], s65 offen offset:1024 lds
    s_add_u32 s65, s65, 245760
    s_add_u32 m0, s68, 6144
    s_nop 0
    buffer_load_dwordx4 v152, s[4:7], s66 offen offset:0 lds
    buffer_load_dwordx4 v153, s[4:7], s66 offen offset:1024 lds
    buffer_load_dwordx4 v154, s[4:7], s66 offen offset:2048 lds
    buffer_load_dwordx4 v155, s[4:7], s66 offen offset:3072 lds
    s_add_u32 m0, s68, 10240
    s_add_u32 s66, s66, 128
    buffer_load_dwordx4 v156, s[8:11], s67 offen offset:0 lds
    buffer_load_dwordx4 v157, s[8:11], s67 offen offset:1024 lds
    s_add_u32 s67, s67, 245760
    s_waitcnt vmcnt(12)
    s_waitcnt lgkmcnt(0)
    s_barrier
    s_add_u32 m0, s68, 49152
    s_nop 0
    buffer_load_dwordx4 v152, s[4:7], s64 offen offset:0 lds
    buffer_load_dwordx4 v153, s[4:7], s64 offen offset:1024 lds
    buffer_load_dwordx4 v154, s[4:7], s64 offen offset:2048 lds
    buffer_load_dwordx4 v155, s[4:7], s64 offen offset:3072 lds
    s_add_u32 m0, s68, 53248
    s_add_u32 s64, s64, 128
    buffer_load_dwordx4 v156, s[8:11], s65 offen offset:0 lds
    buffer_load_dwordx4 v157, s[8:11], s65 offen offset:1024 lds
    s_add_u32 s65, s65, 245760
    s_add_u32 m0, s68, 55296
    s_nop 0
    buffer_load_dwordx4 v152, s[4:7], s66 offen offset:0 lds
    buffer_load_dwordx4 v153, s[4:7], s66 offen offset:1024 lds
    buffer_load_dwordx4 v154, s[4:7], s66 offen offset:2048 lds
    buffer_load_dwordx4 v155, s[4:7], s66 offen offset:3072 lds
    s_add_u32 m0, s68, 59392
    s_add_u32 s66, s66, 128
    buffer_load_dwordx4 v156, s[8:11], s67 offen offset:0 lds
    buffer_load_dwordx4 v157, s[8:11], s67 offen offset:1024 lds
    s_add_u32 s67, s67, 245760
    s_waitcnt vmcnt(12)
    s_waitcnt lgkmcnt(0)
    s_barrier
    s_add_u32 m0, s68, 98304
    s_nop 0
    buffer_load_dwordx4 v152, s[4:7], s64 offen offset:0 lds
    buffer_load_dwordx4 v153, s[4:7], s64 offen offset:1024 lds
    buffer_load_dwordx4 v154, s[4:7], s64 offen offset:2048 lds
    buffer_load_dwordx4 v155, s[4:7], s64 offen offset:3072 lds
    s_add_u32 m0, s68, 102400
    s_add_u32 s64, s64, 128
    buffer_load_dwordx4 v156, s[8:11], s65 offen offset:0 lds
    buffer_load_dwordx4 v157, s[8:11], s65 offen offset:1024 lds
    s_add_u32 s65, s65, 245760
    s_add_u32 m0, s68, 104448
    s_nop 0
    buffer_load_dwordx4 v152, s[4:7], s66 offen offset:0 lds
    buffer_load_dwordx4 v153, s[4:7], s66 offen offset:1024 lds
    buffer_load_dwordx4 v154, s[4:7], s66 offen offset:2048 lds
    buffer_load_dwordx4 v155, s[4:7], s66 offen offset:3072 lds
    s_add_u32 m0, s68, 108544
    s_add_u32 s66, s66, 128
    buffer_load_dwordx4 v156, s[8:11], s67 offen offset:0 lds
    buffer_load_dwordx4 v157, s[8:11], s67 offen offset:1024 lds
    s_add_u32 s67, s67, 245760
    buffer_load_dword v92, v90, s[12:15], 0 offen sc1
    buffer_load_dwordx4 v[48:51], v44, s[12:15], 0 offen sc1
    buffer_load_dwordx4 v[52:55], v95, s[12:15], 0 offen sc1
    s_waitcnt vmcnt(15)
    s_waitcnt lgkmcnt(0)
    s_barrier
    s_add_u32 m0, s68, 0
    s_nop 0
    buffer_load_dwordx4 v152, s[4:7], s64 offen offset:0 lds
    buffer_load_dwordx4 v153, s[4:7], s64 offen offset:1024 lds
    buffer_load_dwordx4 v154, s[4:7], s64 offen offset:2048 lds
    buffer_load_dwordx4 v155, s[4:7], s64 offen offset:3072 lds
    s_add_u32 m0, s68, 4096
    s_add_u32 s64, s64, 128
    buffer_load_dwordx4 v156, s[8:11], s65 offen offset:0 lds
    buffer_load_dwordx4 v157, s[8:11], s65 offen offset:1024 lds
    s_add_u32 s65, s65, 245760
    s_add_u32 m0, s68, 6144
    s_nop 0
    buffer_load_dwordx4 v152, s[4:7], s66 offen offset:0 lds
    buffer_load_dwordx4 v153, s[4:7], s66 offen offset:1024 lds
    buffer_load_dwordx4 v154, s[4:7], s66 offen offset:2048 lds
    buffer_load_dwordx4 v155, s[4:7], s66 offen offset:3072 lds
    s_add_u32 m0, s68, 10240
    s_add_u32 s66, s66, 128
    buffer_load_dwordx4 v156, s[8:11], s67 offen offset:0 lds
    buffer_load_dwordx4 v157, s[8:11], s67 offen offset:1024 lds
    s_add_u32 s67, s67, 245760
    s_mul_i32 s55, s45, 15
    s_add_u32 s55, s55, s46
    s_lshl_b32 s55, s55, 2
    s_add_u32 s55, s55, s44
    s_mul_i32 s55, s55, 1792
    v_min_u32 v10, 13, v1
    v_lshlrev_b32 v10, 7, v10
    buffer_load_dword v13, v10, s[24:27], s55 offen
    s_lshl_b32 s56, s46, 2
    s_add_u32 s56, s56, s44
    s_cmp_lt_u32 s56, 56
    s_cselect_b32 s56, s56, 1000
    s_lshl_b32 s56, s56, 15
    s_lshr_b32 s55, s45, 1
    s_lshl_b32 s55, s55, 10
    s_add_u32 s55, s55, s56
    v_lshrrev_b32 v10, 3, v1
    v_lshlrev_b32 v10, 12, v10
    v_and_b32 v11, 7, v1
    v_lshl_add_u32 v10, v11, 7, v10
    s_and_b32 s56, s45, 1
    s_mul_i32 s56, s56, 3670016
    s_add_u32 s55, s55, s56
    buffer_load_dword v13, v10, s[20:23], s55 offen
    s_add_u32 s55, s55, 1835008
    buffer_load_dword v13, v10, s[20:23], s55 offen
    s_add_u32 s55, s55, 1835008
    s_waitcnt vmcnt(18)
    s_waitcnt lgkmcnt(0)
    s_barrier
    s_waitcnt vmcnt(15)
    v_cmp_ne_u32 vcc, s50, v92
    v_cmp_ne_u64 s[98:99], v[50:51], s[50:51]
    s_or_b64 vcc, vcc, s[98:99]
    v_cmp_ne_u64 s[98:99], v[54:55], s[50:51]
    s_or_b64 vcc, vcc, s[98:99]
    s_and_b64 vcc, vcc, exec
    s_cbranch_scc0 ok_4
    s_mov_b32 s97, 400000
sp_5:
    s_sleep 2
    buffer_load_dword v92, v90, s[12:15], 0 offen offset:0 sc1
    buffer_load_dwordx4 v[48:51], v44, s[12:15], 0 offen offset:0 sc1
    buffer_load_dwordx4 v[52:55], v95, s[12:15], 0 offen offset:0 sc1
    s_waitcnt vmcnt(0)
    v_cmp_ne_u32 vcc, s50, v92
    v_cmp_ne_u64 s[98:99], v[50:51], s[50:51]
    s_or_b64 vcc, vcc, s[98:99]
    v_cmp_ne_u64 s[98:99], v[54:55], s[50:51]
    s_or_b64 vcc, vcc, s[98:99]
    s_and_b64 vcc, vcc, exec
    s_cbranch_scc0 ok_4
    s_sub_u32 s97, s97, 1
    s_cbranch_scc0 sp_5
    v_mov_b32 v14, 16
    v_mov_b32 v15, 224
    buffer_store_dword v15, v14, s[40:43], 0 offen
ok_4:
    v_pk_add_f32 v[48:49], v[48:49], v[52:53]
    v_mov_b32 v50, v48
    v_mov_b32 v51, v49
    s_nop 0
    v_permlane16_swap_b32 v48, v50
    v_permlane16_swap_b32 v49, v51
    v_pk_add_f32 v[48:49], v[48:49], v[50:51]
    v_mov_b32 v50, v48
    v_mov_b32 v51, v49
    s_nop 0
    v_permlane32_swap_b32 v48, v50
    v_permlane32_swap_b32 v49, v51
    v_pk_add_f32 v[48:49], v[48:49], v[50:51]
    ds_write_b64 v45, v[48:49]
    s_waitcnt vmcnt(3)
    s_waitcnt lgkmcnt(0)
    s_barrier
    s_waitcnt lgkmcnt(0)
    s_barrier
    v_lshlrev_b32 v20, 4, v1
    v_add_u32 v21, 4096, v20
    s_mul_i32 s71, s44, 36864
    s_lshr_b32 s57, s45, 1
    s_lshl_b32 s57, s57, 3
    s_bfe_u32 s58, s46, 0x30001
    s_add_u32 s72, s57, s58
    s_lshr_b32 s57, s46, 4
    s_xor_b32 s58, s58, s57
    s_and_b32 s58, s58, 1
    s_and_b32 s57, s46, 1
    s_lshl_b32 s57, s57, 1
    s_add_u32 s58, s58, s57
    s_and_b32 s57, s45, 1
    s_lshl_b32 s57, s57, 2
    s_add_u32 s73, s57, s58
    s_lshl_b32 s74, s44, 17
    s_lshl_b32 s57, s72, 7
    s_add_u32 s74, s74, s57
    v_lshrrev_b32 v6, 4, v1
    v_lshrrev_b32 v4, 3, v1
    v_lshlrev_b32 v4, 12, v4
    v_bfe_u32 v5, v1, 1, 2
    v_xor_b32 v5, v5, v6
    v_lshl_add_u32 v4, v5, 5, v4
    v_and_b32 v5, 1, v1
    v_lshl_add_u32 v16, v5, 4, v4
    v_add_u32 v17, 31744, v16
    v_add_u32 v18, 63488, v16
    v_add_u32 v19, 95232, v16
    v_mov_b32 v10, 160448
    s_mov_b32 s97, 8000000
ls_6:
    ds_read_b32 v12, v10
    s_waitcnt lgkmcnt(0)
    v_readfirstlane_b32 s100, v12
    s_cmp_ge_u32 s100, 4
    s_cbranch_scc1 ok_7
    s_sub_u32 s97, s97, 1
    s_cbranch_scc0 ls_6
    v_mov_b32 v14, 32
    v_mov_b32 v15, 228
    buffer_store_dword v15, v14, s[40:43], 0 offen
ok_7:
    s_cmp_lt_u32 s46, 5
    s_cbranch_scc0 L_8
    s_mov_b32 s88, s46
L_9:
    s_mul_i32 s77, s44, 204800
    s_mul_i32 s57, s45, 160
    s_add_u32 s77, s77, s57
    s_mul_i32 s57, s88, 51200
    s_cmp_lt_u32 s88, 4
    s_cselect_b32 s57, s57, 0
    s_cselect_b64 s[86:87], -1, 0
    s_add_u32 s77, s77, s57
    s_mul_i32 s76, s44, 36864
    v_bfe_u32 v4, v1, 2, 4
    v_mul_u32_u24 v4, 160, v4
    v_and_b32 v5, 3, v1
    v_lshl_add_u32 v4, v5, 3, v4
    v_add_u32 v36, s76, v4
    v_add_u32 v4, 0, v1
    v_mul_u32_u24 v5, 6554, v4
    v_lshrrev_b32 v5, 16, v5
    v_mul_u32_u24 v6, 10, v5
    v_sub_u32 v6, v4, v6
    v_lshrrev_b32 v7, 4, v5
    v_bfe_u32 v12, v5, 2, 2
    v_and_b32 v9, 3, v5
    v_lshrrev_b32 v10, 1, v12
    v_mul_u32_u24 v10, 20, v10
    v_lshl_add_u32 v10, v7, 3, v10
    v_and_b32 v11, 1, v12
    v_lshl_add_u32 v10, v11, 2, v10
    v_lshl_add_u32 v11, v12, 1, v7
    v_mad_u32_u24 v11, v11, 20, 16
    v_cndmask_b32 v10, v11, v10, s[86:87]
    v_add_u32 v10, v10, v9
    v_mul_u32_u24 v10, 1280, v10
    v_lshl_add_u32 v10, v6, 4, v10
    v_subrev_u32 v26, 0, v10
    v_add_u32 v4, 64, v1
    v_mul_u32_u24 v5, 6554, v4
    v_lshrrev_b32 v5, 16, v5
    v_mul_u32_u24 v6, 10, v5
    v_sub_u32 v6, v4, v6
    v_lshrrev_b32 v7, 4, v5
    v_bfe_u32 v12, v5, 2, 2
    v_and_b32 v9, 3, v5
    v_lshrrev_b32 v10, 1, v12
    v_mul_u32_u24 v10, 20, v10
    v_lshl_add_u32 v10, v7, 3, v10
    v_and_b32 v11, 1, v12
    v_lshl_add_u32 v10, v11, 2, v10
    v_lshl_add_u32 v11, v12, 1, v7
    v_mad_u32_u24 v11, v11, 20, 16
    v_cndmask_b32 v10, v11, v10, s[86:87]
    v_add_u32 v10, v10, v9
    v_mul_u32_u24 v10, 1280, v10
    v_lshl_add_u32 v10, v6, 4, v10
    v_subrev_u32 v27, 1024, v10
    v_add_u32 v4, 128, v1
    v_mul_u32_u24 v5, 6554, v4
    v_lshrrev_b32 v5, 16, v5
    v_mul_u32_u24 v6, 10, v5
    v_sub_u32 v6, v4, v6
    v_lshrrev_b32 v7, 4, v5
    v_bfe_u32 v12, v5, 2, 2
    v_and_b32 v9, 3, v5
    v_lshrrev_b32 v10, 1, v12
    v_mul_u32_u24 v10, 20, v10
    v_lshl_add_u32 v10, v7, 3, v10
    v_and_b32 v11, 1, v12
    v_lshl_add_u32 v10, v11, 2, v10
    v_lshl_add_u32 v11, v12, 1, v7
    v_mad_u32_u24 v11, v11, 20, 16
    v_cndmask_b32 v10, v11, v10, s[86:87]
    v_add_u32 v10, v10, v9
    v_mul_u32_u24 v10, 1280, v10
    v_lshl_add_u32 v10, v6, 4, v10
    v_subrev_u32 v28, 2048, v10
    v_add_u32 v4, 192, v1
    v_mul_u32_u24 v5, 6554, v4
    v_lshrrev_b32 v5, 16, v5
    v_mul_u32_u24 v6, 10, v5
    v_sub_u32 v6, v4, v6
    v_lshrrev_b32 v7, 4, v5
    v_bfe_u32 v12, v5, 2, 2
    v_and_b32 v9, 3, v5
    v_lshrrev_b32 v10, 1, v12
    v_mul_u32_u24 v10, 20, v10
    v_lshl_add_u32 v10, v7, 3, v10
    v_and_b32 v11, 1, v12
    v_lshl_add_u32 v10, v11, 2, v10
    v_lshl_add_u32 v11, v12, 1, v7
    v_mad_u32_u24 v11, v11, 20, 16
    v_cndmask_b32 v10, v11, v10, s[86:87]
    v_add_u32 v10, v10, v9
    v_mul_u32_u24 v10, 1280, v10
    v_lshl_add_u32 v10, v6, 4, v10
    v_subrev_u32 v29, 3072, v10
    v_add_u32 v4, 256, v1
    v_mul_u32_u24 v5, 6554, v4
    v_lshrrev_b32 v5, 16, v5
    v_mul_u32_u24 v6, 10, v5
    v_sub_u32 v6, v4, v6
    v_lshrrev_b32 v7, 4, v5
    v_bfe_u32 v12, v5, 2, 2
    v_and_b32 v9, 3, v5
    v_lshrrev_b32 v10, 1, v12
    v_mul_u32_u24 v10, 20, v10
    v_lshl_add_u32 v10, v7, 3, v10
    v_and_b32 v11, 1, v12
    v_lshl_add_u32 v10, v11, 2, v10
    v_lshl_add_u32 v11, v12, 1, v7
    v_mad_u32_u24 v11, v11, 20, 16
    v_cndmask_b32 v10, v11, v10, s[86:87]
    v_add_u32 v10, v10, v9
    v_mul_u32_u24 v10, 1280, v10
    v_lshl_add_u32 v10, v6, 4, v10
    v_subrev_u32 v30, 0, v10
    s_mov_b32 m0, s76
    s_nop 0
    buffer_load_dwordx4 v26, s[24:27], s77 offen offset:0 lds
    buffer_load_dwordx4 v27, s[24:27], s77 offen offset:1024 lds
    buffer_load_dwordx4 v28, s[24:27], s77 offen offset:2048 lds
    buffer_load_dwordx4 v29, s[24:27], s77 offen offset:3072 lds
    s_add_u32 m0, s76, 4096
    s_nop 0
    buffer_load_dwordx4 v30, s[24:27], s77 offen offset:0 lds
    s_lshl_b32 s57, s45, 2
    s_add_u32 s57, s57, s44
    s_mul_i32 s57, s57, 5
    s_add_u32 s57, s57, s88
    s_mul_i32 s57, s57, 5120
    s_add_u32 s57, s57, 786432
    s_waitcnt vmcnt(0)
    ds_read_b64_tr_b16 v[96:97], v36 offset:0
    ds_read_b64_tr_b16 v[98:99], v36 offset:2560
    ds_read_b64_tr_b16 v[100:101], v36 offset:32
    ds_read_b64_tr_b16 v[102:103], v36 offset:2592
    ds_read_b64_tr_b16 v[104:105], v36 offset:64
    ds_read_b64_tr_b16 v[106:107], v36 offset:2624
    ds_read_b64_tr_b16 v[108:109], v36 offset:96
    ds_read_b64_tr_b16 v[110:111], v36 offset:2656
    ds_read_b64_tr_b16 v[112:113], v36 offset:128
    ds_read_b64_tr_b16 v[114:115], v36 offset:2688
    s_waitcnt lgkmcnt(0)
    buffer_store_dwordx4 v[96:99], v20, s[12:15], s57 offen offset:0 sc1
    buffer_store_dwordx4 v[100:103], v20, s[12:15], s57 offen offset:1024 sc1
    buffer_store_dwordx4 v[104:107], v20, s[12:15], s57 offen offset:2048 sc1
    buffer_store_dwordx4 v[108:111], v20, s[12:15], s57 offen offset:3072 sc1
    buffer_store_dwordx4 v[112:115], v21, s[12:15], s57 offen offset:0 sc1
    s_lshl_b32 s57, s45, 3
    s_add_u32 s57, s57, s44
    s_lshl_b32 s57, s57, 7
    s_add_u32 s57, s57, 393472
    v_lshlrev_b32 v13, 13, v1
    v_add_u32 v13, s57, v13
    s_waitcnt vmcnt(0)
    s_mov_b32 exec_hi, 0
    v_mov_b32 v10, 256
    buffer_atomic_add v10, v13, s[12:15], 0 offen sc1
    s_mov_b32 exec_hi, -1
L_8:
    v_mov_b32 v10, 160452
    s_mov_b32 s97, 8000000
ls_10:
    ds_read_b32 v12, v10
    s_waitcnt lgkmcnt(0)
    v_readfirstlane_b32 s100, v12
    s_cmp_ge_u32 s100, 4
    s_cbranch_scc1 ok_11
    s_sub_u32 s97, s97, 1
    s_cbranch_scc0 ls_10
    v_mov_b32 v14, 32
    v_mov_b32 v15, 228
    buffer_store_dword v15, v14, s[40:43], 0 offen
ok_11:
    s_branch L_C0
L_C0:
    s_mul_i32 s75, s44, 40960
    s_mul_i32 s57, s73, 5120
    s_add_u32 s75, s75, s57
    s_add_u32 s75, s75, 14745600
    s_mul_i32 s76, s72, 81920
    s_mul_i32 s57, s44, 5120
    s_add_u32 s76, s76, s57
    s_add_u32 s76, s76, 12124160
    s_lshl_b32 s77, s73, 2
    s_add_u32 s77, s77, s44
    s_mul_i32 s77, s77, 25600
    s_add_u32 s77, s77, 786432
    s_lshl_b32 s80, s72, 3
    s_add_u32 s80, s80, s73
    s_lshl_b32 s80, s80, 10
    s_add_u32 s80, s80, 393344
    s_lshl_b32 s81, s44, 7
    s_add_u32 s81, s81, s80
    s_add_u32 s81, s81, 0x80
    v_bfe_u32 v8, v1, 2, 2
    v_lshrrev_b32 v6, 4, v1
    v_and_b32 v9, 15, v1
    v_lshlrev_b32 v9, 3, v9
    s_lshr_b32 s57, 0x5a, s73
    s_and_b32 s57, s57, 1
    s_lshl_b32 s82, 27, s57
    v_lshl_add_u32 v4, v6, 2, v8
    v_and_b32 v5, 3, v1
    v_lshlrev_b32 v5, 3, v5
    v_add_u32 v5, s71, v5
    v_lshrrev_b32 v7, 5, v1
    v_lshl_add_u32 v7, v7, 3, v4
    v_lshl_add_u32 v5, v7, 7, v5
    v_bfe_u32 v4, v4, 1, 2
    s_add_u32 s57, s44, 0
    s_and_b32 s57, s57, 3
    v_xor_b32 v7, s57, v4
    v_lshl_add_u32 v22, v7, 5, v5
    s_mul_i32 s57, s57, 20480
    v_add_u32 v37, s57, v20
    v_sub_u32 v31, v37, v9
    s_add_u32 s57, s44, 1
    s_and_b32 s57, s57, 3
    v_xor_b32 v7, s57, v4
    v_lshl_add_u32 v23, v7, 5, v5
    s_mul_i32 s57, s57, 20480
    v_add_u32 v38, s57, v20
    v_sub_u32 v32, v38, v9
    s_add_u32 s57, s44, 2
    s_and_b32 s57, s57, 3
    v_xor_b32 v7, s57, v4
    v_lshl_add_u32 v24, v7, 5, v5
    s_mul_i32 s57, s57, 20480
    v_add_u32 v39, s57, v20
    v_sub_u32 v33, v39, v9
    s_add_u32 s57, s44, 3
    s_and_b32 s57, s57, 3
    v_xor_b32 v7, s57, v4
    v_lshl_add_u32 v25, v7, 5, v5
    s_mul_i32 s57, s57, 20480
    v_add_u32 v40, s57, v20
    v_sub_u32 v34, v40, v9
    s_lshl_b32 s57, s72, 2
    s_add_u32 s57, s57, s44
    s_lshl_b32 s57, s57, 4
    v_and_b32 v4, 15, v1
    v_add_u32 v5, s57, v4
    v_lshlrev_b32 v46, 1, v5
    s_mul_i32 s58, s44, 3072
    s_add_u32 s58, s58, 147456
    v_mul_u32_u24 v4, 160, v4
    v_lshl_add_u32 v4, v6, 3, v4
    v_add_u32 v29, s58, v4
    v_add_u32 v30, s58, v20
    s_mul_i32 s57, s57, 1280
    s_mul_i32 s58, s73, 160
    s_add_u32 s57, s57, s58
    v_add_u32 v4, 0, v1
    v_mul_u32_u24 v5, 6554, v4
    v_lshrrev_b32 v5, 16, v5
    v_mul_u32_u24 v5, 1120, v5
    v_lshl_add_u32 v5, v4, 4, v5
    v_add_u32 v26, s57, v5
    v_add_u32 v4, 64, v1
    v_mul_u32_u24 v5, 6554, v4
    v_lshrrev_b32 v5, 16, v5
    v_mul_u32_u24 v5, 1120, v5
    v_lshl_add_u32 v5, v4, 4, v5
    v_add_u32 v27, s57, v5
    v_add_u32 v4, 128, v1
    v_mul_u32_u24 v5, 6554, v4
    v_lshrrev_b32 v5, 16, v5
    v_mul_u32_u24 v5, 1120, v5
    v_lshl_add_u32 v5, v4, 4, v5
    v_add_u32 v28, s57, v5
    v_mov_b32 v4, 0x7f000000
    v_cmp_gt_u32 vcc, 32, v1
    s_nop 1
    v_cndmask_b32 v28, v4, v28, vcc
    v_add_u32 v42, s71, v20
    s_sub_u32 s57, s44, 1
    s_and_b32 s57, s57, 3
    s_mul_i32 s57, s57, 36864
    v_add_u32 v43, s57, v20
    s_sub_u32 s57, s44, 2
    s_and_b32 s57, s57, 3
    s_mul_i32 s57, s57, 36864
    v_add_u32 v44, s57, v20
    s_sub_u32 s57, s44, 3
    s_and_b32 s57, s57, 3
    s_mul_i32 s57, s57, 36864
    v_add_u32 v45, s57, v20
    s_add_u32 m0, s71, 16384
    s_nop 0
    buffer_load_dwordx4 v16, s[20:23], s74 offen offset:0 lds
    buffer_load_dwordx4 v17, s[20:23], s74 offen offset:1024 lds
    buffer_load_dwordx4 v18, s[20:23], s74 offen offset:2048 lds
    buffer_load_dwordx4 v19, s[20:23], s74 offen offset:3072 lds
    s_add_u32 s74, s74, 524288
    s_add_u32 m0, s71, 20480
    s_nop 0
    buffer_load_dwordx4 v16, s[20:23], s74 offen offset:0 lds
    buffer_load_dwordx4 v17, s[20:23], s74 offen offset:1024 lds
    buffer_load_dwordx4 v18, s[20:23], s74 offen offset:2048 lds
    buffer_load_dwordx4 v19, s[20:23], s74 offen offset:3072 lds
    s_add_u32 s74, s74, 524288
    s_add_u32 m0, s71, 24576
    s_nop 0
    buffer_load_dwordx4 v16, s[20:23], s74 offen offset:0 lds
    buffer_load_dwordx4 v17, s[20:23], s74 offen offset:1024 lds
    buffer_load_dwordx4 v18, s[20:23], s74 offen offset:2048 lds
    buffer_load_dwordx4 v19, s[20:23], s74 offen offset:3072 lds
    s_add_u32 s74, s74, 524288
    s_add_u32 m0, s71, 28672
    s_nop 0
    buffer_load_dwordx4 v16, s[20:23], s74 offen offset:0 lds
    buffer_load_dwordx4 v17, s[20:23], s74 offen offset:1024 lds
    buffer_load_dwordx4 v18, s[20:23], s74 offen offset:2048 lds
    buffer_load_dwordx4 v19, s[20:23], s74 offen offset:3072 lds
    s_add_u32 s74, s74, 524288
    s_add_u32 m0, s71, 32768
    s_nop 0
    buffer_load_dwordx4 v16, s[20:23], s74 offen offset:0 lds
    buffer_load_dwordx4 v17, s[20:23], s74 offen offset:1024 lds
    buffer_load_dwordx4 v18, s[20:23], s74 offen offset:2048 lds
    buffer_load_dwordx4 v19, s[20:23], s74 offen offset:3072 lds
    s_add_u32 s74, s74, 524288
    s_add_u32 m0, s71, 0
    s_nop 0
    buffer_load_dwordx4 v16, s[20:23], s74 offen offset:0 lds
    buffer_load_dwordx4 v17, s[20:23], s74 offen offset:1024 lds
    buffer_load_dwordx4 v18, s[20:23], s74 offen offset:2048 lds
    buffer_load_dwordx4 v19, s[20:23], s74 offen offset:3072 lds
    s_add_u32 s74, s74, 524288
    s_add_u32 m0, s71, 4096
    s_nop 0
    buffer_load_dwordx4 v16, s[20:23], s74 offen offset:0 lds
    buffer_load_dwordx4 v17, s[20:23], s74 offen offset:1024 lds
    buffer_load_dwordx4 v18, s[20:23], s74 offen offset:2048 lds
    buffer_load_dwordx4 v19, s[20:23], s74 offen offset:3072 lds
    s_add_u32 s74, s74, 524288
    s_add_u32 m0, s71, 8192
    s_nop 0
    buffer_load_dwordx4 v16, s[20:23], s74 offen offset:0 lds
    buffer_load_dwordx4 v17, s[20:23], s74 offen offset:1024 lds
    buffer_load_dwordx4 v18, s[20:23], s74 offen offset:2048 lds
    buffer_load_dwordx4 v19, s[20:23], s74 offen offset:3072 lds
    s_add_u32 s74, s74, 524288
    s_add_u32 m0, s71, 12288
    s_nop 0
    buffer_load_dwordx4 v16, s[20:23], s74 offen offset:0 lds
    buffer_load_dwordx4 v17, s[20:23], s74 offen offset:1024 lds
    buffer_load_dwordx4 v18, s[20:23], s74 offen offset:2048 lds
    buffer_load_dwordx4 v19, s[20:23], s74 offen offset:3072 lds
    s_add_u32 s74, s74, 524288
    s_cmp_lt_u32 s46, 15
    s_cbranch_scc0 L_12
    s_lshl_b32 s57, s46, 2
    s_add_u32 s57, s57, s44
    s_mul_i32 s57, s57, 118784
    s_lshr_b32 s58, s45, 1
    s_lshl_b32 s58, s58, 10
    s_add_u32 s57, s57, s58
    s_add_u32 s57, s57, 384
    v_min_u32 v4, 28, v1
    v_lshlrev_b32 v4, 12, v4
    buffer_load_dword v13, v4, s[20:23], s57 offen
L_12:
    buffer_load_dwordx4 v[84:87], v26, s[4:7], 0 offen
    buffer_load_dwordx4 v[88:91], v27, s[4:7], 0 offen
    buffer_load_dwordx4 v[92:95], v28, s[4:7], 0 offen
    buffer_load_ushort v47, v46, s[36:39], 0 offen
    s_waitcnt vmcnt(36)
    ds_read_b64_tr_b16 v[48:49], v22 offset:16384
    ds_read_b64_tr_b16 v[50:51], v22 offset:17408
    ds_read_b64_tr_b16 v[52:53], v23 offset:16384
    ds_read_b64_tr_b16 v[54:55], v23 offset:17408
    ds_read_b64_tr_b16 v[56:57], v24 offset:16384
    ds_read_b64_tr_b16 v[58:59], v24 offset:17408
    ds_read_b64_tr_b16 v[60:61], v25 offset:16384
    ds_read_b64_tr_b16 v[62:63], v25 offset:17408
    s_load_dword s101, s[12:13], s80 glc
    s_waitcnt lgkmcnt(0)
    s_cmp_ge_u32 s101, s82
    s_cbranch_scc1 ok_14
    s_mov_b32 s97, 400000
sp_13:
    s_sleep 1
    s_load_dword s101, s[12:13], s80 glc
    s_waitcnt lgkmcnt(0)
    s_cmp_ge_u32 s101, s82
    s_cbranch_scc1 ok_14
    s_sub_u32 s97, s97, 1
    s_cbranch_scc0 sp_13
    v_mov_b32 v14, 36
    v_mov_b32 v15, 229
    buffer_store_dword v15, v14, s[40:43], 0 offen
ok_14:
    buffer_load_dwordx4 v[96:99], v20, s[12:15], s75 offen offset:0 sc1
    buffer_load_dwordx4 v[100:103], v20, s[12:15], s75 offen offset:1024 sc1
    buffer_load_dwordx4 v[104:107], v20, s[12:15], s75 offen offset:2048 sc1
    buffer_load_dwordx4 v[108:111], v20, s[12:15], s75 offen offset:3072 sc1
    buffer_load_dwordx4 v[112:115], v21, s[12:15], s75 offen offset:0 sc1
    s_add_u32 s75, s75, 163840
    buffer_load_dwordx4 v[116:119], v20, s[12:15], s75 offen offset:0 sc1
    buffer_load_dwordx4 v[120:123], v20, s[12:15], s75 offen offset:1024 sc1
    buffer_load_dwordx4 v[124:127], v20, s[12:15], s75 offen offset:2048 sc1
    buffer_load_dwordx4 v[128:131], v20, s[12:15], s75 offen offset:3072 sc1
    buffer_load_dwordx4 v[132:135], v21, s[12:15], s75 offen offset:0 sc1
    s_add_u32 s75, s75, 163840
    buffer_load_dwordx4 v[136:139], v20, s[12:15], s75 offen offset:0 sc1
    buffer_load_dwordx4 v[140:143], v20, s[12:15], s75 offen offset:1024 sc1
    buffer_load_dwordx4 v[144:147], v20, s[12:15], s75 offen offset:2048 sc1
    buffer_load_dwordx4 v[148:151], v20, s[12:15], s75 offen offset:3072 sc1
    buffer_load_dwordx4 v[152:155], v21, s[12:15], s75 offen offset:0 sc1
    s_add_u32 s75, s75, 163840
    buffer_load_dwordx4 v[156:159], v20, s[12:15], s75 offen offset:0 sc1
    buffer_load_dwordx4 v[160:163], v20, s[12:15], s75 offen offset:1024 sc1
    buffer_load_dwordx4 v[164:167], v20, s[12:15], s75 offen offset:2048 sc1
    buffer_load_dwordx4 v[168:171], v20, s[12:15], s75 offen offset:3072 sc1
    buffer_load_dwordx4 v[172:175], v21, s[12:15], s75 offen offset:0 sc1
    s_add_u32 s75, s75, 163840
    s_waitcnt vmcnt(20)
    ds_write_b128 v30, v[84:87] offset:0
    ds_write_b128 v30, v[88:91] offset:1024
    ds_write_b128 v30, v[92:95] offset:2048
    ds_read_b64 v[2:3], v29 offset:0
    ds_read_b64 v[4:5], v29 offset:32
    ds_read_b64 v[6:7], v29 offset:64
    ds_read_b64 v[8:9], v29 offset:96
    ds_read_b64 v[10:11], v29 offset:128
    v_lshlrev_b32 v12, 16, v47
    s_waitcnt lgkmcnt(4)
    v_lshlrev_b32 v176, 16, v2
    v_and_b32 v177, 0xffff0000, v2
    v_lshlrev_b32 v178, 16, v3
    v_and_b32 v179, 0xffff0000, v3
    v_pk_add_f32 v[176:177], v[176:177], v[12:13] op_sel_hi:[1,0]
    v_pk_add_f32 v[178:179], v[178:179], v[12:13] op_sel_hi:[1,0]
    s_waitcnt lgkmcnt(3)
    v_lshlrev_b32 v192, 16, v4
    v_and_b32 v193, 0xffff0000, v4
    v_lshlrev_b32 v194, 16, v5
    v_and_b32 v195, 0xffff0000, v5
    v_pk_add_f32 v[192:193], v[192:193], v[12:13] op_sel_hi:[1,0]
    v_pk_add_f32 v[194:195], v[194:195], v[12:13] op_sel_hi:[1,0]
    s_waitcnt lgkmcnt(2)
    v_lshlrev_b32 v208, 16, v6
    v_and_b32 v209, 0xffff0000, v6
    v_lshlrev_b32 v210, 16, v7
    v_and_b32 v211, 0xffff0000, v7
    v_pk_add_f32 v[208:209], v[208:209], v[12:13] op_sel_hi:[1,0]
    v_pk_add_f32 v[210:211], v[210:211], v[12:13] op_sel_hi:[1,0]
    s_waitcnt lgkmcnt(1)
    v_lshlrev_b32 v224, 16, v8
    v_and_b32 v225, 0xffff0000, v8
    v_lshlrev_b32 v226, 16, v9
    v_and_b32 v227, 0xffff0000, v9
    v_pk_add_f32 v[224:225], v[224:225], v[12:13] op_sel_hi:[1,0]
    v_pk_add_f32 v[226:227], v[226:227], v[12:13] op_sel_hi:[1,0]
    s_waitcnt lgkmcnt(0)
    v_lshlrev_b32 v240, 16, v10
    v_and_b32 v241, 0xffff0000, v10
    v_lshlrev_b32 v242, 16, v11
    v_and_b32 v243, 0xffff0000, v11
    v_pk_add_f32 v[240:241], v[240:241], v[12:13] op_sel_hi:[1,0]
    v_pk_add_f32 v[242:243], v[242:243], v[12:13] op_sel_hi:[1,0]
    s_add_u32 m0, s71, 16384
    s_waitcnt vmcnt(19)
    v_mfma_f32_16x16x32_bf16 v[176:179], v[96:99], v[48:51], v[176:179]
    v_mfma_f32_16x16x32_bf16 v[180:183], v[96:99], v[52:55], 0
    buffer_load_dwordx4 v16, s[20:23], s74 offen offset:0 lds
    v_mfma_f32_16x16x32_bf16 v[184:187], v[96:99], v[56:59], 0
    v_mfma_f32_16x16x32_bf16 v[188:191], v[96:99], v[60:63], 0
    buffer_load_dwordx4 v[96:99], v20, s[12:15], s75 offen offset:0 sc1
    s_waitcnt vmcnt(20)
    v_mfma_f32_16x16x32_bf16 v[192:195], v[100:103], v[48:51], v[192:195]
    v_mfma_f32_16x16x32_bf16 v[196:199], v[100:103], v[52:55], 0
    buffer_load_dwordx4 v17, s[20:23], s74 offen offset:1024 lds
    v_mfma_f32_16x16x32_bf16 v[200:203], v[100:103], v[56:59], 0
    v_mfma_f32_16x16x32_bf16 v[204:207], v[100:103], v[60:63], 0
    buffer_load_dwordx4 v[100:103], v20, s[12:15], s75 offen offset:1024 sc1
    s_waitcnt vmcnt(21)
    ds_read_b64_tr_b16 v[64:65], v22 offset:20480
    v_mfma_f32_16x16x32_bf16 v[208:211], v[104:107], v[48:51], v[208:211]
    ds_read_b64_tr_b16 v[66:67], v22 offset:21504
    ds_read_b64_tr_b16 v[68:69], v23 offset:20480
    v_mfma_f32_16x16x32_bf16 v[212:215], v[104:107], v[52:55], 0
    buffer_load_dwordx4 v18, s[20:23], s74 offen offset:2048 lds
    v_mfma_f32_16x16x32_bf16 v[216:219], v[104:107], v[56:59], 0
    ds_read_b64_tr_b16 v[70:71], v23 offset:21504
    ds_read_b64_tr_b16 v[72:73], v24 offset:20480
    v_mfma_f32_16x16x32_bf16 v[220:223], v[104:107], v[60:63], 0
    buffer_load_dwordx4 v[104:107], v20, s[12:15], s75 offen offset:2048 sc1
    s_waitcnt vmcnt(22)
    v_mfma_f32_16x16x32_bf16 v[224:227], v[108:111], v[48:51], v[224:227]
    ds_read_b64_tr_b16 v[74:75], v24 offset:21504
    ds_read_b64_tr_b16 v[76:77], v25 offset:20480
    v_mfma_f32_16x16x32_bf16 v[228:231], v[108:111], v[52:55], 0
    buffer_load_dwordx4 v19, s[20:23], s74 offen offset:3072 lds
    v_mfma_f32_16x16x32_bf16 v[232:235], v[108:111], v[56:59], 0
    ds_read_b64_tr_b16 v[78:79], v25 offset:21504
    v_mfma_f32_16x16x32_bf16 v[236:239], v[108:111], v[60:63], 0
    buffer_load_dwordx4 v[108:111], v20, s[12:15], s75 offen offset:3072 sc1
    s_waitcnt vmcnt(23)
    v_mfma_f32_16x16x32_bf16 v[240:243], v[112:115], v[48:51], v[240:243]
    v_mfma_f32_16x16x32_bf16 v[244:247], v[112:115], v[52:55], 0
    s_add_u32 s74, s74, 524288
    v_mfma_f32_16x16x32_bf16 v[248:251], v[112:115], v[56:59], 0
    v_mfma_f32_16x16x32_bf16 v[252:255], v[112:115], v[60:63], 0
    buffer_load_dwordx4 v[112:115], v21, s[12:15], s75 offen offset:0 sc1
    s_add_u32 s75, s75, 163840
    s_waitcnt lgkmcnt(0)
    s_add_u32 m0, s71, 20480
    s_waitcnt vmcnt(23)
    v_mfma_f32_16x16x32_bf16 v[176:179], v[116:119], v[64:67], v[176:179]
    v_mfma_f32_16x16x32_bf16 v[180:183], v[116:119], v[68:71], v[180:183]
    buffer_load_dwordx4 v16, s[20:23], s74 offen offset:0 lds
    v_mfma_f32_16x16x32_bf16 v[184:187], v[116:119], v[72:75], v[184:187]
    v_mfma_f32_16x16x32_bf16 v[188:191], v[116:119], v[76:79], v[188:191]
    buffer_load_dwordx4 v[116:119], v20, s[12:15], s75 offen offset:0 sc1
    s_waitcnt vmcnt(24)
    v_mfma_f32_16x16x32_bf16 v[192:195], v[120:123], v[64:67], v[192:195]
    v_mfma_f32_16x16x32_bf16 v[196:199], v[120:123], v[68:71], v[196:199]
    buffer_load_dwordx4 v17, s[20:23], s74 offen offset:1024 lds
    v_mfma_f32_16x16x32_bf16 v[200:203], v[120:123], v[72:75], v[200:203]
    v_mfma_f32_16x16x32_bf16 v[204:207], v[120:123], v[76:79], v[204:207]
    buffer_load_dwordx4 v[120:123], v20, s[12:15], s75 offen offset:1024 sc1
    s_waitcnt vmcnt(25)
    ds_read_b64_tr_b16 v[48:49], v22 offset:24576
    v_mfma_f32_16x16x32_bf16 v[208:211], v[124:127], v[64:67], v[208:211]
    ds_read_b64_tr_b16 v[50:51], v22 offset:25600
    ds_read_b64_tr_b16 v[52:53], v23 offset:24576
    v_mfma_f32_16x16x32_bf16 v[212:215], v[124:127], v[68:71], v[212:215]
    buffer_load_dwordx4 v18, s[20:23], s74 offen offset:2048 lds
    v_mfma_f32_16x16x32_bf16 v[216:219], v[124:127], v[72:75], v[216:219]
    ds_read_b64_tr_b16 v[54:55], v23 offset:25600
    ds_read_b64_tr_b16 v[56:57], v24 offset:24576
    v_mfma_f32_16x16x32_bf16 v[220:223], v[124:127], v[76:79], v[220:223]
    buffer_load_dwordx4 v[124:127], v20, s[12:15], s75 offen offset:2048 sc1
    s_waitcnt vmcnt(26)
    v_mfma_f32_16x16x32_bf16 v[224:227], v[128:131], v[64:67], v[224:227]
    ds_read_b64_tr_b16 v[58:59], v24 offset:25600
    ds_read_b64_tr_b16 v[60:61], v25 offset:24576
    v_mfma_f32_16x16x32_bf16 v[228:231], v[128:131], v[68:71], v[228:231]
    buffer_load_dwordx4 v19, s[20:23], s74 offen offset:3072 lds
    v_mfma_f32_16x16x32_bf16 v[232:235], v[128:131], v[72:75], v[232:235]
    ds_read_b64_tr_b16 v[62:63], v25 offset:25600
    v_mfma_f32_16x16x32_bf16 v[236:239], v[128:131], v[76:79], v[236:239]
    buffer_load_dwordx4 v[128:131], v20, s[12:15], s75 offen offset:3072 sc1
    s_waitcnt vmcnt(27)
    v_mfma_f32_16x16x32_bf16 v[240:243], v[132:135], v[64:67], v[240:243]
    v_mfma_f32_16x16x32_bf16 v[244:247], v[132:135], v[68:71], v[244:247]
    s_add_u32 s74, s74, 524288
    v_mfma_f32_16x16x32_bf16 v[248:251], v[132:135], v[72:75], v[248:251]
    v_mfma_f32_16x16x32_bf16 v[252:255], v[132:135], v[76:79], v[252:255]
    buffer_load_dwordx4 v[132:135], v21, s[12:15], s75 offen offset:0 sc1
    s_add_u32 s75, s75, 163840
    s_waitcnt lgkmcnt(0)
    s_add_u32 m0, s71, 24576
    s_waitcnt vmcnt(27)
    v_mfma_f32_16x16x32_bf16 v[176:179], v[136:139], v[48:51], v[176:179]
    v_mfma_f32_16x16x32_bf16 v[180:183], v[136:139], v[52:55], v[180:183]
    buffer_load_dwordx4 v16, s[20:23], s74 offen offset:0 lds
    v_mfma_f32_16x16x32_bf16 v[184:187], v[136:139], v[56:59], v[184:187]
    v_mfma_f32_16x16x32_bf16 v[188:191], v[136:139], v[60:63], v[188:191]
    buffer_load_dwordx4 v[136:139], v20, s[12:15], s75 offen offset:0 sc1
    s_waitcnt vmcnt(28)
    v_mfma_f32_16x16x32_bf16 v[192:195], v[140:143], v[48:51], v[192:195]
    v_mfma_f32_16x16x32_bf16 v[196:199], v[140:143], v[52:55], v[196:199]
    buffer_load_dwordx4 v17, s[20:23], s74 offen offset:1024 lds
    v_mfma_f32_16x16x32_bf16 v[200:203], v[140:143], v[56:59], v[200:203]
    v_mfma_f32_16x16x32_bf16 v[204:207], v[140:143], v[60:63], v[204:207]
    buffer_load_dwordx4 v[140:143], v20, s[12:15], s75 offen offset:1024 sc1
    s_waitcnt vmcnt(29)
    ds_read_b64_tr_b16 v[64:65], v22 offset:28672
    v_mfma_f32_16x16x32_bf16 v[208:211], v[144:147], v[48:51], v[208:211]
    ds_read_b64_tr_b16 v[66:67], v22 offset:29696
    ds_read_b64_tr_b16 v[68:69], v23 offset:28672
    v_mfma_f32_16x16x32_bf16 v[212:215], v[144:147], v[52:55], v[212:215]
    buffer_load_dwordx4 v18, s[20:23], s74 offen offset:2048 lds
    v_mfma_f32_16x16x32_bf16 v[216:219], v[144:147], v[56:59], v[216:219]
    ds_read_b64_tr_b16 v[70:71], v23 offset:29696
    ds_read_b64_tr_b16 v[72:73], v24 offset:28672
    v_mfma_f32_16x16x32_bf16 v[220:223], v[144:147], v[60:63], v[220:223]
    buffer_load_dwordx4 v[144:147], v20, s[12:15], s75 offen offset:2048 sc1
    s_waitcnt vmcnt(30)
    v_mfma_f32_16x16x32_bf16 v[224:227], v[148:151], v[48:51], v[224:227]
    ds_read_b64_tr_b16 v[74:75], v24 offset:29696
    ds_read_b64_tr_b16 v[76:77], v25 offset:28672
    v_mfma_f32_16x16x32_bf16 v[228:231], v[148:151], v[52:55], v[228:231]
    buffer_load_dwordx4 v19, s[20:23], s74 offen offset:3072 lds
    v_mfma_f32_16x16x32_bf16 v[232:235], v[148:151], v[56:59], v[232:235]
    ds_read_b64_tr_b16 v[78:79], v25 offset:29696
    v_mfma_f32_16x16x32_bf16 v[236:239], v[148:151], v[60:63], v[236:239]
    buffer_load_dwordx4 v[148:151], v20, s[12:15], s75 offen offset:3072 sc1
    s_waitcnt vmcnt(31)
    v_mfma_f32_16x16x32_bf16 v[240:243], v[152:155], v[48:51], v[240:243]
    v_mfma_f32_16x16x32_bf16 v[244:247], v[152:155], v[52:55], v[244:247]
    s_add_u32 s74, s74, 524288
    v_mfma_f32_16x16x32_bf16 v[248:251], v[152:155], v[56:59], v[248:251]
    v_mfma_f32_16x16x32_bf16 v[252:255], v[152:155], v[60:63], v[252:255]
    buffer_load_dwordx4 v[152:155], v21, s[12:15], s75 offen offset:0 sc1
    s_add_u32 s75, s75, 163840
    s_waitcnt lgkmcnt(0)
    s_add_u32 m0, s71, 28672
    s_waitcnt vmcnt(31)
    v_mfma_f32_16x16x32_bf16 v[176:179], v[156:159], v[64:67], v[176:179]
    v_mfma_f32_16x16x32_bf16 v[180:183], v[156:159], v[68:71], v[180:183]
    buffer_load_dwordx4 v16, s[20:23], s74 offen offset:0 lds
    v_mfma_f32_16x16x32_bf16 v[184:187], v[156:159], v[72:75], v[184:187]
    v_mfma_f32_16x16x32_bf16 v[188:191], v[156:159], v[76:79], v[188:191]
    buffer_load_dwordx4 v[156:159], v20, s[12:15], s75 offen offset:0 sc1
    s_waitcnt vmcnt(32)
    v_mfma_f32_16x16x32_bf16 v[192:195], v[160:163], v[64:67], v[192:195]
    v_mfma_f32_16x16x32_bf16 v[196:199], v[160:163], v[68:71], v[196:199]
    buffer_load_dwordx4 v17, s[20:23], s74 offen offset:1024 lds
    v_mfma_f32_16x16x32_bf16 v[200:203], v[160:163], v[72:75], v[200:203]
    v_mfma_f32_16x16x32_bf16 v[204:207], v[160:163], v[76:79], v[204:207]
    buffer_load_dwordx4 v[160:163], v20, s[12:15], s75 offen offset:1024 sc1
    s_waitcnt vmcnt(33)
    ds_read_b64_tr_b16 v[48:49], v22 offset:32768
    v_mfma_f32_16x16x32_bf16 v[208:211], v[164:167], v[64:67], v[208:211]
    ds_read_b64_tr_b16 v[50:51], v22 offset:33792
    ds_read_b64_tr_b16 v[52:53], v23 offset:32768
    v_mfma_f32_16x16x32_bf16 v[212:215], v[164:167], v[68:71], v[212:215]
    buffer_load_dwordx4 v18, s[20:23], s74 offen offset:2048 lds
    v_mfma_f32_16x16x32_bf16 v[216:219], v[164:167], v[72:75], v[216:219]
    ds_read_b64_tr_b16 v[54:55], v23 offset:33792
    ds_read_b64_tr_b16 v[56:57], v24 offset:32768
    v_mfma_f32_16x16x32_bf16 v[220:223], v[164:167], v[76:79], v[220:223]
    buffer_load_dwordx4 v[164:167], v20, s[12:15], s75 offen offset:2048 sc1
    s_waitcnt vmcnt(34)
    v_mfma_f32_16x16x32_bf16 v[224:227], v[168:171], v[64:67], v[224:227]
    ds_read_b64_tr_b16 v[58:59], v24 offset:33792
    ds_read_b64_tr_b16 v[60:61], v25 offset:32768
    v_mfma_f32_16x16x32_bf16 v[228:231], v[168:171], v[68:71], v[228:231]
    buffer_load_dwordx4 v19, s[20:23], s74 offen offset:3072 lds
    v_mfma_f32_16x16x32_bf16 v[232:235], v[168:171], v[72:75], v[232:235]
    ds_read_b64_tr_b16 v[62:63], v25 offset:33792
    v_mfma_f32_16x16x32_bf16 v[236:239], v[168:171], v[76:79], v[236:239]
    buffer_load_dwordx4 v[168:171], v20, s[12:15], s75 offen offset:3072 sc1
    s_waitcnt vmcnt(35)
    v_mfma_f32_16x16x32_bf16 v[240:243], v[172:175], v[64:67], v[240:243]
    v_mfma_f32_16x16x32_bf16 v[244:247], v[172:175], v[68:71], v[244:247]
    s_add_u32 s74, s74, 524288
    v_mfma_f32_16x16x32_bf16 v[248:251], v[172:175], v[72:75], v[248:251]
    v_mfma_f32_16x16x32_bf16 v[252:255], v[172:175], v[76:79], v[252:255]
    buffer_load_dwordx4 v[172:175], v21, s[12:15], s75 offen offset:0 sc1
    s_add_u32 s75, s75, 163840
    s_waitcnt lgkmcnt(0)
    s_add_u32 m0, s71, 32768
    s_waitcnt vmcnt(34)
    v_mfma_f32_16x16x32_bf16 v[176:179], v[96:99], v[48:51], v[176:179]
    v_mfma_f32_16x16x32_bf16 v[180:183], v[96:99], v[52:55], v[180:183]
    buffer_load_dwordx4 v16, s[20:23], s74 offen offset:0 lds
    v_mfma_f32_16x16x32_bf16 v[184:187], v[96:99], v[56:59], v[184:187]
    v_mfma_f32_16x16x32_bf16 v[188:191], v[96:99], v[60:63], v[188:191]
    buffer_load_dwordx4 v[96:99], v20, s[12:15], s75 offen offset:0 sc1
    s_waitcnt vmcnt(34)
    v_mfma_f32_16x16x32_bf16 v[192:195], v[100:103], v[48:51], v[192:195]
    v_mfma_f32_16x16x32_bf16 v[196:199], v[100:103], v[52:55], v[196:199]
    buffer_load_dwordx4 v17, s[20:23], s74 offen offset:1024 lds
    v_mfma_f32_16x16x32_bf16 v[200:203], v[100:103], v[56:59], v[200:203]
    v_mfma_f32_16x16x32_bf16 v[204:207], v[100:103], v[60:63], v[204:207]
    buffer_load_dwordx4 v[100:103], v20, s[12:15], s75 offen offset:1024 sc1
    s_waitcnt vmcnt(34)
    ds_read_b64_tr_b16 v[64:65], v22 offset:0
    v_mfma_f32_16x16x32_bf16 v[208:211], v[104:107], v[48:51], v[208:211]
    ds_read_b64_tr_b16 v[66:67], v22 offset:1024
    ds_read_b64_tr_b16 v[68:69], v23 offset:0
    v_mfma_f32_16x16x32_bf16 v[212:215], v[104:107], v[52:55], v[212:215]
    buffer_load_dwordx4 v18, s[20:23], s74 offen offset:2048 lds
    v_mfma_f32_16x16x32_bf16 v[216:219], v[104:107], v[56:59], v[216:219]
    ds_read_b64_tr_b16 v[70:71], v23 offset:1024
    ds_read_b64_tr_b16 v[72:73], v24 offset:0
    v_mfma_f32_16x16x32_bf16 v[220:223], v[104:107], v[60:63], v[220:223]
    buffer_load_dwordx4 v[104:107], v20, s[12:15], s75 offen offset:2048 sc1
    s_waitcnt vmcnt(34)
    v_mfma_f32_16x16x32_bf16 v[224:227], v[108:111], v[48:51], v[224:227]
    ds_read_b64_tr_b16 v[74:75], v24 offset:1024
    ds_read_b64_tr_b16 v[76:77], v25 offset:0
    v_mfma_f32_16x16x32_bf16 v[228:231], v[108:111], v[52:55], v[228:231]
    buffer_load_dwordx4 v19, s[20:23], s74 offen offset:3072 lds
    v_mfma_f32_16x16x32_bf16 v[232:235], v[108:111], v[56:59], v[232:235]
    ds_read_b64_tr_b16 v[78:79], v25 offset:1024
    v_mfma_f32_16x16x32_bf16 v[236:239], v[108:111], v[60:63], v[236:239]
    buffer_load_dwordx4 v[108:111], v20, s[12:15], s75 offen offset:3072 sc1
    s_waitcnt vmcnt(35)
    v_mfma_f32_16x16x32_bf16 v[240:243], v[112:115], v[48:51], v[240:243]
    v_mfma_f32_16x16x32_bf16 v[244:247], v[112:115], v[52:55], v[244:247]
    s_add_u32 s74, s74, 524288
    v_mfma_f32_16x16x32_bf16 v[248:251], v[112:115], v[56:59], v[248:251]
    v_mfma_f32_16x16x32_bf16 v[252:255], v[112:115], v[60:63], v[252:255]
    buffer_load_dwordx4 v[112:115], v21, s[12:15], s75 offen offset:0 sc1
    s_add_u32 s75, s75, 163840
    s_waitcnt lgkmcnt(0)
    s_waitcnt vmcnt(34)
    v_mfma_f32_16x16x32_bf16 v[176:179], v[116:119], v[64:67], v[176:179]
    v_mfma_f32_16x16x32_bf16 v[180:183], v[116:119], v[68:71], v[180:183]
    v_mfma_f32_16x16x32_bf16 v[184:187], v[116:119], v[72:75], v[184:187]
    v_mfma_f32_16x16x32_bf16 v[188:191], v[116:119], v[76:79], v[188:191]
    buffer_load_dwordx4 v[116:119], v20, s[12:15], s75 offen offset:0 sc1
    s_waitcnt vmcnt(33)
    v_mfma_f32_16x16x32_bf16 v[192:195], v[120:123], v[64:67], v[192:195]
    v_mfma_f32_16x16x32_bf16 v[196:199], v[120:123], v[68:71], v[196:199]
    v_mfma_f32_16x16x32_bf16 v[200:203], v[120:123], v[72:75], v[200:203]
    v_mfma_f32_16x16x32_bf16 v[204:207], v[120:123], v[76:79], v[204:207]
    buffer_load_dwordx4 v[120:123], v20, s[12:15], s75 offen offset:1024 sc1
    s_waitcnt vmcnt(32)
    ds_read_b64_tr_b16 v[48:49], v22 offset:4096
    v_mfma_f32_16x16x32_bf16 v[208:211], v[124:127], v[64:67], v[208:211]
    ds_read_b64_tr_b16 v[50:51], v22 offset:5120
    ds_read_b64_tr_b16 v[52:53], v23 offset:4096
    v_mfma_f32_16x16x32_bf16 v[212:215], v[124:127], v[68:71], v[212:215]
    v_mfma_f32_16x16x32_bf16 v[216:219], v[124:127], v[72:75], v[216:219]
    ds_read_b64_tr_b16 v[54:55], v23 offset:5120
    ds_read_b64_tr_b16 v[56:57], v24 offset:4096
    v_mfma_f32_16x16x32_bf16 v[220:223], v[124:127], v[76:79], v[220:223]
    buffer_load_dwordx4 v[124:127], v20, s[12:15], s75 offen offset:2048 sc1
    s_waitcnt vmcnt(31)
    v_mfma_f32_16x16x32_bf16 v[224:227], v[128:131], v[64:67], v[224:227]
    ds_read_b64_tr_b16 v[58:59], v24 offset:5120
    ds_read_b64_tr_b16 v[60:61], v25 offset:4096
    v_mfma_f32_16x16x32_bf16 v[228:231], v[128:131], v[68:71], v[228:231]
    v_mfma_f32_16x16x32_bf16 v[232:235], v[128:131], v[72:75], v[232:235]
    ds_read_b64_tr_b16 v[62:63], v25 offset:5120
    v_mfma_f32_16x16x32_bf16 v[236:239], v[128:131], v[76:79], v[236:239]
    buffer_load_dwordx4 v[128:131], v20, s[12:15], s75 offen offset:3072 sc1
    s_waitcnt vmcnt(31)
    v_mfma_f32_16x16x32_bf16 v[240:243], v[132:135], v[64:67], v[240:243]
    v_mfma_f32_16x16x32_bf16 v[244:247], v[132:135], v[68:71], v[244:247]
    v_mfma_f32_16x16x32_bf16 v[248:251], v[132:135], v[72:75], v[248:251]
    v_mfma_f32_16x16x32_bf16 v[252:255], v[132:135], v[76:79], v[252:255]
    buffer_load_dwordx4 v[132:135], v21, s[12:15], s75 offen offset:0 sc1
    s_add_u32 s75, s75, 163840
    s_waitcnt lgkmcnt(0)
    s_waitcnt vmcnt(30)
    v_mfma_f32_16x16x32_bf16 v[176:179], v[136:139], v[48:51], v[176:179]
    v_mfma_f32_16x16x32_bf16 v[180:183], v[136:139], v[52:55], v[180:183]
    v_mfma_f32_16x16x32_bf16 v[184:187], v[136:139], v[56:59], v[184:187]
    v_mfma_f32_16x16x32_bf16 v[188:191], v[136:139], v[60:63], v[188:191]
    buffer_load_dwordx4 v[136:139], v20, s[12:15], s75 offen offset:0 sc1
    s_waitcnt vmcnt(29)
    v_mfma_f32_16x16x32_bf16 v[192:195], v[140:143], v[48:51], v[192:195]
    v_mfma_f32_16x16x32_bf16 v[196:199], v[140:143], v[52:55], v[196:199]
    v_mfma_f32_16x16x32_bf16 v[200:203], v[140:143], v[56:59], v[200:203]
    v_mfma_f32_16x16x32_bf16 v[204:207], v[140:143], v[60:63], v[204:207]
    buffer_load_dwordx4 v[140:143], v20, s[12:15], s75 offen offset:1024 sc1
    s_waitcnt vmcnt(28)
    ds_read_b64_tr_b16 v[64:65], v22 offset:8192
    v_mfma_f32_16x16x32_bf16 v[208:211], v[144:147], v[48:51], v[208:211]
    ds_read_b64_tr_b16 v[66:67], v22 offset:9216
    ds_read_b64_tr_b16 v[68:69], v23 offset:8192
    v_mfma_f32_16x16x32_bf16 v[212:215], v[144:147], v[52:55], v[212:215]
    v_mfma_f32_16x16x32_bf16 v[216:219], v[144:147], v[56:59], v[216:219]
    ds_read_b64_tr_b16 v[70:71], v23 offset:9216
    ds_read_b64_tr_b16 v[72:73], v24 offset:8192
    v_mfma_f32_16x16x32_bf16 v[220:223], v[144:147], v[60:63], v[220:223]
    buffer_load_dwordx4 v[144:147], v20, s[12:15], s75 offen offset:2048 sc1
    s_waitcnt vmcnt(27)
    v_mfma_f32_16x16x32_bf16 v[224:227], v[148:151], v[48:51], v[224:227]
    ds_read_b64_tr_b16 v[74:75], v24 offset:9216
    ds_read_b64_tr_b16 v[76:77], v25 offset:8192
    v_mfma_f32_16x16x32_bf16 v[228:231], v[148:151], v[52:55], v[228:231]
    v_mfma_f32_16x16x32_bf16 v[232:235], v[148:151], v[56:59], v[232:235]
    ds_read_b64_tr_b16 v[78:79], v25 offset:9216
    v_mfma_f32_16x16x32_bf16 v[236:239], v[148:151], v[60:63], v[236:239]
    buffer_load_dwordx4 v[148:151], v20, s[12:15], s75 offen offset:3072 sc1
    s_waitcnt vmcnt(27)
    v_mfma_f32_16x16x32_bf16 v[240:243], v[152:155], v[48:51], v[240:243]
    v_mfma_f32_16x16x32_bf16 v[244:247], v[152:155], v[52:55], v[244:247]
    v_mfma_f32_16x16x32_bf16 v[248:251], v[152:155], v[56:59], v[248:251]
    v_mfma_f32_16x16x32_bf16 v[252:255], v[152:155], v[60:63], v[252:255]
    buffer_load_dwordx4 v[152:155], v21, s[12:15], s75 offen offset:0 sc1
    s_add_u32 s75, s75, 163840
    s_waitcnt lgkmcnt(0)
    s_waitcnt vmcnt(26)
    v_mfma_f32_16x16x32_bf16 v[176:179], v[156:159], v[64:67], v[176:179]
    v_mfma_f32_16x16x32_bf16 v[180:183], v[156:159], v[68:71], v[180:183]
    v_mfma_f32_16x16x32_bf16 v[184:187], v[156:159], v[72:75], v[184:187]
    v_mfma_f32_16x16x32_bf16 v[188:191], v[156:159], v[76:79], v[188:191]
    buffer_load_dwordx4 v[156:159], v20, s[12:15], s75 offen offset:0 sc1
    s_waitcnt vmcnt(25)
    v_mfma_f32_16x16x32_bf16 v[192:195], v[160:163], v[64:67], v[192:195]
    v_mfma_f32_16x16x32_bf16 v[196:199], v[160:163], v[68:71], v[196:199]
    v_mfma_f32_16x16x32_bf16 v[200:203], v[160:163], v[72:75], v[200:203]
    v_mfma_f32_16x16x32_bf16 v[204:207], v[160:163], v[76:79], v[204:207]
    buffer_load_dwordx4 v[160:163], v20, s[12:15], s75 offen offset:1024 sc1
    s_waitcnt vmcnt(24)
    ds_read_b64_tr_b16 v[48:49], v22 offset:12288
    v_mfma_f32_16x16x32_bf16 v[208:211], v[164:167], v[64:67], v[208:211]
    ds_read_b64_tr_b16 v[50:51], v22 offset:13312
    ds_read_b64_tr_b16 v[52:53], v23 offset:12288
    v_mfma_f32_16x16x32_bf16 v[212:215], v[164:167], v[68:71], v[212:215]
    v_mfma_f32_16x16x32_bf16 v[216:219], v[164:167], v[72:75], v[216:219]
    ds_read_b64_tr_b16 v[54:55], v23 offset:13312
    ds_read_b64_tr_b16 v[56:57], v24 offset:12288
    v_mfma_f32_16x16x32_bf16 v[220:223], v[164:167], v[76:79], v[220:223]
    buffer_load_dwordx4 v[164:167], v20, s[12:15], s75 offen offset:2048 sc1
    s_waitcnt vmcnt(23)
    v_mfma_f32_16x16x32_bf16 v[224:227], v[168:171], v[64:67], v[224:227]
    ds_read_b64_tr_b16 v[58:59], v24 offset:13312
    ds_read_b64_tr_b16 v[60:61], v25 offset:12288
    v_mfma_f32_16x16x32_bf16 v[228:231], v[168:171], v[68:71], v[228:231]
    v_mfma_f32_16x16x32_bf16 v[232:235], v[168:171], v[72:75], v[232:235]
    ds_read_b64_tr_b16 v[62:63], v25 offset:13312
    v_mfma_f32_16x16x32_bf16 v[236:239], v[168:171], v[76:79], v[236:239]
    buffer_load_dwordx4 v[168:171], v20, s[12:15], s75 offen offset:3072 sc1
    s_waitcnt vmcnt(23)
    v_mfma_f32_16x16x32_bf16 v[240:243], v[172:175], v[64:67], v[240:243]
    v_mfma_f32_16x16x32_bf16 v[244:247], v[172:175], v[68:71], v[244:247]
    v_mfma_f32_16x16x32_bf16 v[248:251], v[172:175], v[72:75], v[248:251]
    v_mfma_f32_16x16x32_bf16 v[252:255], v[172:175], v[76:79], v[252:255]
    buffer_load_dwordx4 v[172:175], v21, s[12:15], s75 offen offset:0 sc1
    s_add_u32 s75, s75, 163840
    s_waitcnt lgkmcnt(0)
    s_waitcnt vmcnt(22)
    v_mfma_f32_16x16x32_bf16 v[176:179], v[96:99], v[48:51], v[176:179]
    v_mfma_f32_16x16x32_bf16 v[180:183], v[96:99], v[52:55], v[180:183]
    v_mfma_f32_16x16x32_bf16 v[184:187], v[96:99], v[56:59], v[184:187]
    v_mfma_f32_16x16x32_bf16 v[188:191], v[96:99], v[60:63], v[188:191]
    buffer_load_dwordx4 v[96:99], v20, s[12:15], s75 offen offset:0 sc1
    s_waitcnt vmcnt(21)
    v_mfma_f32_16x16x32_bf16 v[192:195], v[100:103], v[48:51], v[192:195]
    v_mfma_f32_16x16x32_bf16 v[196:199], v[100:103], v[52:55], v[196:199]
    v_mfma_f32_16x16x32_bf16 v[200:203], v[100:103], v[56:59], v[200:203]
    v_mfma_f32_16x16x32_bf16 v[204:207], v[100:103], v[60:63], v[204:207]
    buffer_load_dwordx4 v[100:103], v20, s[12:15], s75 offen offset:1024 sc1
    s_waitcnt vmcnt(20)
    ds_read_b64_tr_b16 v[64:65], v22 offset:16384
    v_mfma_f32_16x16x32_bf16 v[208:211], v[104:107], v[48:51], v[208:211]
    ds_read_b64_tr_b16 v[66:67], v22 offset:17408
    ds_read_b64_tr_b16 v[68:69], v23 offset:16384
    v_mfma_f32_16x16x32_bf16 v[212:215], v[104:107], v[52:55], v[212:215]
    v_mfma_f32_16x16x32_bf16 v[216:219], v[104:107], v[56:59], v[216:219]
    ds_read_b64_tr_b16 v[70:71], v23 offset:17408
    ds_read_b64_tr_b16 v[72:73], v24 offset:16384
    v_mfma_f32_16x16x32_bf16 v[220:223], v[104:107], v[60:63], v[220:223]
    buffer_load_dwordx4 v[104:107], v20, s[12:15], s75 offen offset:2048 sc1
    s_waitcnt vmcnt(19)
    v_mfma_f32_16x16x32_bf16 v[224:227], v[108:111], v[48:51], v[224:227]
    ds_read_b64_tr_b16 v[74:75], v24 offset:17408
    ds_read_b64_tr_b16 v[76:77], v25 offset:16384
    v_mfma_f32_16x16x32_bf16 v[228:231], v[108:111], v[52:55], v[228:231]
    v_mfma_f32_16x16x32_bf16 v[232:235], v[108:111], v[56:59], v[232:235]
    ds_read_b64_tr_b16 v[78:79], v25 offset:17408
    v_mfma_f32_16x16x32_bf16 v[236:239], v[108:111], v[60:63], v[236:239]
    buffer_load_dwordx4 v[108:111], v20, s[12:15], s75 offen offset:3072 sc1
    s_waitcnt vmcnt(19)
    v_mfma_f32_16x16x32_bf16 v[240:243], v[112:115], v[48:51], v[240:243]
    v_mfma_f32_16x16x32_bf16 v[244:247], v[112:115], v[52:55], v[244:247]
    v_mfma_f32_16x16x32_bf16 v[248:251], v[112:115], v[56:59], v[248:251]
    v_mfma_f32_16x16x32_bf16 v[252:255], v[112:115], v[60:63], v[252:255]
    buffer_load_dwordx4 v[112:115], v21, s[12:15], s75 offen offset:0 sc1
    s_add_u32 s75, s75, 163840
    s_waitcnt lgkmcnt(0)
    s_waitcnt vmcnt(19)
    s_load_dword s101, s[12:13], s81 glc
    v_mfma_f32_16x16x32_bf16 v[176:179], v[116:119], v[64:67], v[176:179]
    v_mfma_f32_16x16x32_bf16 v[180:183], v[116:119], v[68:71], v[180:183]
    v_mfma_f32_16x16x32_bf16 v[184:187], v[116:119], v[72:75], v[184:187]
    v_mfma_f32_16x16x32_bf16 v[188:191], v[116:119], v[76:79], v[188:191]
    buffer_load_dwordx4 v[116:119], v20, s[12:15], s75 offen offset:0 sc1
    s_waitcnt vmcnt(19)
    v_mfma_f32_16x16x32_bf16 v[192:195], v[120:123], v[64:67], v[192:195]
    v_mfma_f32_16x16x32_bf16 v[196:199], v[120:123], v[68:71], v[196:199]
    v_mfma_f32_16x16x32_bf16 v[200:203], v[120:123], v[72:75], v[200:203]
    v_mfma_f32_16x16x32_bf16 v[204:207], v[120:123], v[76:79], v[204:207]
    buffer_load_dwordx4 v[120:123], v20, s[12:15], s75 offen offset:1024 sc1
    s_waitcnt vmcnt(19)
    ds_read_b64_tr_b16 v[48:49], v22 offset:20480
    v_mfma_f32_16x16x32_bf16 v[208:211], v[124:127], v[64:67], v[208:211]
    ds_read_b64_tr_b16 v[50:51], v22 offset:21504
    ds_read_b64_tr_b16 v[52:53], v23 offset:20480
    v_mfma_f32_16x16x32_bf16 v[212:215], v[124:127], v[68:71], v[212:215]
    v_mfma_f32_16x16x32_bf16 v[216:219], v[124:127], v[72:75], v[216:219]
    ds_read_b64_tr_b16 v[54:55], v23 offset:21504
    ds_read_b64_tr_b16 v[56:57], v24 offset:20480
    v_mfma_f32_16x16x32_bf16 v[220:223], v[124:127], v[76:79], v[220:223]
    buffer_load_dwordx4 v[124:127], v20, s[12:15], s75 offen offset:2048 sc1
    s_waitcnt vmcnt(19)
    v_mfma_f32_16x16x32_bf16 v[224:227], v[128:131], v[64:67], v[224:227]
    ds_read_b64_tr_b16 v[58:59], v24 offset:21504
    ds_read_b64_tr_b16 v[60:61], v25 offset:20480
    v_mfma_f32_16x16x32_bf16 v[228:231], v[128:131], v[68:71], v[228:231]
    v_mfma_f32_16x16x32_bf16 v[232:235], v[128:131], v[72:75], v[232:235]
    ds_read_b64_tr_b16 v[62:63], v25 offset:21504
    v_mfma_f32_16x16x32_bf16 v[236:239], v[128:131], v[76:79], v[236:239]
    buffer_load_dwordx4 v[128:131], v20, s[12:15], s75 offen offset:3072 sc1
    s_waitcnt vmcnt(19)
    v_mfma_f32_16x16x32_bf16 v[240:243], v[132:135], v[64:67], v[240:243]
    v_mfma_f32_16x16x32_bf16 v[244:247], v[132:135], v[68:71], v[244:247]
    v_mfma_f32_16x16x32_bf16 v[248:251], v[132:135], v[72:75], v[248:251]
    v_mfma_f32_16x16x32_bf16 v[252:255], v[132:135], v[76:79], v[252:255]
    buffer_load_dwordx4 v[132:135], v21, s[12:15], s75 offen offset:0 sc1
    s_add_u32 s75, s75, 163840
    s_waitcnt lgkmcnt(0)
    s_cmp_ge_u32 s101, 0x500
    s_cbranch_scc1 ok_16
    s_mov_b32 s97, 400000
sp_15:
    s_sleep 1
    s_load_dword s101, s[12:13], s81 glc
    s_waitcnt lgkmcnt(0)
    s_cmp_ge_u32 s101, 0x500
    s_cbranch_scc1 ok_16
    s_sub_u32 s97, s97, 1
    s_cbranch_scc0 sp_15
    v_mov_b32 v14, 40
    v_mov_b32 v15, 230
    buffer_store_dword v15, v14, s[40:43], 0 offen
ok_16:
    s_waitcnt vmcnt(19)
    v_mfma_f32_16x16x32_bf16 v[176:179], v[136:139], v[48:51], v[176:179]
    v_mfma_f32_16x16x32_bf16 v[180:183], v[136:139], v[52:55], v[180:183]
    v_mfma_f32_16x16x32_bf16 v[184:187], v[136:139], v[56:59], v[184:187]
    v_mfma_f32_16x16x32_bf16 v[188:191], v[136:139], v[60:63], v[188:191]
    buffer_load_dwordx4 v[136:139], v20, s[12:15], s77 offen offset:0 sc1
    s_waitcnt vmcnt(19)
    v_mfma_f32_16x16x32_bf16 v[192:195], v[140:143], v[48:51], v[192:195]
    v_mfma_f32_16x16x32_bf16 v[196:199], v[140:143], v[52:55], v[196:199]
    v_mfma_f32_16x16x32_bf16 v[200:203], v[140:143], v[56:59], v[200:203]
    v_mfma_f32_16x16x32_bf16 v[204:207], v[140:143], v[60:63], v[204:207]
    buffer_load_dwordx4 v[140:143], v20, s[12:15], s77 offen offset:1024 sc1
    s_waitcnt vmcnt(19)
    ds_read_b64_tr_b16 v[64:65], v22 offset:24576
    v_mfma_f32_16x16x32_bf16 v[208:211], v[144:147], v[48:51], v[208:211]
    ds_read_b64_tr_b16 v[66:67], v22 offset:25600
    ds_read_b64_tr_b16 v[68:69], v23 offset:24576
    v_mfma_f32_16x16x32_bf16 v[212:215], v[144:147], v[52:55], v[212:215]
    v_mfma_f32_16x16x32_bf16 v[216:219], v[144:147], v[56:59], v[216:219]
    ds_read_b64_tr_b16 v[70:71], v23 offset:25600
    ds_read_b64_tr_b16 v[72:73], v24 offset:24576
    v_mfma_f32_16x16x32_bf16 v[220:223], v[144:147], v[60:63], v[220:223]
    buffer_load_dwordx4 v[144:147], v20, s[12:15], s77 offen offset:2048 sc1
    s_waitcnt vmcnt(19)
    v_mfma_f32_16x16x32_bf16 v[224:227], v[148:151], v[48:51], v[224:227]
    ds_read_b64_tr_b16 v[74:75], v24 offset:25600
    ds_read_b64_tr_b16 v[76:77], v25 offset:24576
    v_mfma_f32_16x16x32_bf16 v[228:231], v[148:151], v[52:55], v[228:231]
    v_mfma_f32_16x16x32_bf16 v[232:235], v[148:151], v[56:59], v[232:235]
    ds_read_b64_tr_b16 v[78:79], v25 offset:25600
    v_mfma_f32_16x16x32_bf16 v[236:239], v[148:151], v[60:63], v[236:239]
    buffer_load_dwordx4 v[148:151], v20, s[12:15], s77 offen offset:3072 sc1
    s_waitcnt vmcnt(19)
    v_mfma_f32_16x16x32_bf16 v[240:243], v[152:155], v[48:51], v[240:243]
    v_mfma_f32_16x16x32_bf16 v[244:247], v[152:155], v[52:55], v[244:247]
    v_mfma_f32_16x16x32_bf16 v[248:251], v[152:155], v[56:59], v[248:251]
    v_mfma_f32_16x16x32_bf16 v[252:255], v[152:155], v[60:63], v[252:255]
    buffer_load_dwordx4 v[152:155], v21, s[12:15], s77 offen offset:0 sc1
    s_add_u32 s77, s77, 5120
    s_waitcnt lgkmcnt(0)
    s_waitcnt vmcnt(19)
    v_mfma_f32_16x16x32_bf16 v[176:179], v[156:159], v[64:67], v[176:179]
    v_mfma_f32_16x16x32_bf16 v[180:183], v[156:159], v[68:71], v[180:183]
    v_mfma_f32_16x16x32_bf16 v[184:187], v[156:159], v[72:75], v[184:187]
    v_mfma_f32_16x16x32_bf16 v[188:191], v[156:159], v[76:79], v[188:191]
    buffer_load_dwordx4 v[156:159], v20, s[12:15], s77 offen offset:0 sc1
    s_waitcnt vmcnt(19)
    v_mfma_f32_16x16x32_bf16 v[192:195], v[160:163], v[64:67], v[192:195]
    v_mfma_f32_16x16x32_bf16 v[196:199], v[160:163], v[68:71], v[196:199]
    v_mfma_f32_16x16x32_bf16 v[200:203], v[160:163], v[72:75], v[200:203]
    v_mfma_f32_16x16x32_bf16 v[204:207], v[160:163], v[76:79], v[204:207]
    buffer_load_dwordx4 v[160:163], v20, s[12:15], s77 offen offset:1024 sc1
    s_waitcnt vmcnt(19)
    ds_read_b64_tr_b16 v[48:49], v22 offset:28672
    v_mfma_f32_16x16x32_bf16 v[208:211], v[164:167], v[64:67], v[208:211]
    ds_read_b64_tr_b16 v[50:51], v22 offset:29696
    ds_read_b64_tr_b16 v[52:53], v23 offset:28672
    v_mfma_f32_16x16x32_bf16 v[212:215], v[164:167], v[68:71], v[212:215]
    v_mfma_f32_16x16x32_bf16 v[216:219], v[164:167], v[72:75], v[216:219]
    ds_read_b64_tr_b16 v[54:55], v23 offset:29696
    ds_read_b64_tr_b16 v[56:57], v24 offset:28672
    v_mfma_f32_16x16x32_bf16 v[220:223], v[164:167], v[76:79], v[220:223]
    buffer_load_dwordx4 v[164:167], v20, s[12:15], s77 offen offset:2048 sc1
    s_waitcnt vmcnt(19)
    v_mfma_f32_16x16x32_bf16 v[224:227], v[168:171], v[64:67], v[224:227]
    ds_read_b64_tr_b16 v[58:59], v24 offset:29696
    ds_read_b64_tr_b16 v[60:61], v25 offset:28672
    v_mfma_f32_16x16x32_bf16 v[228:231], v[168:171], v[68:71], v[228:231]
    v_mfma_f32_16x16x32_bf16 v[232:235], v[168:171], v[72:75], v[232:235]
    ds_read_b64_tr_b16 v[62:63], v25 offset:29696
    v_mfma_f32_16x16x32_bf16 v[236:239], v[168:171], v[76:79], v[236:239]
    buffer_load_dwordx4 v[168:171], v20, s[12:15], s77 offen offset:3072 sc1
    s_waitcnt vmcnt(19)
    v_mfma_f32_16x16x32_bf16 v[240:243], v[172:175], v[64:67], v[240:243]
    v_mfma_f32_16x16x32_bf16 v[244:247], v[172:175], v[68:71], v[244:247]
    v_mfma_f32_16x16x32_bf16 v[248:251], v[172:175], v[72:75], v[248:251]
    v_mfma_f32_16x16x32_bf16 v[252:255], v[172:175], v[76:79], v[252:255]
    buffer_load_dwordx4 v[172:175], v21, s[12:15], s77 offen offset:0 sc1
    s_add_u32 s77, s77, 5120
    s_waitcnt lgkmcnt(0)
    s_waitcnt vmcnt(19)
    s_load_dword s101, s[12:13], s81 glc
    v_mfma_f32_16x16x32_bf16 v[176:179], v[96:99], v[48:51], v[176:179]
    v_mfma_f32_16x16x32_bf16 v[180:183], v[96:99], v[52:55], v[180:183]
    v_mfma_f32_16x16x32_bf16 v[184:187], v[96:99], v[56:59], v[184:187]
    v_mfma_f32_16x16x32_bf16 v[188:191], v[96:99], v[60:63], v[188:191]
    buffer_load_dwordx4 v[96:99], v20, s[12:15], s77 offen offset:0 sc1
    s_waitcnt vmcnt(19)
    v_mfma_f32_16x16x32_bf16 v[192:195], v[100:103], v[48:51], v[192:195]
    v_mfma_f32_16x16x32_bf16 v[196:199], v[100:103], v[52:55], v[196:199]
    v_mfma_f32_16x16x32_bf16 v[200:203], v[100:103], v[56:59], v[200:203]
    v_mfma_f32_16x16x32_bf16 v[204:207], v[100:103], v[60:63], v[204:207]
    buffer_load_dwordx4 v[100:103], v20, s[12:15], s77 offen offset:1024 sc1
    s_waitcnt vmcnt(19)
    ds_read_b64_tr_b16 v[64:65], v22 offset:32768
    v_mfma_f32_16x16x32_bf16 v[208:211], v[104:107], v[48:51], v[208:211]
    ds_read_b64_tr_b16 v[66:67], v22 offset:33792
    ds_read_b64_tr_b16 v[68:69], v23 offset:32768
    v_mfma_f32_16x16x32_bf16 v[212:215], v[104:107], v[52:55], v[212:215]
    v_mfma_f32_16x16x32_bf16 v[216:219], v[104:107], v[56:59], v[216:219]
    ds_read_b64_tr_b16 v[70:71], v23 offset:33792
    ds_read_b64_tr_b16 v[72:73], v24 offset:32768
    v_mfma_f32_16x16x32_bf16 v[220:223], v[104:107], v[60:63], v[220:223]
    buffer_load_dwordx4 v[104:107], v20, s[12:15], s77 offen offset:2048 sc1
    s_waitcnt vmcnt(19)
    v_mfma_f32_16x16x32_bf16 v[224:227], v[108:111], v[48:51], v[224:227]
    ds_read_b64_tr_b16 v[74:75], v24 offset:33792
    ds_read_b64_tr_b16 v[76:77], v25 offset:32768
    v_mfma_f32_16x16x32_bf16 v[228:231], v[108:111], v[52:55], v[228:231]
    v_mfma_f32_16x16x32_bf16 v[232:235], v[108:111], v[56:59], v[232:235]
    ds_read_b64_tr_b16 v[78:79], v25 offset:33792
    v_mfma_f32_16x16x32_bf16 v[236:239], v[108:111], v[60:63], v[236:239]
    buffer_load_dwordx4 v[108:111], v20, s[12:15], s77 offen offset:3072 sc1
    s_waitcnt vmcnt(19)
    v_mfma_f32_16x16x32_bf16 v[240:243], v[112:115], v[48:51], v[240:243]
    v_mfma_f32_16x16x32_bf16 v[244:247], v[112:115], v[52:55], v[244:247]
    v_mfma_f32_16x16x32_bf16 v[248:251], v[112:115], v[56:59], v[248:251]
    v_mfma_f32_16x16x32_bf16 v[252:255], v[112:115], v[60:63], v[252:255]
    buffer_load_dwordx4 v[112:115], v21, s[12:15], s77 offen offset:0 sc1
    s_add_u32 s77, s77, 5120
    s_waitcnt lgkmcnt(0)
    s_and_b32 s101, s101, 0xff
    s_cmp_ge_u32 s101, 8
    s_cbranch_scc1 ok_18
    s_mov_b32 s97, 400000
sp_17:
    s_sleep 1
    s_load_dword s101, s[12:13], s81 glc
    s_waitcnt lgkmcnt(0)
    s_and_b32 s101, s101, 0xff
    s_cmp_ge_u32 s101, 8
    s_cbranch_scc1 ok_18
    s_sub_u32 s97, s97, 1
    s_cbranch_scc0 sp_17
    v_mov_b32 v14, 56
    v_mov_b32 v15, 234
    buffer_store_dword v15, v14, s[40:43], 0 offen
ok_18:
    s_waitcnt vmcnt(19)
    buffer_load_dwordx4 v[80:83], v37, s[12:15], s76 offen offset:0 sc1
    v_mfma_f32_16x16x32_bf16 v[176:179], v[116:119], v[64:67], v[176:179]
    buffer_load_dwordx4 v[84:87], v38, s[12:15], s76 offen offset:0 sc1
    v_mfma_f32_16x16x32_bf16 v[180:183], v[116:119], v[68:71], v[180:183]
    buffer_load_dwordx4 v[88:91], v39, s[12:15], s76 offen offset:0 sc1
    v_mfma_f32_16x16x32_bf16 v[184:187], v[116:119], v[72:75], v[184:187]
    buffer_load_dwordx4 v[92:95], v40, s[12:15], s76 offen offset:0 sc1
    v_mfma_f32_16x16x32_bf16 v[188:191], v[116:119], v[76:79], v[188:191]
    buffer_load_dwordx4 v[116:119], v20, s[12:15], s77 offen offset:0 sc1
    s_waitcnt vmcnt(23)
    v_mfma_f32_16x16x32_bf16 v[192:195], v[120:123], v[64:67], v[192:195]
    v_mfma_f32_16x16x32_bf16 v[196:199], v[120:123], v[68:71], v[196:199]
    buffer_load_dwordx4 v[48:51], v37, s[12:15], s76 offen offset:1024 sc1
    v_mfma_f32_16x16x32_bf16 v[200:203], v[120:123], v[72:75], v[200:203]
    v_mfma_f32_16x16x32_bf16 v[204:207], v[120:123], v[76:79], v[204:207]
    buffer_load_dwordx4 v[120:123], v20, s[12:15], s77 offen offset:1024 sc1
    s_waitcnt vmcnt(24)
    v_mfma_f32_16x16x32_bf16 v[208:211], v[124:127], v[64:67], v[208:211]
    v_mfma_f32_16x16x32_bf16 v[212:215], v[124:127], v[68:71], v[212:215]
    buffer_load_dwordx4 v[52:55], v38, s[12:15], s76 offen offset:1024 sc1
    v_mfma_f32_16x16x32_bf16 v[216:219], v[124:127], v[72:75], v[216:219]
    v_mfma_f32_16x16x32_bf16 v[220:223], v[124:127], v[76:79], v[220:223]
    buffer_load_dwordx4 v[124:127], v20, s[12:15], s77 offen offset:2048 sc1
    s_waitcnt vmcnt(25)
    v_mfma_f32_16x16x32_bf16 v[224:227], v[128:131], v[64:67], v[224:227]
    v_mfma_f32_16x16x32_bf16 v[228:231], v[128:131], v[68:71], v[228:231]
    buffer_load_dwordx4 v[56:59], v39, s[12:15], s76 offen offset:1024 sc1
    v_mfma_f32_16x16x32_bf16 v[232:235], v[128:131], v[72:75], v[232:235]
    v_mfma_f32_16x16x32_bf16 v[236:239], v[128:131], v[76:79], v[236:239]
    buffer_load_dwordx4 v[128:131], v20, s[12:15], s77 offen offset:3072 sc1
    s_waitcnt vmcnt(26)
    v_mfma_f32_16x16x32_bf16 v[240:243], v[132:135], v[64:67], v[240:243]
    v_mfma_f32_16x16x32_bf16 v[244:247], v[132:135], v[68:71], v[244:247]
    buffer_load_dwordx4 v[60:63], v40, s[12:15], s76 offen offset:1024 sc1
    v_mfma_f32_16x16x32_bf16 v[248:251], v[132:135], v[72:75], v[248:251]
    v_mfma_f32_16x16x32_bf16 v[252:255], v[132:135], v[76:79], v[252:255]
    buffer_load_dwordx4 v[132:135], v21, s[12:15], s77 offen offset:0 sc1
    s_add_u32 s77, s77, 5120
    s_waitcnt vmcnt(23)
    s_waitcnt vmcnt(12)
    v_mfma_f32_16x16x32_bf16 v[176:179], v[136:139], v[80:83], v[176:179]
    v_mfma_f32_16x16x32_bf16 v[192:195], v[140:143], v[80:83], v[192:195]
    buffer_load_dwordx4 v[64:67], v37, s[12:15], s76 offen offset:2048 sc1
    v_mfma_f32_16x16x32_bf16 v[208:211], v[144:147], v[80:83], v[208:211]
    v_mfma_f32_16x16x32_bf16 v[224:227], v[148:151], v[80:83], v[224:227]
    v_mfma_f32_16x16x32_bf16 v[240:243], v[152:155], v[80:83], v[240:243]
    buffer_load_dwordx4 v[80:83], v37, s[12:15], s76 offen offset:3072 sc1
    s_waitcnt vmcnt(13)
    v_mfma_f32_16x16x32_bf16 v[180:183], v[136:139], v[84:87], v[180:183]
    v_mfma_f32_16x16x32_bf16 v[196:199], v[140:143], v[84:87], v[196:199]
    buffer_load_dwordx4 v[68:71], v38, s[12:15], s76 offen offset:2048 sc1
    v_mfma_f32_16x16x32_bf16 v[212:215], v[144:147], v[84:87], v[212:215]
    v_mfma_f32_16x16x32_bf16 v[228:231], v[148:151], v[84:87], v[228:231]
    v_mfma_f32_16x16x32_bf16 v[244:247], v[152:155], v[84:87], v[244:247]
    buffer_load_dwordx4 v[84:87], v38, s[12:15], s76 offen offset:3072 sc1
    s_waitcnt vmcnt(14)
    v_mfma_f32_16x16x32_bf16 v[184:187], v[136:139], v[88:91], v[184:187]
    v_mfma_f32_16x16x32_bf16 v[200:203], v[140:143], v[88:91], v[200:203]
    buffer_load_dwordx4 v[72:75], v39, s[12:15], s76 offen offset:2048 sc1
    v_mfma_f32_16x16x32_bf16 v[216:219], v[144:147], v[88:91], v[216:219]
    v_mfma_f32_16x16x32_bf16 v[232:235], v[148:151], v[88:91], v[232:235]
    v_mfma_f32_16x16x32_bf16 v[248:251], v[152:155], v[88:91], v[248:251]
    buffer_load_dwordx4 v[88:91], v39, s[12:15], s76 offen offset:3072 sc1
    s_waitcnt vmcnt(15)
    v_mfma_f32_16x16x32_bf16 v[188:191], v[136:139], v[92:95], v[188:191]
    buffer_load_dwordx4 v[136:139], v20, s[12:15], s77 offen offset:0 sc1
    v_mfma_f32_16x16x32_bf16 v[204:207], v[140:143], v[92:95], v[204:207]
    buffer_load_dwordx4 v[76:79], v40, s[12:15], s76 offen offset:2048 sc1
    buffer_load_dwordx4 v[140:143], v20, s[12:15], s77 offen offset:1024 sc1
    v_mfma_f32_16x16x32_bf16 v[220:223], v[144:147], v[92:95], v[220:223]
    buffer_load_dwordx4 v[144:147], v20, s[12:15], s77 offen offset:2048 sc1
    v_mfma_f32_16x16x32_bf16 v[236:239], v[148:151], v[92:95], v[236:239]
    buffer_load_dwordx4 v[148:151], v20, s[12:15], s77 offen offset:3072 sc1
    v_mfma_f32_16x16x32_bf16 v[252:255], v[152:155], v[92:95], v[252:255]
    buffer_load_dwordx4 v[92:95], v40, s[12:15], s76 offen offset:3072 sc1
    buffer_load_dwordx4 v[152:155], v21, s[12:15], s77 offen offset:0 sc1
    s_add_u32 s77, s77, 5120
    s_waitcnt vmcnt(20)
    v_mfma_f32_16x16x32_bf16 v[176:179], v[156:159], v[48:51], v[176:179]
    v_mfma_f32_16x16x32_bf16 v[192:195], v[160:163], v[48:51], v[192:195]
    v_mfma_f32_16x16x32_bf16 v[208:211], v[164:167], v[48:51], v[208:211]
    v_mfma_f32_16x16x32_bf16 v[224:227], v[168:171], v[48:51], v[224:227]
    v_mfma_f32_16x16x32_bf16 v[240:243], v[172:175], v[48:51], v[240:243]
    s_add_u32 s76, s76, 4096
    buffer_load_dwordx2 v[48:49], v31, s[12:15], s76 offen offset:0 sc1
    buffer_load_dwordx2 v[50:51], v31, s[12:15], s76 offen offset:128 sc1
    s_waitcnt vmcnt(20)
    v_mfma_f32_16x16x32_bf16 v[180:183], v[156:159], v[52:55], v[180:183]
    v_mfma_f32_16x16x32_bf16 v[196:199], v[160:163], v[52:55], v[196:199]
    v_mfma_f32_16x16x32_bf16 v[212:215], v[164:167], v[52:55], v[212:215]
    v_mfma_f32_16x16x32_bf16 v[228:231], v[168:171], v[52:55], v[228:231]
    v_mfma_f32_16x16x32_bf16 v[244:247], v[172:175], v[52:55], v[244:247]
    buffer_load_dwordx2 v[52:53], v32, s[12:15], s76 offen offset:0 sc1
    buffer_load_dwordx2 v[54:55], v32, s[12:15], s76 offen offset:128 sc1
    s_waitcnt vmcnt(20)
    v_mfma_f32_16x16x32_bf16 v[184:187], v[156:159], v[56:59], v[184:187]
    v_mfma_f32_16x16x32_bf16 v[200:203], v[160:163], v[56:59], v[200:203]
    v_mfma_f32_16x16x32_bf16 v[216:219], v[164:167], v[56:59], v[216:219]
    v_mfma_f32_16x16x32_bf16 v[232:235], v[168:171], v[56:59], v[232:235]
    v_mfma_f32_16x16x32_bf16 v[248:251], v[172:175], v[56:59], v[248:251]
    buffer_load_dwordx2 v[56:57], v33, s[12:15], s76 offen offset:0 sc1
    buffer_load_dwordx2 v[58:59], v33, s[12:15], s76 offen offset:128 sc1
    s_waitcnt vmcnt(20)
    v_mfma_f32_16x16x32_bf16 v[188:191], v[156:159], v[60:63], v[188:191]
    v_mfma_f32_16x16x32_bf16 v[204:207], v[160:163], v[60:63], v[204:207]
    v_mfma_f32_16x16x32_bf16 v[220:223], v[164:167], v[60:63], v[220:223]
    v_mfma_f32_16x16x32_bf16 v[236:239], v[168:171], v[60:63], v[236:239]
    v_mfma_f32_16x16x32_bf16 v[252:255], v[172:175], v[60:63], v[252:255]
    buffer_load_dwordx2 v[60:61], v34, s[12:15], s76 offen offset:0 sc1
    buffer_load_dwordx2 v[62:63], v34, s[12:15], s76 offen offset:128 sc1
    s_waitcnt vmcnt(20)
    v_mfma_f32_16x16x32_bf16 v[176:179], v[96:99], v[64:67], v[176:179]
    v_mfma_f32_16x16x32_bf16 v[192:195], v[100:103], v[64:67], v[192:195]
    v_mfma_f32_16x16x32_bf16 v[208:211], v[104:107], v[64:67], v[208:211]
    v_mfma_f32_16x16x32_bf16 v[224:227], v[108:111], v[64:67], v[224:227]
    v_mfma_f32_16x16x32_bf16 v[240:243], v[112:115], v[64:67], v[240:243]
    s_waitcnt vmcnt(18)
    v_mfma_f32_16x16x32_bf16 v[180:183], v[96:99], v[68:71], v[180:183]
    v_mfma_f32_16x16x32_bf16 v[196:199], v[100:103], v[68:71], v[196:199]
    v_mfma_f32_16x16x32_bf16 v[212:215], v[104:107], v[68:71], v[212:215]
    v_mfma_f32_16x16x32_bf16 v[228:231], v[108:111], v[68:71], v[228:231]
    v_mfma_f32_16x16x32_bf16 v[244:247], v[112:115], v[68:71], v[244:247]
    s_waitcnt vmcnt(16)
    v_mfma_f32_16x16x32_bf16 v[184:187], v[96:99], v[72:75], v[184:187]
    v_mfma_f32_16x16x32_bf16 v[200:203], v[100:103], v[72:75], v[200:203]
    v_mfma_f32_16x16x32_bf16 v[216:219], v[104:107], v[72:75], v[216:219]
    v_mfma_f32_16x16x32_bf16 v[232:235], v[108:111], v[72:75], v[232:235]
    v_mfma_f32_16x16x32_bf16 v[248:251], v[112:115], v[72:75], v[248:251]
    s_waitcnt vmcnt(13)
    v_mfma_f32_16x16x32_bf16 v[188:191], v[96:99], v[76:79], v[188:191]
    v_mfma_f32_16x16x32_bf16 v[204:207], v[100:103], v[76:79], v[204:207]
    v_mfma_f32_16x16x32_bf16 v[220:223], v[104:107], v[76:79], v[220:223]
    v_mfma_f32_16x16x32_bf16 v[236:239], v[108:111], v[76:79], v[236:239]
    v_mfma_f32_16x16x32_bf16 v[252:255], v[112:115], v[76:79], v[252:255]
    v_mfma_f32_16x16x32_bf16 v[176:179], v[116:119], v[80:83], v[176:179]
    v_mfma_f32_16x16x32_bf16 v[192:195], v[120:123], v[80:83], v[192:195]
    v_mfma_f32_16x16x32_bf16 v[208:211], v[124:127], v[80:83], v[208:211]
    v_mfma_f32_16x16x32_bf16 v[224:227], v[128:131], v[80:83], v[224:227]
    v_mfma_f32_16x16x32_bf16 v[240:243], v[132:135], v[80:83], v[240:243]
    v_mfma_f32_16x16x32_bf16 v[180:183], v[116:119], v[84:87], v[180:183]
    v_mfma_f32_16x16x32_bf16 v[196:199], v[120:123], v[84:87], v[196:199]
    v_mfma_f32_16x16x32_bf16 v[212:215], v[124:127], v[84:87], v[212:215]
    v_mfma_f32_16x16x32_bf16 v[228:231], v[128:131], v[84:87], v[228:231]
    v_mfma_f32_16x16x32_bf16 v[244:247], v[132:135], v[84:87], v[244:247]
    v_mfma_f32_16x16x32_bf16 v[184:187], v[116:119], v[88:91], v[184:187]
    v_mfma_f32_16x16x32_bf16 v[200:203], v[120:123], v[88:91], v[200:203]
    v_mfma_f32_16x16x32_bf16 v[216:219], v[124:127], v[88:91], v[216:219]
    v_mfma_f32_16x16x32_bf16 v[232:235], v[128:131], v[88:91], v[232:235]
    v_mfma_f32_16x16x32_bf16 v[248:251], v[132:135], v[88:91], v[248:251]
    s_waitcnt vmcnt(9)
    v_mfma_f32_16x16x32_bf16 v[188:191], v[116:119], v[92:95], v[188:191]
    v_mfma_f32_16x16x32_bf16 v[204:207], v[120:123], v[92:95], v[204:207]
    v_mfma_f32_16x16x32_bf16 v[220:223], v[124:127], v[92:95], v[220:223]
    v_mfma_f32_16x16x32_bf16 v[236:239], v[128:131], v[92:95], v[236:239]
    v_mfma_f32_16x16x32_bf16 v[252:255], v[132:135], v[92:95], v[252:255]
    s_waitcnt vmcnt(8)
    s_waitcnt vmcnt(4)
    v_mfma_f32_16x16x32_bf16 v[180:183], v[136:139], v[52:55], v[180:183]
    v_mfma_f32_16x16x32_bf16 v[196:199], v[140:143], v[52:55], v[196:199]
    v_mfma_f32_16x16x32_bf16 v[212:215], v[144:147], v[52:55], v[212:215]
    v_mfma_f32_16x16x32_bf16 v[228:231], v[148:151], v[52:55], v[228:231]
    v_mfma_f32_16x16x32_bf16 v[244:247], v[152:155], v[52:55], v[244:247]
    s_waitcnt vmcnt(2)
    v_mfma_f32_16x16x32_bf16 v[184:187], v[136:139], v[56:59], v[184:187]
    v_mfma_f32_16x16x32_bf16 v[200:203], v[140:143], v[56:59], v[200:203]
    s_nop 0
    ds_write_b128 v42, v[180:183] offset:0
    v_mfma_f32_16x16x32_bf16 v[216:219], v[144:147], v[56:59], v[216:219]
    ds_write_b128 v42, v[196:199] offset:1024
    v_mfma_f32_16x16x32_bf16 v[232:235], v[148:151], v[56:59], v[232:235]
    ds_write_b128 v42, v[212:215] offset:2048
    v_mfma_f32_16x16x32_bf16 v[248:251], v[152:155], v[56:59], v[248:251]
    s_waitcnt vmcnt(0)
    ds_write_b128 v42, v[228:231] offset:3072
    v_mfma_f32_16x16x32_bf16 v[188:191], v[136:139], v[60:63], v[188:191]
    ds_write_b128 v42, v[244:247] offset:4096
    v_mfma_f32_16x16x32_bf16 v[204:207], v[140:143], v[60:63], v[204:207]
    ds_write_b128 v42, v[184:187] offset:5120
    v_mfma_f32_16x16x32_bf16 v[220:223], v[144:147], v[60:63], v[220:223]
    ds_write_b128 v42, v[200:203] offset:6144
    v_mfma_f32_16x16x32_bf16 v[236:239], v[148:151], v[60:63], v[236:239]
    ds_write_b128 v42, v[216:219] offset:7168
    v_mfma_f32_16x16x32_bf16 v[252:255], v[152:155], v[60:63], v[252:255]
    ds_write_b128 v42, v[232:235] offset:8192
    v_mfma_f32_16x16x32_bf16 v[176:179], v[136:139], v[48:51], v[176:179]
    ds_write_b128 v42, v[248:251] offset:9216
    v_mfma_f32_16x16x32_bf16 v[192:195], v[140:143], v[48:51], v[192:195]
    ds_write_b128 v42, v[188:191] offset:10240
    v_mfma_f32_16x16x32_bf16 v[208:211], v[144:147], v[48:51], v[208:211]
    ds_write_b128 v42, v[204:207] offset:11264
    v_mfma_f32_16x16x32_bf16 v[224:227], v[148:151], v[48:51], v[224:227]
    ds_write_b128 v42, v[220:223] offset:12288
    v_mfma_f32_16x16x32_bf16 v[240:243], v[152:155], v[48:51], v[240:243]
    ds_write_b128 v42, v[236:239] offset:13312
    ds_write_b128 v42, v[252:255] offset:14336
    s_waitcnt lgkmcnt(0)
    s_barrier
    ds_read_b128 v[96:99], v43 offset:0
    ds_read_b128 v[100:103], v44 offset:5120
    ds_read_b128 v[104:107], v45 offset:10240
    ds_read_b128 v[108:111], v43 offset:1024
    ds_read_b128 v[112:115], v44 offset:6144
    ds_read_b128 v[116:119], v45 offset:11264
    ds_read_b128 v[120:123], v43 offset:2048
    ds_read_b128 v[124:127], v44 offset:7168
    ds_read_b128 v[128:131], v45 offset:12288
    ds_read_b128 v[132:135], v43 offset:3072
    ds_read_b128 v[136:139], v44 offset:8192
    ds_read_b128 v[140:143], v45 offset:13312
    ds_read_b128 v[144:147], v43 offset:4096
    ds_read_b128 v[148:151], v44 offset:9216
    ds_read_b128 v[152:155], v45 offset:14336
    s_waitcnt lgkmcnt(12)
    v_pk_add_f32 v[96:97], v[96:97], v[100:101]
    v_pk_add_f32 v[98:99], v[98:99], v[102:103]
    v_pk_add_f32 v[176:177], v[176:177], v[104:105]
    v_pk_add_f32 v[178:179], v[178:179], v[106:107]
    v_pk_add_f32 v[176:177], v[176:177], v[96:97]
    v_pk_add_f32 v[178:179], v[178:179], v[98:99]
    v_cvt_pk_bf16_f32 v176, v176, v177
    v_cvt_pk_bf16_f32 v177, v178, v179
    ds_write_b64 v29, v[176:177] offset:0
    s_waitcnt lgkmcnt(10)
    v_pk_add_f32 v[108:109], v[108:109], v[112:113]
    v_pk_add_f32 v[110:111], v[110:111], v[114:115]
    v_pk_add_f32 v[192:193], v[192:193], v[116:117]
    v_pk_add_f32 v[194:195], v[194:195], v[118:119]
    v_pk_add_f32 v[192:193], v[192:193], v[108:109]
    v_pk_add_f32 v[194:195], v[194:195], v[110:111]
    v_cvt_pk_bf16_f32 v192, v192, v193
    v_cvt_pk_bf16_f32 v193, v194, v195
    ds_write_b64 v29, v[192:193] offset:32
    s_waitcnt lgkmcnt(8)
    v_pk_add_f32 v[120:121], v[120:121], v[124:125]
    v_pk_add_f32 v[122:123], v[122:123], v[126:127]
    v_pk_add_f32 v[208:209], v[208:209], v[128:129]
    v_pk_add_f32 v[210:211], v[210:211], v[130:131]
    v_pk_add_f32 v[208:209], v[208:209], v[120:121]
    v_pk_add_f32 v[210:211], v[210:211], v[122:123]
    v_cvt_pk_bf16_f32 v208, v208, v209
    v_cvt_pk_bf16_f32 v209, v210, v211
    ds_write_b64 v29, v[208:209] offset:64
    s_waitcnt lgkmcnt(6)
    v_pk_add_f32 v[132:133], v[132:133], v[136:137]
    v_pk_add_f32 v[134:135], v[134:135], v[138:139]
    v_pk_add_f32 v[224:225], v[224:225], v[140:141]
    v_pk_add_f32 v[226:227], v[226:227], v[142:143]
    v_pk_add_f32 v[224:225], v[224:225], v[132:133]
    v_pk_add_f32 v[226:227], v[226:227], v[134:135]
    v_cvt_pk_bf16_f32 v224, v224, v225
    v_cvt_pk_bf16_f32 v225, v226, v227
    ds_write_b64 v29, v[224:225] offset:96
    s_waitcnt lgkmcnt(4)
    v_pk_add_f32 v[144:145], v[144:145], v[148:149]
    v_pk_add_f32 v[146:147], v[146:147], v[150:151]
    v_pk_add_f32 v[240:241], v[240:241], v[152:153]
    v_pk_add_f32 v[242:243], v[242:243], v[154:155]
    v_pk_add_f32 v[240:241], v[240:241], v[144:145]
    v_pk_add_f32 v[242:243], v[242:243], v[146:147]
    v_cvt_pk_bf16_f32 v240, v240, v241
    v_cvt_pk_bf16_f32 v241, v242, v243
    ds_write_b64 v29, v[240:241] offset:128
    ds_read_b128 v[84:87], v30 offset:0
    ds_read_b128 v[88:91], v30 offset:1024
    ds_read_b128 v[92:95], v30 offset:2048
    s_waitcnt lgkmcnt(2)
    buffer_store_dwordx4 v[84:87], v26, s[28:31], 0 offen nt
    s_waitcnt lgkmcnt(1)
    buffer_store_dwordx4 v[88:91], v27, s[28:31], 0 offen nt
    s_waitcnt lgkmcnt(0)
    buffer_store_dwordx4 v[92:95], v28, s[28:31], 0 offen nt
    s_endpgm
L_B:
    s_lshr_b32 s75, s45, 1
    s_mul_i32 s75, s75, 22
    s_add_u32 s75, s75, s49
    s_mul_i32 s55, s75, 24
    s_add_u32 s55, s55, s44
    s_mul_i32 s55, s55, 1280
    s_add_u32 s56, s55, 10240
    s_add_u32 s57, s55, 20480
    v_lshlrev_b32 v2, 2, v1
    s_waitcnt lgkmcnt(0)
    s_cmp_lt_u32 s49, 22
    s_cbranch_scc0 L_B0
    buffer_load_dword v96, v2, s[4:7], s55 offen offset:0
    buffer_load_dword v97, v2, s[4:7], s55 offen offset:256
    buffer_load_dword v98, v2, s[4:7], s55 offen offset:512
    buffer_load_dword v99, v2, s[4:7], s55 offen offset:768
    buffer_load_dword v100, v2, s[4:7], s55 offen offset:1024
    buffer_load_dword v101, v2, s[4:7], s56 offen offset:0
    buffer_load_dword v102, v2, s[4:7], s56 offen offset:256
    buffer_load_dword v103, v2, s[4:7], s56 offen offset:512
    buffer_load_dword v104, v2, s[4:7], s56 offen offset:768
    buffer_load_dword v105, v2, s[4:7], s56 offen offset:1024
    buffer_load_dword v106, v2, s[4:7], s57 offen offset:0
    buffer_load_dword v107, v2, s[4:7], s57 offen offset:256
    buffer_load_dword v108, v2, s[4:7], s57 offen offset:512
    buffer_load_dword v109, v2, s[4:7], s57 offen offset:768
    buffer_load_dword v110, v2, s[4:7], s57 offen offset:1024
L_B0:
    s_lshr_b32 s73, s44, 2
    v_lshrrev_b32 v4, 3, v1
    v_mul_u32_u24 v4, 3456, v4
    v_bfe_u32 v5, v1, 2, 1
    v_bfe_u32 v6, v1, 4, 1
    v_xor_b32 v5, v5, v6
    v_lshl_add_u32 v4, v5, 6, v4
    v_and_b32 v7, 3, v1
    v_lshl_add_u32 v80, v7, 4, v4
    s_mul_i32 s69, s44, 55296
    s_lshl_b32 s57, s47, 7
    s_add_u32 s69, s69, s57
    s_lshl_b32 s57, s48, 2
    s_add_u32 s57, s57, s62
    s_lshl_b32 s57, s57, 17
    s_add_u32 s70, s57, 1638400
    s_cmp_ge_u32 s52, 135
    s_cselect_b32 s69, 0x70000000, s69
    s_cselect_b32 s70, 0x70000000, s70
    s_lshl_b32 s68, s44, 11
    v_add_u32 v81, 26624, v80
    s_cmp_lt_u32 s44, 4
    s_cbranch_scc0 L_19
    s_add_u32 m0, s68, 0
    s_nop 0
    buffer_load_dwordx4 v80, s[16:19], s69 offen lds
    buffer_load_dwordx4 v81, s[16:19], s69 offen offset:1024 lds
    s_add_u32 s69, s69, 221184
    s_add_u32 m0, s68, 8192
    s_nop 0
    buffer_load_dwordx4 v80, s[16:19], s69 offen lds
    buffer_load_dwordx4 v81, s[16:19], s69 offen offset:1024 lds
    s_add_u32 s69, s69, 221184
L_19:
    v_lshlrev_b32 v91, 4, v1
    v_bfe_u32 v8, v1, 2, 2
    v_lshrrev_b32 v4, 5, v1
    v_lshl_add_u32 v9, v4, 3, v8
    v_lshlrev_b32 v5, 7, v9
    v_lshl_add_u32 v5, v6, 5, v5
    v_lshl_add_u32 v5, v7, 3, v5
    v_lshrrev_b32 v10, 1, v8
    v_lshl_add_u32 v82, v10, 6, v5
    v_xor_b32 v83, 64, v82
    v_add_u32 v84, 0x10000, v82
    v_add_u32 v85, 0x10000, v83
    v_add_u32 v86, 0x20000, v82
    v_add_u32 v87, 0x20000, v83
    v_and_b32 v7, 15, v1
    v_lshlrev_b32 v12, 4, v7
    v_lshl_add_u32 v12, v6, 10, v12
    v_lshl_add_u32 v88, v4, 8, v12
    s_lshl_b32 s57, s47, 7
    v_lshl_add_u32 v89, v4, 3, s57
    s_cmp_lt_u32 s49, 22
    s_cbranch_scc1 L_B1
    s_barrier
    s_cmp_lt_u32 s44, 4
    s_cbranch_scc1 L_B2
    v_mov_b32 v254, 0
    buffer_load_dwordx2 v[250:251], v254, s[40:43], 0 offen sc1
    s_waitcnt vmcnt(0)
    v_mov_b32 v254, 0
    s_mov_b32 s97, 400000
nl_20:
    v_readfirstlane_b32 s50, v250
    v_readfirstlane_b32 s51, v251
    s_cmp_lg_u32 s50, 0
    s_cbranch_scc1 ok_21
    s_sleep 2
    buffer_load_dwordx2 v[250:251], v254, s[40:43], 0 offen sc1
    s_waitcnt vmcnt(0)
    s_sub_u32 s97, s97, 1
    s_cbranch_scc0 nl_20
    v_mov_b32 v14, 24
    v_mov_b32 v15, 226
    buffer_store_dword v15, v14, s[40:43], 0 offen
ok_21:
    s_branch L_YB
L_B1:
    v_lshrrev_b32 v10, 4, v1
    v_and_b32 v7, 3, v1
    v_mul_u32_u24 v11, 1296, v8
    v_lshl_add_u32 v11, v10, 5, v11
    v_lshl_add_u32 v11, v7, 3, v11
    v_and_b32 v12, 31, v1
    v_lshlrev_b32 v12, 4, v12
    v_lshl_add_u32 v12, v4, 17, v12
    s_cmp_ge_u32 s44, 4
    s_cbranch_scc0 L_22
    s_mul_i32 s56, s75, 3
    s_lshl_b32 s55, s56, 9
    s_lshl_b32 s57, s62, 18
    s_add_u32 s55, s55, s57
    s_add_u32 s55, s55, 1638400
    s_lshl_b32 s57, s62, 7
    s_add_u32 s57, s57, 116352
    s_mov_b32 s58, s62
    v_add_u32 v172, s57, v11
    s_cmp_lt_u32 s56, 256
    s_cselect_b32 s80, s55, 0x70000000
    s_add_u32 s55, s55, 1048576
    s_add_u32 s57, s57, 512
    s_add_u32 s58, s58, 4
    v_add_u32 v173, s57, v11
    s_cmp_lt_u32 s56, 256
    s_cselect_b32 s81, s55, 0x70000000
    s_add_u32 s55, s55, 1048576
    s_add_u32 s57, s57, 512
    s_add_u32 s58, s58, 4
    s_cmp_ge_u32 s58, 10
    s_cselect_b32 s59, 1, 0
    s_add_u32 s56, s56, s59
    s_mul_i32 s100, s59, 10
    s_sub_u32 s58, s58, s100
    s_mul_i32 s100, s59, 0xffd80200
    s_add_u32 s55, s55, s100
    s_mul_i32 s100, s59, 9088
    s_add_u32 s57, s57, s100
    v_add_u32 v174, s57, v11
    s_cmp_lt_u32 s56, 256
    s_cselect_b32 s82, s55, 0x70000000
    s_add_u32 s55, s55, 1048576
    s_add_u32 s57, s57, 512
    s_add_u32 s58, s58, 4
    s_cmp_ge_u32 s58, 10
    s_cselect_b32 s59, 1, 0
    s_add_u32 s56, s56, s59
    s_mul_i32 s100, s59, 10
    s_sub_u32 s58, s58, s100
    s_mul_i32 s100, s59, 0xffd80200
    s_add_u32 s55, s55, s100
    s_mul_i32 s100, s59, 9088
    s_add_u32 s57, s57, s100
    v_add_u32 v175, s57, v11
    s_cmp_lt_u32 s56, 256
    s_cselect_b32 s83, s55, 0x70000000
    s_add_u32 s55, s55, 1048576
    s_add_u32 s57, s57, 512
    s_add_u32 s58, s58, 4
    v_add_u32 v176, s57, v11
    s_cmp_lt_u32 s56, 256
    s_cselect_b32 s84, s55, 0x70000000
    s_add_u32 s55, s55, 1048576
    s_add_u32 s57, s57, 512
    s_add_u32 s58, s58, 4
    s_cmp_ge_u32 s58, 10
    s_cselect_b32 s59, 1, 0
    s_add_u32 s56, s56, s59
    s_mul_i32 s100, s59, 10
    s_sub_u32 s58, s58, s100
    s_mul_i32 s100, s59, 0xffd80200
    s_add_u32 s55, s55, s100
    s_mul_i32 s100, s59, 9088
    s_add_u32 s57, s57, s100
    v_add_u32 v177, s57, v11
    s_cmp_lt_u32 s56, 256
    s_cselect_b32 s85, s55, 0x70000000
    s_add_u32 s55, s55, 1048576
    s_add_u32 s57, s57, 512
    s_add_u32 s58, s58, 4
    v_add_u32 v178, s57, v11
    s_cmp_lt_u32 s56, 256
    s_cselect_b32 s86, s55, 0x70000000
    s_add_u32 s55, s55, 1048576
    s_add_u32 s57, s57, 512
    s_add_u32 s58, s58, 4
    s_cmp_ge_u32 s58, 10
    s_cselect_b32 s59, 1, 0
    s_add_u32 s56, s56, s59
    s_mul_i32 s100, s59, 10
    s_sub_u32 s58, s58, s100
    s_mul_i32 s100, s59, 0xffd80200
    s_add_u32 s55, s55, s100
    s_mul_i32 s100, s59, 9088
    s_add_u32 s57, s57, s100
    s_cmp_lt_u32 s62, 2
    s_cselect_b32 s56, s56, 1000
    s_cselect_b32 s57, s57, 116352
    v_add_u32 v179, s57, v11
    s_cmp_lt_u32 s56, 256
    s_cselect_b32 s87, s55, 0x70000000
    s_mul_i32 s88, s75, 384
    s_add_u32 s88, s88, 0
    s_cmp_lt_u32 s75, 86
    s_cselect_b32 s59, s62, 7
    s_cmp_eq_u32 s59, 0
    s_cselect_b32 s88, s88, 0x7f000000
    s_mul_i32 s58, s75, 3
    s_add_u32 s58, s58, s62
    s_sub_u32 s58, s58, 1
    s_sub_u32 s59, s62, 1
    s_cmp_lt_u32 s59, 3
    s_cselect_b32 s58, s58, 1000
    s_lshl_b32 s59, s58, 10
    s_add_u32 s59, s59, 393216
    s_cmp_lt_u32 s58, 256
    s_cselect_b32 s89, s59, 0x7f000000
L_22:
    s_mul_i32 s55, s44, 1296
    s_add_u32 s55, s55, 116352
    v_add_u32 v2, s55, v2
    s_lshl_b32 s55, s44, 3
    s_add_u32 s55, s55, 160256
    v_mov_b32 v13, s55
    s_mov_b32 s55, 0x3acccccd
    s_mov_b32 s56, 0x3727c5ac
    s_cmp_lt_u32 s44, 4
    s_cbranch_scc1 L_23
    s_waitcnt vmcnt(0)
L_23:
    s_waitcnt vmcnt(4)
    v_lshlrev_b32 v112, 16, v96
    v_and_b32 v113, 0xffff0000, v96
    v_lshlrev_b32 v114, 16, v97
    v_and_b32 v115, 0xffff0000, v97
    v_lshlrev_b32 v116, 16, v98
    v_and_b32 v117, 0xffff0000, v98
    v_lshlrev_b32 v118, 16, v99
    v_and_b32 v119, 0xffff0000, v99
    v_lshlrev_b32 v120, 16, v100
    v_and_b32 v121, 0xffff0000, v100
    v_lshlrev_b32 v122, 16, v101
    v_and_b32 v123, 0xffff0000, v101
    v_lshlrev_b32 v124, 16, v102
    v_and_b32 v125, 0xffff0000, v102
    v_lshlrev_b32 v126, 16, v103
    v_and_b32 v127, 0xffff0000, v103
    v_lshlrev_b32 v128, 16, v104
    v_and_b32 v129, 0xffff0000, v104
    v_lshlrev_b32 v130, 16, v105
    v_and_b32 v131, 0xffff0000, v105
    v_lshlrev_b32 v132, 16, v106
    v_and_b32 v133, 0xffff0000, v106
    v_lshlrev_b32 v134, 16, v107
    v_and_b32 v135, 0xffff0000, v107
    v_lshlrev_b32 v136, 16, v108
    v_and_b32 v137, 0xffff0000, v108
    v_lshlrev_b32 v138, 16, v109
    v_and_b32 v139, 0xffff0000, v109
    v_lshlrev_b32 v140, 16, v110
    v_and_b32 v141, 0xffff0000, v110
    v_readfirstlane_b32 s64, v112
    v_readfirstlane_b32 s66, v122
    v_readfirstlane_b32 s76, v132
    v_pk_add_f32 v[112:113], v[112:113], s[64:65] op_sel_hi:[1,0] neg_lo:[0,1] neg_hi:[0,1]
    v_pk_add_f32 v[122:123], v[122:123], s[66:67] op_sel_hi:[1,0] neg_lo:[0,1] neg_hi:[0,1]
    v_pk_add_f32 v[132:133], v[132:133], s[76:77] op_sel_hi:[1,0] neg_lo:[0,1] neg_hi:[0,1]
    v_pk_add_f32 v[114:115], v[114:115], s[64:65] op_sel_hi:[1,0] neg_lo:[0,1] neg_hi:[0,1]
    v_pk_add_f32 v[124:125], v[124:125], s[66:67] op_sel_hi:[1,0] neg_lo:[0,1] neg_hi:[0,1]
    v_pk_add_f32 v[134:135], v[134:135], s[76:77] op_sel_hi:[1,0] neg_lo:[0,1] neg_hi:[0,1]
    v_pk_add_f32 v[116:117], v[116:117], s[64:65] op_sel_hi:[1,0] neg_lo:[0,1] neg_hi:[0,1]
    v_pk_add_f32 v[126:127], v[126:127], s[66:67] op_sel_hi:[1,0] neg_lo:[0,1] neg_hi:[0,1]
    v_pk_add_f32 v[136:137], v[136:137], s[76:77] op_sel_hi:[1,0] neg_lo:[0,1] neg_hi:[0,1]
    v_pk_add_f32 v[118:119], v[118:119], s[64:65] op_sel_hi:[1,0] neg_lo:[0,1] neg_hi:[0,1]
    v_pk_add_f32 v[128:129], v[128:129], s[66:67] op_sel_hi:[1,0] neg_lo:[0,1] neg_hi:[0,1]
    v_pk_add_f32 v[138:139], v[138:139], s[76:77] op_sel_hi:[1,0] neg_lo:[0,1] neg_hi:[0,1]
    v_pk_add_f32 v[120:121], v[120:121], s[64:65] op_sel_hi:[1,0] neg_lo:[0,1] neg_hi:[0,1]
    v_pk_add_f32 v[130:131], v[130:131], s[66:67] op_sel_hi:[1,0] neg_lo:[0,1] neg_hi:[0,1]
    v_pk_add_f32 v[140:141], v[140:141], s[76:77] op_sel_hi:[1,0] neg_lo:[0,1] neg_hi:[0,1]
    v_pk_add_f32 v[160:161], v[112:113], v[114:115]
    v_pk_mul_f32 v[166:167], v[112:113], v[112:113]
    v_pk_add_f32 v[162:163], v[122:123], v[124:125]
    v_pk_mul_f32 v[168:169], v[122:123], v[122:123]
    v_pk_add_f32 v[164:165], v[132:133], v[134:135]
    v_pk_mul_f32 v[170:171], v[132:133], v[132:133]
    v_pk_fma_f32 v[166:167], v[114:115], v[114:115], v[166:167]
    v_pk_fma_f32 v[168:169], v[124:125], v[124:125], v[168:169]
    v_pk_fma_f32 v[170:171], v[134:135], v[134:135], v[170:171]
    v_pk_add_f32 v[160:161], v[160:161], v[116:117]
    v_pk_fma_f32 v[166:167], v[116:117], v[116:117], v[166:167]
    v_pk_add_f32 v[162:163], v[162:163], v[126:127]
    v_pk_fma_f32 v[168:169], v[126:127], v[126:127], v[168:169]
    v_pk_add_f32 v[164:165], v[164:165], v[136:137]
    v_pk_fma_f32 v[170:171], v[136:137], v[136:137], v[170:171]
    v_pk_add_f32 v[160:161], v[160:161], v[118:119]
    v_pk_fma_f32 v[166:167], v[118:119], v[118:119], v[166:167]
    v_pk_add_f32 v[162:163], v[162:163], v[128:129]
    v_pk_fma_f32 v[168:169], v[128:129], v[128:129], v[168:169]
    v_pk_add_f32 v[164:165], v[164:165], v[138:139]
    v_pk_fma_f32 v[170:171], v[138:139], v[138:139], v[170:171]
    v_pk_add_f32 v[160:161], v[160:161], v[120:121]
    v_pk_fma_f32 v[166:167], v[120:121], v[120:121], v[166:167]
    v_pk_add_f32 v[162:163], v[162:163], v[130:131]
    v_pk_fma_f32 v[168:169], v[130:131], v[130:131], v[168:169]
    v_pk_add_f32 v[164:165], v[164:165], v[140:141]
    v_pk_fma_f32 v[170:171], v[140:141], v[140:141], v[170:171]
    v_add_f32 v142, v160, v161
    v_add_f32 v143, v166, v167
    v_add_f32 v144, v162, v163
    v_add_f32 v145, v168, v169
    v_add_f32 v146, v164, v165
    v_add_f32 v147, v170, v171
    v_add_f32_dpp v142, v142, v142 quad_perm:[1,0,3,2] row_mask:0xf bank_mask:0xf
    v_add_f32_dpp v143, v143, v143 quad_perm:[1,0,3,2] row_mask:0xf bank_mask:0xf
    v_add_f32_dpp v144, v144, v144 quad_perm:[1,0,3,2] row_mask:0xf bank_mask:0xf
    v_add_f32_dpp v145, v145, v145 quad_perm:[1,0,3,2] row_mask:0xf bank_mask:0xf
    v_add_f32_dpp v146, v146, v146 quad_perm:[1,0,3,2] row_mask:0xf bank_mask:0xf
    v_add_f32_dpp v147, v147, v147 quad_perm:[1,0,3,2] row_mask:0xf bank_mask:0xf
    v_add_f32_dpp v142, v142, v142 quad_perm:[2,3,0,1] row_mask:0xf bank_mask:0xf
    v_add_f32_dpp v143, v143, v143 quad_perm:[2,3,0,1] row_mask:0xf bank_mask:0xf
    v_add_f32_dpp v144, v144, v144 quad_perm:[2,3,0,1] row_mask:0xf bank_mask:0xf
    v_add_f32_dpp v145, v145, v145 quad_perm:[2,3,0,1] row_mask:0xf bank_mask:0xf
    v_add_f32_dpp v146, v146, v146 quad_perm:[2,3,0,1] row_mask:0xf bank_mask:0xf
    v_add_f32_dpp v147, v147, v147 quad_perm:[2,3,0,1] row_mask:0xf bank_mask:0xf
    v_add_f32_dpp v142, v142, v142 row_half_mirror row_mask:0xf bank_mask:0xf
    v_add_f32_dpp v143, v143, v143 row_half_mirror row_mask:0xf bank_mask:0xf
    v_add_f32_dpp v144, v144, v144 row_half_mirror row_mask:0xf bank_mask:0xf
    v_add_f32_dpp v145, v145, v145 row_half_mirror row_mask:0xf bank_mask:0xf
    v_add_f32_dpp v146, v146, v146 row_half_mirror row_mask:0xf bank_mask:0xf
    v_add_f32_dpp v147, v147, v147 row_half_mirror row_mask:0xf bank_mask:0xf
    v_add_f32_dpp v142, v142, v142 row_mirror row_mask:0xf bank_mask:0xf
    v_add_f32_dpp v143, v143, v143 row_mirror row_mask:0xf bank_mask:0xf
    v_add_f32_dpp v144, v144, v144 row_mirror row_mask:0xf bank_mask:0xf
    v_add_f32_dpp v145, v145, v145 row_mirror row_mask:0xf bank_mask:0xf
    v_add_f32_dpp v146, v146, v146 row_mirror row_mask:0xf bank_mask:0xf
    v_add_f32_dpp v147, v147, v147 row_mirror row_mask:0xf bank_mask:0xf
    v_mov_b32 v148, v142
    v_mov_b32 v149, v143
    v_mov_b32 v150, v144
    v_mov_b32 v151, v145
    v_mov_b32 v152, v146
    v_mov_b32 v153, v147
    v_permlane16_swap_b32 v142, v148
    v_permlane16_swap_b32 v143, v149
    v_permlane16_swap_b32 v144, v150
    v_permlane16_swap_b32 v145, v151
    v_permlane16_swap_b32 v146, v152
    v_permlane16_swap_b32 v147, v153
    v_add_f32 v142, v142, v148
    v_add_f32 v143, v143, v149
    v_add_f32 v144, v144, v150
    v_add_f32 v145, v145, v151
    v_add_f32 v146, v146, v152
    v_add_f32 v147, v147, v153
    v_mov_b32 v148, v142
    v_mov_b32 v149, v143
    v_mov_b32 v150, v144
    v_mov_b32 v151, v145
    v_mov_b32 v152, v146
    v_mov_b32 v153, v147
    v_permlane32_swap_b32 v142, v148
    v_permlane32_swap_b32 v143, v149
    v_permlane32_swap_b32 v144, v150
    v_permlane32_swap_b32 v145, v151
    v_permlane32_swap_b32 v146, v152
    v_permlane32_swap_b32 v147, v153
    v_add_f32 v142, v142, v148
    v_add_f32 v143, v143, v149
    v_add_f32 v144, v144, v150
    v_add_f32 v145, v145, v151
    v_add_f32 v146, v146, v152
    v_add_f32 v147, v147, v153
    v_mul_f32 v160, s55, v142
    v_mul_f32 v162, s55, v144
    v_mul_f32 v164, s55, v146
    v_mul_f32 v166, s55, v143
    v_mul_f32 v168, s55, v145
    v_mul_f32 v170, s55, v147
    v_fma_f32 v166, -v160, v160, v166
    v_fma_f32 v168, -v162, v162, v168
    v_fma_f32 v170, -v164, v164, v170
    v_max_f32 v166, 0, v166
    v_max_f32 v168, 0, v168
    v_max_f32 v170, 0, v170
    v_add_f32 v148, s56, v166
    v_add_f32 v149, s56, v168
    v_add_f32 v150, s56, v170
    v_rsq_f32 v155, v148
    v_rsq_f32 v157, v149
    v_rsq_f32 v159, v150
    v_add_f32 v154, s64, v160
    v_add_f32 v156, s66, v162
    v_add_f32 v158, s76, v164
    v_mul_f32 v166, v166, v155
    v_mul_f32 v168, v168, v157
    v_mul_f32 v170, v170, v159
    v_fma_f32 v148, v166, v155, s56
    v_fma_f32 v149, v168, v157, s56
    v_fma_f32 v150, v170, v159, s56
    v_rsq_f32 v148, v148
    v_rsq_f32 v149, v149
    v_rsq_f32 v150, v150
    v_mul_f32 v166, v148, v155
    v_mul_f32 v168, v149, v157
    v_mul_f32 v170, v150, v159
    v_mul_f32 v160, v160, v166
    v_mul_f32 v162, v162, v168
    v_mul_f32 v164, v164, v170
    v_pk_fma_f32 v[112:113], v[112:113], v[166:167], v[160:161] op_sel_hi:[1,0,0] neg_lo:[0,0,1] neg_hi:[0,0,1]
    v_pk_fma_f32 v[122:123], v[122:123], v[168:169], v[162:163] op_sel_hi:[1,0,0] neg_lo:[0,0,1] neg_hi:[0,0,1]
    v_pk_fma_f32 v[132:133], v[132:133], v[170:171], v[164:165] op_sel_hi:[1,0,0] neg_lo:[0,0,1] neg_hi:[0,0,1]
    v_pk_fma_f32 v[114:115], v[114:115], v[166:167], v[160:161] op_sel_hi:[1,0,0] neg_lo:[0,0,1] neg_hi:[0,0,1]
    v_pk_fma_f32 v[124:125], v[124:125], v[168:169], v[162:163] op_sel_hi:[1,0,0] neg_lo:[0,0,1] neg_hi:[0,0,1]
    v_pk_fma_f32 v[134:135], v[134:135], v[170:171], v[164:165] op_sel_hi:[1,0,0] neg_lo:[0,0,1] neg_hi:[0,0,1]
    v_pk_fma_f32 v[116:117], v[116:117], v[166:167], v[160:161] op_sel_hi:[1,0,0] neg_lo:[0,0,1] neg_hi:[0,0,1]
    v_pk_fma_f32 v[126:127], v[126:127], v[168:169], v[162:163] op_sel_hi:[1,0,0] neg_lo:[0,0,1] neg_hi:[0,0,1]
    v_pk_fma_f32 v[136:137], v[136:137], v[170:171], v[164:165] op_sel_hi:[1,0,0] neg_lo:[0,0,1] neg_hi:[0,0,1]
    v_pk_fma_f32 v[118:119], v[118:119], v[166:167], v[160:161] op_sel_hi:[1,0,0] neg_lo:[0,0,1] neg_hi:[0,0,1]
    v_pk_fma_f32 v[128:129], v[128:129], v[168:169], v[162:163] op_sel_hi:[1,0,0] neg_lo:[0,0,1] neg_hi:[0,0,1]
    v_pk_fma_f32 v[138:139], v[138:139], v[170:171], v[164:165] op_sel_hi:[1,0,0] neg_lo:[0,0,1] neg_hi:[0,0,1]
    v_pk_fma_f32 v[120:121], v[120:121], v[166:167], v[160:161] op_sel_hi:[1,0,0] neg_lo:[0,0,1] neg_hi:[0,0,1]
    v_pk_fma_f32 v[130:131], v[130:131], v[168:169], v[162:163] op_sel_hi:[1,0,0] neg_lo:[0,0,1] neg_hi:[0,0,1]
    v_pk_fma_f32 v[140:141], v[140:141], v[170:171], v[164:165] op_sel_hi:[1,0,0] neg_lo:[0,0,1] neg_hi:[0,0,1]
    v_cvt_pk_bf16_f32 v96, v112, v113
    v_cvt_pk_bf16_f32 v97, v114, v115
    v_cvt_pk_bf16_f32 v98, v116, v117
    v_cvt_pk_bf16_f32 v99, v118, v119
    v_cvt_pk_bf16_f32 v100, v120, v121
    ds_write_b32 v2, v96 offset:0
    ds_write_b32 v2, v97 offset:256
    ds_write_b32 v2, v98 offset:512
    ds_write_b32 v2, v99 offset:768
    ds_write_b32 v2, v100 offset:1024
    v_cvt_pk_bf16_f32 v101, v122, v123
    v_cvt_pk_bf16_f32 v102, v124, v125
    v_cvt_pk_bf16_f32 v103, v126, v127
    v_cvt_pk_bf16_f32 v104, v128, v129
    v_cvt_pk_bf16_f32 v105, v130, v131
    ds_write_b32 v2, v101 offset:10368
    ds_write_b32 v2, v102 offset:10624
    ds_write_b32 v2, v103 offset:10880
    ds_write_b32 v2, v104 offset:11136
    ds_write_b32 v2, v105 offset:11392
    v_cvt_pk_bf16_f32 v106, v132, v133
    v_cvt_pk_bf16_f32 v107, v134, v135
    v_cvt_pk_bf16_f32 v108, v136, v137
    v_cvt_pk_bf16_f32 v109, v138, v139
    v_cvt_pk_bf16_f32 v110, v140, v141
    ds_write_b32 v2, v106 offset:20736
    ds_write_b32 v2, v107 offset:20992
    ds_write_b32 v2, v108 offset:21248
    ds_write_b32 v2, v109 offset:21504
    ds_write_b32 v2, v110 offset:21760
    ds_write_b64 v13, v[154:155] offset:0
    ds_write_b64 v13, v[156:157] offset:64
    ds_write_b64 v13, v[158:159] offset:128
    s_waitcnt lgkmcnt(0)
    s_barrier
    s_cmp_ge_u32 s44, 4
    s_cbranch_scc0 L_B3
    s_setprio 2
    ds_read_b64_tr_b16 v[112:113], v172 offset:0
    ds_read_b64_tr_b16 v[114:115], v172 offset:5184
    ds_read_b64_tr_b16 v[116:117], v173 offset:0
    ds_read_b64_tr_b16 v[118:119], v173 offset:5184
    ds_read_b64_tr_b16 v[120:121], v174 offset:0
    ds_read_b64_tr_b16 v[122:123], v174 offset:5184
    ds_read_b64_tr_b16 v[124:125], v175 offset:0
    ds_read_b64_tr_b16 v[126:127], v175 offset:5184
    ds_read_b64_tr_b16 v[128:129], v176 offset:0
    ds_read_b64_tr_b16 v[130:131], v176 offset:5184
    ds_read_b64_tr_b16 v[132:133], v177 offset:0
    ds_read_b64_tr_b16 v[134:135], v177 offset:5184
    s_waitcnt lgkmcnt(10)
    buffer_store_dwordx4 v[112:115], v12, s[12:15], s80 offen sc1
    s_waitcnt lgkmcnt(8)
    buffer_store_dwordx4 v[116:119], v12, s[12:15], s81 offen sc1
    ds_read_b64_tr_b16 v[136:137], v178 offset:0
    ds_read_b64_tr_b16 v[138:139], v178 offset:5184
    ds_read_b64_tr_b16 v[140:141], v179 offset:0
    ds_read_b64_tr_b16 v[142:143], v179 offset:5184
    v_min_u32 v7, 23, v1
    v_lshlrev_b32 v7, 3, v7
    v_add_u32 v7, 160256, v7
    ds_read_b64 v[108:109], v7
    s_waitcnt lgkmcnt(11)
    buffer_store_dwordx4 v[120:123], v12, s[12:15], s82 offen sc1
    s_waitcnt lgkmcnt(9)
    buffer_store_dwordx4 v[124:127], v12, s[12:15], s83 offen sc1
    s_waitcnt lgkmcnt(7)
    buffer_store_dwordx4 v[128:131], v12, s[12:15], s84 offen sc1
    s_waitcnt lgkmcnt(5)
    buffer_store_dwordx4 v[132:135], v12, s[12:15], s85 offen sc1
    s_waitcnt lgkmcnt(3)
    buffer_store_dwordx4 v[136:139], v12, s[12:15], s86 offen sc1
    s_waitcnt lgkmcnt(1)
    buffer_store_dwordx4 v[140:143], v12, s[12:15], s87 offen sc1
    v_mov_b32 v144, 0
    v_mov_b32 v145, 0
    v_mov_b32 v146, 0
    v_mov_b32 v147, 0
    buffer_store_dwordx4 v[144:147], v91, s[12:15], s89 offen sc1
    v_mov_b32 v254, 0
    buffer_load_dwordx2 v[250:251], v254, s[40:43], 0 offen sc1
    s_waitcnt lgkmcnt(0)
    s_barrier
    s_waitcnt vmcnt(0)
    v_mov_b32 v254, 0
    s_mov_b32 s97, 400000
nl_25:
    v_readfirstlane_b32 s50, v250
    v_readfirstlane_b32 s51, v251
    s_cmp_lg_u32 s50, 0
    s_cbranch_scc1 ok_26
    s_sleep 2
    buffer_load_dwordx2 v[250:251], v254, s[40:43], 0 offen sc1
    s_waitcnt vmcnt(0)
    s_sub_u32 s97, s97, 1
    s_cbranch_scc0 nl_25
    v_mov_b32 v14, 24
    v_mov_b32 v15, 226
    buffer_store_dword v15, v14, s[40:43], 0 offen
ok_26:
    v_mov_b32 v110, s50
    v_mov_b32 v111, s51
    s_mov_b32 exec_lo, 0xffffff
    s_mov_b32 exec_hi, 0
    buffer_store_dwordx4 v[108:111], v91, s[12:15], s88 offen sc1
    s_mov_b64 exec, -1
    v_mov_b32 v10, 160464
    v_mov_b32 v11, 1
    s_mov_b64 exec, 1
    ds_add_rtn_u32 v12, v10, v11
    s_mov_b64 exec, -1
    s_waitcnt lgkmcnt(0)
    v_readfirstlane_b32 s100, v12
    s_cmp_eq_u32 s100, 3
    s_cbranch_scc0 L_27
    s_lshr_b32 s57, s45, 1
    s_lshl_b32 s57, s57, 5
    s_add_u32 s57, s57, s49
    s_lshl_b32 s57, s57, 2
    s_add_u32 s57, s57, 36864
    v_mov_b32 v4, s50
    v_lshlrev_b32 v6, 9, v1
    s_mov_b32 exec_hi, 0
    buffer_store_dword v4, v6, s[12:15], s57 offen sc1
    s_mov_b32 exec_hi, -1
L_27:
    s_branch L_YB
L_B3:
    s_barrier
L_B2:
    buffer_load_dwordx2 v[208:209], v89, s[32:35], 0 offen offset:0
    buffer_load_dwordx2 v[210:211], v89, s[32:35], 0 offen offset:16
    buffer_load_dwordx2 v[212:213], v89, s[32:35], 0 offen offset:32
    buffer_load_dwordx2 v[214:215], v89, s[32:35], 0 offen offset:48
    buffer_load_dwordx2 v[216:217], v89, s[32:35], 0 offen offset:64
    buffer_load_dwordx2 v[218:219], v89, s[32:35], 0 offen offset:80
    buffer_load_dwordx2 v[220:221], v89, s[32:35], 0 offen offset:96
    buffer_load_dwordx2 v[222:223], v89, s[32:35], 0 offen offset:112
    s_add_u32 m0, s68, 16384
    s_nop 0
    buffer_load_dwordx4 v80, s[16:19], s69 offen lds
    buffer_load_dwordx4 v81, s[16:19], s69 offen offset:1024 lds
    s_add_u32 s69, s69, 221184
    s_add_u32 m0, s68, 24576
    s_nop 0
    buffer_load_dwordx4 v80, s[16:19], s69 offen lds
    buffer_load_dwordx4 v81, s[16:19], s69 offen offset:1024 lds
    s_add_u32 s69, s69, 221184
    s_add_u32 m0, s68, 32768
    s_nop 0
    buffer_load_dwordx4 v80, s[16:19], s69 offen lds
    buffer_load_dwordx4 v81, s[16:19], s69 offen offset:1024 lds
    s_add_u32 s69, s69, 221184
    s_add_u32 m0, s68, 40960
    s_nop 0
    buffer_load_dwordx4 v80, s[16:19], s69 offen lds
    buffer_load_dwordx4 v81, s[16:19], s69 offen offset:1024 lds
    s_add_u32 s69, s69, 221184
    s_add_u32 m0, s68, 49152
    s_nop 0
    buffer_load_dwordx4 v80, s[16:19], s69 offen lds
    buffer_load_dwordx4 v81, s[16:19], s69 offen offset:1024 lds
    s_add_u32 s69, s69, 221184
    s_add_u32 m0, s68, 57344
    s_nop 0
    buffer_load_dwordx4 v80, s[16:19], s69 offen lds
    buffer_load_dwordx4 v81, s[16:19], s69 offen offset:1024 lds
    s_add_u32 s69, s69, 221184
    s_add_u32 m0, s68, 65536
    s_nop 0
    buffer_load_dwordx4 v80, s[16:19], s69 offen lds
    buffer_load_dwordx4 v81, s[16:19], s69 offen offset:1024 lds
    s_add_u32 s69, s69, 221184
    s_add_u32 m0, s68, 73728
    s_nop 0
    buffer_load_dwordx4 v80, s[16:19], s69 offen lds
    buffer_load_dwordx4 v81, s[16:19], s69 offen offset:1024 lds
    s_add_u32 s69, s69, 221184
    s_add_u32 m0, s68, 81920
    s_nop 0
    buffer_load_dwordx4 v80, s[16:19], s69 offen lds
    buffer_load_dwordx4 v81, s[16:19], s69 offen offset:1024 lds
    s_add_u32 s69, s69, 221184
    s_add_u32 m0, s68, 90112
    s_nop 0
    buffer_load_dwordx4 v80, s[16:19], s69 offen lds
    buffer_load_dwordx4 v81, s[16:19], s69 offen offset:1024 lds
    s_add_u32 s69, s69, 221184
    s_add_u32 m0, s68, 98304
    s_nop 0
    buffer_load_dwordx4 v80, s[16:19], s69 offen lds
    buffer_load_dwordx4 v81, s[16:19], s69 offen offset:1024 lds
    s_add_u32 s69, s69, 221184
    s_add_u32 m0, s68, 106496
    s_nop 0
    buffer_load_dwordx4 v80, s[16:19], s69 offen lds
    buffer_load_dwordx4 v81, s[16:19], s69 offen offset:1024 lds
    s_add_u32 s69, s69, 221184
    s_add_u32 m0, s68, 114688
    s_nop 0
    buffer_load_dwordx4 v80, s[16:19], s69 offen lds
    buffer_load_dwordx4 v81, s[16:19], s69 offen offset:1024 lds
    s_add_u32 s69, s69, 221184
    s_add_u32 m0, s68, 122880
    s_nop 0
    buffer_load_dwordx4 v80, s[16:19], s69 offen lds
    buffer_load_dwordx4 v81, s[16:19], s69 offen offset:1024 lds
    s_add_u32 s69, s69, 221184
    s_add_u32 m0, s68, 131072
    s_nop 0
    buffer_load_dwordx4 v80, s[16:19], s69 offen lds
    buffer_load_dwordx4 v81, s[16:19], s69 offen offset:1024 lds
    s_add_u32 s69, s69, 221184
    s_add_u32 m0, s68, 139264
    s_nop 0
    buffer_load_dwordx4 v80, s[16:19], s69 offen lds
    buffer_load_dwordx4 v81, s[16:19], s69 offen offset:1024 lds
    s_add_u32 s69, s69, 221184
    s_waitcnt vmcnt(28)
    s_barrier
    buffer_load_dwordx4 v[96:99], v91, s[12:15], s70 offen offset:0 sc1
    buffer_load_dwordx4 v[100:103], v91, s[12:15], s70 offen offset:1024 sc1
    buffer_load_dwordx4 v[104:107], v91, s[12:15], s70 offen offset:2048 sc1
    buffer_load_dwordx4 v[108:111], v91, s[12:15], s70 offen offset:3072 sc1
    s_add_u32 s70, s70, 4096
    buffer_load_dwordx4 v[112:115], v91, s[12:15], s70 offen offset:0 sc1
    buffer_load_dwordx4 v[116:119], v91, s[12:15], s70 offen offset:1024 sc1
    buffer_load_dwordx4 v[120:123], v91, s[12:15], s70 offen offset:2048 sc1
    buffer_load_dwordx4 v[124:127], v91, s[12:15], s70 offen offset:3072 sc1
    s_add_u32 s70, s70, 4096
    buffer_load_dwordx4 v[128:131], v91, s[12:15], s70 offen offset:0 sc1
    buffer_load_dwordx4 v[132:135], v91, s[12:15], s70 offen offset:1024 sc1
    buffer_load_dwordx4 v[136:139], v91, s[12:15], s70 offen offset:2048 sc1
    buffer_load_dwordx4 v[140:143], v91, s[12:15], s70 offen offset:3072 sc1
    s_add_u32 s70, s70, 4096
    buffer_load_dwordx4 v[144:147], v91, s[12:15], s70 offen offset:0 sc1
    buffer_load_dwordx4 v[148:151], v91, s[12:15], s70 offen offset:1024 sc1
    buffer_load_dwordx4 v[152:155], v91, s[12:15], s70 offen offset:2048 sc1
    ds_read_b64_tr_b16 v[48:49], v82 offset:0
    ds_read_b64_tr_b16 v[50:51], v82 offset:512
    ds_read_b64_tr_b16 v[52:53], v83 offset:0
    ds_read_b64_tr_b16 v[54:55], v83 offset:512
    ds_read_b64_tr_b16 v[56:57], v82 offset:2048
    ds_read_b64_tr_b16 v[58:59], v82 offset:2560
    ds_read_b64_tr_b16 v[60:61], v83 offset:2048
    ds_read_b64_tr_b16 v[62:63], v83 offset:2560
    v_lshlrev_b32 v176, 16, v208
    v_and_b32 v177, 0xffff0000, v208
    v_lshlrev_b32 v178, 16, v209
    v_and_b32 v179, 0xffff0000, v209
    v_lshlrev_b32 v180, 16, v210
    v_and_b32 v181, 0xffff0000, v210
    v_lshlrev_b32 v182, 16, v211
    v_and_b32 v183, 0xffff0000, v211
    v_lshlrev_b32 v184, 16, v212
    v_and_b32 v185, 0xffff0000, v212
    v_lshlrev_b32 v186, 16, v213
    v_and_b32 v187, 0xffff0000, v213
    v_lshlrev_b32 v188, 16, v214
    v_and_b32 v189, 0xffff0000, v214
    v_lshlrev_b32 v190, 16, v215
    v_and_b32 v191, 0xffff0000, v215
    v_lshlrev_b32 v192, 16, v216
    v_and_b32 v193, 0xffff0000, v216
    v_lshlrev_b32 v194, 16, v217
    v_and_b32 v195, 0xffff0000, v217
    v_lshlrev_b32 v196, 16, v218
    v_and_b32 v197, 0xffff0000, v218
    v_lshlrev_b32 v198, 16, v219
    v_and_b32 v199, 0xffff0000, v219
    v_lshlrev_b32 v200, 16, v220
    v_and_b32 v201, 0xffff0000, v220
    v_lshlrev_b32 v202, 16, v221
    v_and_b32 v203, 0xffff0000, v221
    v_lshlrev_b32 v204, 16, v222
    v_and_b32 v205, 0xffff0000, v222
    v_lshlrev_b32 v206, 16, v223
    v_and_b32 v207, 0xffff0000, v223
    s_waitcnt vmcnt(14) lgkmcnt(4)
    v_mfma_f32_32x32x16_bf16 v[176:191], v[48:51], v[96:99], v[176:191]
    ds_read_b64_tr_b16 v[64:65], v82 offset:4096
    ds_read_b64_tr_b16 v[66:67], v82 offset:4608
    buffer_load_dwordx4 v[156:159], v91, s[12:15], s70 offen offset:3072 sc1
    s_add_u32 s70, s70, 4096
    v_mfma_f32_32x32x16_bf16 v[192:207], v[52:55], v[96:99], v[192:207]
    ds_read_b64_tr_b16 v[68:69], v83 offset:4096
    ds_read_b64_tr_b16 v[70:71], v83 offset:4608
    s_waitcnt vmcnt(14) lgkmcnt(4)
    v_mfma_f32_32x32x16_bf16 v[176:191], v[56:59], v[100:103], v[176:191]
    ds_read_b64_tr_b16 v[48:49], v82 offset:6144
    ds_read_b64_tr_b16 v[50:51], v82 offset:6656
    buffer_load_dwordx4 v[96:99], v91, s[12:15], s70 offen offset:0 sc1
    v_mfma_f32_32x32x16_bf16 v[192:207], v[60:63], v[100:103], v[192:207]
    ds_read_b64_tr_b16 v[52:53], v83 offset:6144
    ds_read_b64_tr_b16 v[54:55], v83 offset:6656
    s_waitcnt vmcnt(14) lgkmcnt(4)
    v_mfma_f32_32x32x16_bf16 v[176:191], v[64:67], v[104:107], v[176:191]
    ds_read_b64_tr_b16 v[56:57], v82 offset:8192
    ds_read_b64_tr_b16 v[58:59], v82 offset:8704
    buffer_load_dwordx4 v[100:103], v91, s[12:15], s70 offen offset:1024 sc1
    v_mfma_f32_32x32x16_bf16 v[192:207], v[68:71], v[104:107], v[192:207]
    ds_read_b64_tr_b16 v[60:61], v83 offset:8192
    ds_read_b64_tr_b16 v[62:63], v83 offset:8704
    s_waitcnt vmcnt(14) lgkmcnt(4)
    v_mfma_f32_32x32x16_bf16 v[176:191], v[48:51], v[108:111], v[176:191]
    ds_read_b64_tr_b16 v[64:65], v82 offset:10240
    ds_read_b64_tr_b16 v[66:67], v82 offset:10752
    buffer_load_dwordx4 v[104:107], v91, s[12:15], s70 offen offset:2048 sc1
    v_mfma_f32_32x32x16_bf16 v[192:207], v[52:55], v[108:111], v[192:207]
    ds_read_b64_tr_b16 v[68:69], v83 offset:10240
    ds_read_b64_tr_b16 v[70:71], v83 offset:10752
    s_waitcnt vmcnt(14) lgkmcnt(4)
    v_mfma_f32_32x32x16_bf16 v[176:191], v[56:59], v[112:115], v[176:191]
    ds_read_b64_tr_b16 v[48:49], v82 offset:12288
    ds_read_b64_tr_b16 v[50:51], v82 offset:12800
    buffer_load_dwordx4 v[108:111], v91, s[12:15], s70 offen offset:3072 sc1
    s_add_u32 s70, s70, 4096
    v_mfma_f32_32x32x16_bf16 v[192:207], v[60:63], v[112:115], v[192:207]
    ds_read_b64_tr_b16 v[52:53], v83 offset:12288
    ds_read_b64_tr_b16 v[54:55], v83 offset:12800
    s_waitcnt vmcnt(14) lgkmcnt(4)
    v_mfma_f32_32x32x16_bf16 v[176:191], v[64:67], v[116:119], v[176:191]
    ds_read_b64_tr_b16 v[56:57], v82 offset:14336
    ds_read_b64_tr_b16 v[58:59], v82 offset:14848
    buffer_load_dwordx4 v[112:115], v91, s[12:15], s70 offen offset:0 sc1
    v_mfma_f32_32x32x16_bf16 v[192:207], v[68:71], v[116:119], v[192:207]
    ds_read_b64_tr_b16 v[60:61], v83 offset:14336
    ds_read_b64_tr_b16 v[62:63], v83 offset:14848
    s_waitcnt lgkmcnt(0)
    s_barrier
    s_waitcnt vmcnt(14)
    v_mfma_f32_32x32x16_bf16 v[176:191], v[48:51], v[120:123], v[176:191]
    s_add_u32 m0, s68, 0
    ds_read_b64_tr_b16 v[64:65], v82 offset:16384
    ds_read_b64_tr_b16 v[66:67], v82 offset:16896
    buffer_load_dwordx4 v[116:119], v91, s[12:15], s70 offen offset:1024 sc1
    v_mfma_f32_32x32x16_bf16 v[192:207], v[52:55], v[120:123], v[192:207]
    ds_read_b64_tr_b16 v[68:69], v83 offset:16384
    ds_read_b64_tr_b16 v[70:71], v83 offset:16896
    buffer_load_dwordx4 v80, s[16:19], s69 offen lds
    s_waitcnt vmcnt(15)
    v_mfma_f32_32x32x16_bf16 v[176:191], v[56:59], v[124:127], v[176:191]
    ds_read_b64_tr_b16 v[48:49], v82 offset:18432
    ds_read_b64_tr_b16 v[50:51], v82 offset:18944
    buffer_load_dwordx4 v[120:123], v91, s[12:15], s70 offen offset:2048 sc1
    v_mfma_f32_32x32x16_bf16 v[192:207], v[60:63], v[124:127], v[192:207]
    ds_read_b64_tr_b16 v[52:53], v83 offset:18432
    ds_read_b64_tr_b16 v[54:55], v83 offset:18944
    buffer_load_dwordx4 v81, s[16:19], s69 offen offset:1024 lds
    s_add_u32 s69, s69, 221184
    s_waitcnt vmcnt(16) lgkmcnt(4)
    v_mfma_f32_32x32x16_bf16 v[176:191], v[64:67], v[128:131], v[176:191]
    s_add_u32 m0, s68, 8192
    ds_read_b64_tr_b16 v[56:57], v82 offset:20480
    ds_read_b64_tr_b16 v[58:59], v82 offset:20992
    buffer_load_dwordx4 v[124:127], v91, s[12:15], s70 offen offset:3072 sc1
    s_add_u32 s70, s70, 4096
    v_mfma_f32_32x32x16_bf16 v[192:207], v[68:71], v[128:131], v[192:207]
    ds_read_b64_tr_b16 v[60:61], v83 offset:20480
    ds_read_b64_tr_b16 v[62:63], v83 offset:20992
    buffer_load_dwordx4 v80, s[16:19], s69 offen lds
    s_waitcnt vmcnt(17) lgkmcnt(4)
    v_mfma_f32_32x32x16_bf16 v[176:191], v[48:51], v[132:135], v[176:191]
    ds_read_b64_tr_b16 v[64:65], v82 offset:22528
    ds_read_b64_tr_b16 v[66:67], v82 offset:23040
    buffer_load_dwordx4 v[128:131], v91, s[12:15], s70 offen offset:0 sc1
    v_mfma_f32_32x32x16_bf16 v[192:207], v[52:55], v[132:135], v[192:207]
    ds_read_b64_tr_b16 v[68:69], v83 offset:22528
    ds_read_b64_tr_b16 v[70:71], v83 offset:23040
    buffer_load_dwordx4 v81, s[16:19], s69 offen offset:1024 lds
    s_add_u32 s69, s69, 221184
    s_waitcnt vmcnt(18) lgkmcnt(4)
    v_mfma_f32_32x32x16_bf16 v[176:191], v[56:59], v[136:139], v[176:191]
    ds_read_b64_tr_b16 v[48:49], v82 offset:24576
    ds_read_b64_tr_b16 v[50:51], v82 offset:25088
    buffer_load_dwordx4 v[132:135], v91, s[12:15], s70 offen offset:1024 sc1
    v_mfma_f32_32x32x16_bf16 v[192:207], v[60:63], v[136:139], v[192:207]
    ds_read_b64_tr_b16 v[52:53], v83 offset:24576
    ds_read_b64_tr_b16 v[54:55], v83 offset:25088
    s_waitcnt vmcnt(18) lgkmcnt(4)
    v_mfma_f32_32x32x16_bf16 v[176:191], v[64:67], v[140:143], v[176:191]
    ds_read_b64_tr_b16 v[56:57], v82 offset:26624
    ds_read_b64_tr_b16 v[58:59], v82 offset:27136
    buffer_load_dwordx4 v[136:139], v91, s[12:15], s70 offen offset:2048 sc1
    v_mfma_f32_32x32x16_bf16 v[192:207], v[68:71], v[140:143], v[192:207]
    ds_read_b64_tr_b16 v[60:61], v83 offset:26624
    ds_read_b64_tr_b16 v[62:63], v83 offset:27136
    s_waitcnt vmcnt(18) lgkmcnt(4)
    v_mfma_f32_32x32x16_bf16 v[176:191], v[48:51], v[144:147], v[176:191]
    ds_read_b64_tr_b16 v[64:65], v82 offset:28672
    ds_read_b64_tr_b16 v[66:67], v82 offset:29184
    buffer_load_dwordx4 v[140:143], v91, s[12:15], s70 offen offset:3072 sc1
    s_add_u32 s70, s70, 4096
    v_mfma_f32_32x32x16_bf16 v[192:207], v[52:55], v[144:147], v[192:207]
    ds_read_b64_tr_b16 v[68:69], v83 offset:28672
    ds_read_b64_tr_b16 v[70:71], v83 offset:29184
    s_waitcnt vmcnt(18) lgkmcnt(4)
    v_mfma_f32_32x32x16_bf16 v[176:191], v[56:59], v[148:151], v[176:191]
    ds_read_b64_tr_b16 v[48:49], v82 offset:30720
    ds_read_b64_tr_b16 v[50:51], v82 offset:31232
    buffer_load_dwordx4 v[144:147], v91, s[12:15], s70 offen offset:0 sc1
    v_mfma_f32_32x32x16_bf16 v[192:207], v[60:63], v[148:151], v[192:207]
    ds_read_b64_tr_b16 v[52:53], v83 offset:30720
    ds_read_b64_tr_b16 v[54:55], v83 offset:31232
    s_waitcnt lgkmcnt(0)
    s_barrier
    s_waitcnt vmcnt(18)
    v_mfma_f32_32x32x16_bf16 v[176:191], v[64:67], v[152:155], v[176:191]
    s_add_u32 m0, s68, 16384
    ds_read_b64_tr_b16 v[56:57], v82 offset:32768
    ds_read_b64_tr_b16 v[58:59], v82 offset:33280
    buffer_load_dwordx4 v[148:151], v91, s[12:15], s70 offen offset:1024 sc1
    v_mfma_f32_32x32x16_bf16 v[192:207], v[68:71], v[152:155], v[192:207]
    ds_read_b64_tr_b16 v[60:61], v83 offset:32768
    ds_read_b64_tr_b16 v[62:63], v83 offset:33280
    buffer_load_dwordx4 v80, s[16:19], s69 offen lds
    s_waitcnt vmcnt(19)
    v_mfma_f32_32x32x16_bf16 v[176:191], v[48:51], v[156:159], v[176:191]
    ds_read_b64_tr_b16 v[64:65], v82 offset:34816
    ds_read_b64_tr_b16 v[66:67], v82 offset:35328
    buffer_load_dwordx4 v[152:155], v91, s[12:15], s70 offen offset:2048 sc1
    v_mfma_f32_32x32x16_bf16 v[192:207], v[52:55], v[156:159], v[192:207]
    ds_read_b64_tr_b16 v[68:69], v83 offset:34816
    ds_read_b64_tr_b16 v[70:71], v83 offset:35328
    buffer_load_dwordx4 v81, s[16:19], s69 offen offset:1024 lds
    s_add_u32 s69, s69, 221184
    s_waitcnt vmcnt(20) lgkmcnt(4)
    v_mfma_f32_32x32x16_bf16 v[176:191], v[56:59], v[96:99], v[176:191]
    s_add_u32 m0, s68, 24576
    ds_read_b64_tr_b16 v[48:49], v82 offset:36864
    ds_read_b64_tr_b16 v[50:51], v82 offset:37376
    buffer_load_dwordx4 v[156:159], v91, s[12:15], s70 offen offset:3072 sc1
    s_add_u32 s70, s70, 4096
    v_mfma_f32_32x32x16_bf16 v[192:207], v[60:63], v[96:99], v[192:207]
    ds_read_b64_tr_b16 v[52:53], v83 offset:36864
    ds_read_b64_tr_b16 v[54:55], v83 offset:37376
    buffer_load_dwordx4 v80, s[16:19], s69 offen lds
    s_waitcnt vmcnt(21) lgkmcnt(4)
    v_mfma_f32_32x32x16_bf16 v[176:191], v[64:67], v[100:103], v[176:191]
    ds_read_b64_tr_b16 v[56:57], v82 offset:38912
    ds_read_b64_tr_b16 v[58:59], v82 offset:39424
    buffer_load_dwordx4 v[96:99], v91, s[12:15], s70 offen offset:0 sc1
    v_mfma_f32_32x32x16_bf16 v[192:207], v[68:71], v[100:103], v[192:207]
    ds_read_b64_tr_b16 v[60:61], v83 offset:38912
    ds_read_b64_tr_b16 v[62:63], v83 offset:39424
    buffer_load_dwordx4 v81, s[16:19], s69 offen offset:1024 lds
    s_add_u32 s69, s69, 221184
    s_waitcnt vmcnt(22) lgkmcnt(4)
    v_mfma_f32_32x32x16_bf16 v[176:191], v[48:51], v[104:107], v[176:191]
    ds_read_b64_tr_b16 v[64:65], v82 offset:40960
    ds_read_b64_tr_b16 v[66:67], v82 offset:41472
    buffer_load_dwordx4 v[100:103], v91, s[12:15], s70 offen offset:1024 sc1
    v_mfma_f32_32x32x16_bf16 v[192:207], v[52:55], v[104:107], v[192:207]
    ds_read_b64_tr_b16 v[68:69], v83 offset:40960
    ds_read_b64_tr_b16 v[70:71], v83 offset:41472
    s_waitcnt vmcnt(22) lgkmcnt(4)
    v_mfma_f32_32x32x16_bf16 v[176:191], v[56:59], v[108:111], v[176:191]
    ds_read_b64_tr_b16 v[48:49], v82 offset:43008
    ds_read_b64_tr_b16 v[50:51], v82 offset:43520
    buffer_load_dwordx4 v[104:107], v91, s[12:15], s70 offen offset:2048 sc1
    v_mfma_f32_32x32x16_bf16 v[192:207], v[60:63], v[108:111], v[192:207]
    ds_read_b64_tr_b16 v[52:53], v83 offset:43008
    ds_read_b64_tr_b16 v[54:55], v83 offset:43520
    s_waitcnt vmcnt(22) lgkmcnt(4)
    v_mfma_f32_32x32x16_bf16 v[176:191], v[64:67], v[112:115], v[176:191]
    ds_read_b64_tr_b16 v[56:57], v82 offset:45056
    ds_read_b64_tr_b16 v[58:59], v82 offset:45568
    buffer_load_dwordx4 v[108:111], v91, s[12:15], s70 offen offset:3072 sc1
    s_add_u32 s70, s70, 4096
    v_mfma_f32_32x32x16_bf16 v[192:207], v[68:71], v[112:115], v[192:207]
    ds_read_b64_tr_b16 v[60:61], v83 offset:45056
    ds_read_b64_tr_b16 v[62:63], v83 offset:45568
    s_waitcnt vmcnt(22) lgkmcnt(4)
    v_mfma_f32_32x32x16_bf16 v[176:191], v[48:51], v[116:119], v[176:191]
    ds_read_b64_tr_b16 v[64:65], v82 offset:47104
    ds_read_b64_tr_b16 v[66:67], v82 offset:47616
    buffer_load_dwordx4 v[112:115], v91, s[12:15], s70 offen offset:0 sc1
    v_mfma_f32_32x32x16_bf16 v[192:207], v[52:55], v[116:119], v[192:207]
    ds_read_b64_tr_b16 v[68:69], v83 offset:47104
    ds_read_b64_tr_b16 v[70:71], v83 offset:47616
    s_waitcnt lgkmcnt(0)
    s_barrier
    s_waitcnt vmcnt(21)
    v_mfma_f32_32x32x16_bf16 v[176:191], v[56:59], v[120:123], v[176:191]
    s_add_u32 m0, s68, 32768
    ds_read_b64_tr_b16 v[48:49], v82 offset:49152
    ds_read_b64_tr_b16 v[50:51], v82 offset:49664
    buffer_load_dwordx4 v[116:119], v91, s[12:15], s70 offen offset:1024 sc1
    v_mfma_f32_32x32x16_bf16 v[192:207], v[60:63], v[120:123], v[192:207]
    ds_read_b64_tr_b16 v[52:53], v83 offset:49152
    ds_read_b64_tr_b16 v[54:55], v83 offset:49664
    buffer_load_dwordx4 v80, s[16:19], s69 offen lds
    s_waitcnt vmcnt(21)
    v_mfma_f32_32x32x16_bf16 v[176:191], v[64:67], v[124:127], v[176:191]
    ds_read_b64_tr_b16 v[56:57], v82 offset:51200
    ds_read_b64_tr_b16 v[58:59], v82 offset:51712
    buffer_load_dwordx4 v[120:123], v91, s[12:15], s70 offen offset:2048 sc1
    v_mfma_f32_32x32x16_bf16 v[192:207], v[68:71], v[124:127], v[192:207]
    ds_read_b64_tr_b16 v[60:61], v83 offset:51200
    ds_read_b64_tr_b16 v[62:63], v83 offset:51712
    buffer_load_dwordx4 v81, s[16:19], s69 offen offset:1024 lds
    s_add_u32 s69, s69, 221184
    s_waitcnt vmcnt(21) lgkmcnt(4)
    v_mfma_f32_32x32x16_bf16 v[176:191], v[48:51], v[128:131], v[176:191]
    s_add_u32 m0, s68, 40960
    ds_read_b64_tr_b16 v[64:65], v82 offset:53248
    ds_read_b64_tr_b16 v[66:67], v82 offset:53760
    buffer_load_dwordx4 v[124:127], v91, s[12:15], s70 offen offset:3072 sc1
    s_add_u32 s70, s70, 4096
    v_mfma_f32_32x32x16_bf16 v[192:207], v[52:55], v[128:131], v[192:207]
    ds_read_b64_tr_b16 v[68:69], v83 offset:53248
    ds_read_b64_tr_b16 v[70:71], v83 offset:53760
    buffer_load_dwordx4 v80, s[16:19], s69 offen lds
    s_waitcnt vmcnt(21) lgkmcnt(4)
    v_mfma_f32_32x32x16_bf16 v[176:191], v[56:59], v[132:135], v[176:191]
    ds_read_b64_tr_b16 v[48:49], v82 offset:55296
    ds_read_b64_tr_b16 v[50:51], v82 offset:55808
    buffer_load_dwordx4 v[128:131], v91, s[12:15], s70 offen offset:0 sc1
    v_mfma_f32_32x32x16_bf16 v[192:207], v[60:63], v[132:135], v[192:207]
    ds_read_b64_tr_b16 v[52:53], v83 offset:55296
    ds_read_b64_tr_b16 v[54:55], v83 offset:55808
    buffer_load_dwordx4 v81, s[16:19], s69 offen offset:1024 lds
    s_add_u32 s69, s69, 221184
    s_waitcnt vmcnt(22) lgkmcnt(4)
    v_mfma_f32_32x32x16_bf16 v[176:191], v[64:67], v[136:139], v[176:191]
    ds_read_b64_tr_b16 v[56:57], v82 offset:57344
    ds_read_b64_tr_b16 v[58:59], v82 offset:57856
    buffer_load_dwordx4 v[132:135], v91, s[12:15], s70 offen offset:1024 sc1
    v_mfma_f32_32x32x16_bf16 v[192:207], v[68:71], v[136:139], v[192:207]
    ds_read_b64_tr_b16 v[60:61], v83 offset:57344
    ds_read_b64_tr_b16 v[62:63], v83 offset:57856
    s_waitcnt vmcnt(22) lgkmcnt(4)
    v_mfma_f32_32x32x16_bf16 v[176:191], v[48:51], v[140:143], v[176:191]
    ds_read_b64_tr_b16 v[64:65], v82 offset:59392
    ds_read_b64_tr_b16 v[66:67], v82 offset:59904
    buffer_load_dwordx4 v[136:139], v91, s[12:15], s70 offen offset:2048 sc1
    v_mfma_f32_32x32x16_bf16 v[192:207], v[52:55], v[140:143], v[192:207]
    ds_read_b64_tr_b16 v[68:69], v83 offset:59392
    ds_read_b64_tr_b16 v[70:71], v83 offset:59904
    s_waitcnt vmcnt(22) lgkmcnt(4)
    v_mfma_f32_32x32x16_bf16 v[176:191], v[56:59], v[144:147], v[176:191]
    ds_read_b64_tr_b16 v[48:49], v82 offset:61440
    ds_read_b64_tr_b16 v[50:51], v82 offset:61952
    buffer_load_dwordx4 v[140:143], v91, s[12:15], s70 offen offset:3072 sc1
    s_add_u32 s70, s70, 4096
    v_mfma_f32_32x32x16_bf16 v[192:207], v[60:63], v[144:147], v[192:207]
    ds_read_b64_tr_b16 v[52:53], v83 offset:61440
    ds_read_b64_tr_b16 v[54:55], v83 offset:61952
    s_waitcnt vmcnt(22) lgkmcnt(4)
    v_mfma_f32_32x32x16_bf16 v[176:191], v[64:67], v[148:151], v[176:191]
    ds_read_b64_tr_b16 v[56:57], v82 offset:63488
    ds_read_b64_tr_b16 v[58:59], v82 offset:64000
    buffer_load_dwordx4 v[144:147], v91, s[12:15], s70 offen offset:0 sc1
    v_mfma_f32_32x32x16_bf16 v[192:207], v[68:71], v[148:151], v[192:207]
    ds_read_b64_tr_b16 v[60:61], v83 offset:63488
    ds_read_b64_tr_b16 v[62:63], v83 offset:64000
    s_waitcnt lgkmcnt(0)
    s_barrier
    s_waitcnt vmcnt(21)
    v_mfma_f32_32x32x16_bf16 v[176:191], v[48:51], v[152:155], v[176:191]
    s_add_u32 m0, s68, 49152
    ds_read_b64_tr_b16 v[64:65], v84 offset:0
    ds_read_b64_tr_b16 v[66:67], v84 offset:512
    buffer_load_dwordx4 v[148:151], v91, s[12:15], s70 offen offset:1024 sc1
    v_mfma_f32_32x32x16_bf16 v[192:207], v[52:55], v[152:155], v[192:207]
    ds_read_b64_tr_b16 v[68:69], v85 offset:0
    ds_read_b64_tr_b16 v[70:71], v85 offset:512
    buffer_load_dwordx4 v80, s[16:19], s69 offen lds
    s_waitcnt vmcnt(21)
    v_mfma_f32_32x32x16_bf16 v[176:191], v[56:59], v[156:159], v[176:191]
    ds_read_b64_tr_b16 v[48:49], v84 offset:2048
    ds_read_b64_tr_b16 v[50:51], v84 offset:2560
    buffer_load_dwordx4 v[152:155], v91, s[12:15], s70 offen offset:2048 sc1
    v_mfma_f32_32x32x16_bf16 v[192:207], v[60:63], v[156:159], v[192:207]
    ds_read_b64_tr_b16 v[52:53], v85 offset:2048
    ds_read_b64_tr_b16 v[54:55], v85 offset:2560
    buffer_load_dwordx4 v81, s[16:19], s69 offen offset:1024 lds
    s_add_u32 s69, s69, 221184
    s_waitcnt vmcnt(21) lgkmcnt(4)
    v_mfma_f32_32x32x16_bf16 v[176:191], v[64:67], v[96:99], v[176:191]
    s_add_u32 m0, s68, 57344
    ds_read_b64_tr_b16 v[56:57], v84 offset:4096
    ds_read_b64_tr_b16 v[58:59], v84 offset:4608
    buffer_load_dwordx4 v[156:159], v91, s[12:15], s70 offen offset:3072 sc1
    s_add_u32 s70, s70, 4096
    v_mfma_f32_32x32x16_bf16 v[192:207], v[68:71], v[96:99], v[192:207]
    ds_read_b64_tr_b16 v[60:61], v85 offset:4096
    ds_read_b64_tr_b16 v[62:63], v85 offset:4608
    buffer_load_dwordx4 v80, s[16:19], s69 offen lds
    s_waitcnt vmcnt(21) lgkmcnt(4)
    v_mfma_f32_32x32x16_bf16 v[176:191], v[48:51], v[100:103], v[176:191]
    ds_read_b64_tr_b16 v[64:65], v84 offset:6144
    ds_read_b64_tr_b16 v[66:67], v84 offset:6656
    buffer_load_dwordx4 v[96:99], v91, s[12:15], s70 offen offset:0 sc1
    v_mfma_f32_32x32x16_bf16 v[192:207], v[52:55], v[100:103], v[192:207]
    ds_read_b64_tr_b16 v[68:69], v85 offset:6144
    ds_read_b64_tr_b16 v[70:71], v85 offset:6656
    buffer_load_dwordx4 v81, s[16:19], s69 offen offset:1024 lds
    s_add_u32 s69, s69, 221184
    s_waitcnt vmcnt(22) lgkmcnt(4)
    v_mfma_f32_32x32x16_bf16 v[176:191], v[56:59], v[104:107], v[176:191]
    ds_read_b64_tr_b16 v[48:49], v84 offset:8192
    ds_read_b64_tr_b16 v[50:51], v84 offset:8704
    buffer_load_dwordx4 v[100:103], v91, s[12:15], s70 offen offset:1024 sc1
    v_mfma_f32_32x32x16_bf16 v[192:207], v[60:63], v[104:107], v[192:207]
    ds_read_b64_tr_b16 v[52:53], v85 offset:8192
    ds_read_b64_tr_b16 v[54:55], v85 offset:8704
    s_waitcnt vmcnt(22) lgkmcnt(4)
    v_mfma_f32_32x32x16_bf16 v[176:191], v[64:67], v[108:111], v[176:191]
    ds_read_b64_tr_b16 v[56:57], v84 offset:10240
    ds_read_b64_tr_b16 v[58:59], v84 offset:10752
    buffer_load_dwordx4 v[104:107], v91, s[12:15], s70 offen offset:2048 sc1
    v_mfma_f32_32x32x16_bf16 v[192:207], v[68:71], v[108:111], v[192:207]
    ds_read_b64_tr_b16 v[60:61], v85 offset:10240
    ds_read_b64_tr_b16 v[62:63], v85 offset:10752
    s_waitcnt vmcnt(22) lgkmcnt(4)
    v_mfma_f32_32x32x16_bf16 v[176:191], v[48:51], v[112:115], v[176:191]
    ds_read_b64_tr_b16 v[64:65], v84 offset:12288
    ds_read_b64_tr_b16 v[66:67], v84 offset:12800
    buffer_load_dwordx4 v[108:111], v91, s[12:15], s70 offen offset:3072 sc1
    s_add_u32 s70, s70, 4096
    v_mfma_f32_32x32x16_bf16 v[192:207], v[52:55], v[112:115], v[192:207]
    ds_read_b64_tr_b16 v[68:69], v85 offset:12288
    ds_read_b64_tr_b16 v[70:71], v85 offset:12800
    s_waitcnt vmcnt(22) lgkmcnt(4)
    v_mfma_f32_32x32x16_bf16 v[176:191], v[56:59], v[116:119], v[176:191]
    ds_read_b64_tr_b16 v[48:49], v84 offset:14336
    ds_read_b64_tr_b16 v[50:51], v84 offset:14848
    buffer_load_dwordx4 v[112:115], v91, s[12:15], s70 offen offset:0 sc1
    v_mfma_f32_32x32x16_bf16 v[192:207], v[60:63], v[116:119], v[192:207]
    ds_read_b64_tr_b16 v[52:53], v85 offset:14336
    ds_read_b64_tr_b16 v[54:55], v85 offset:14848
    s_waitcnt lgkmcnt(0)
    s_barrier
    s_waitcnt vmcnt(21)
    v_mfma_f32_32x32x16_bf16 v[176:191], v[64:67], v[120:123], v[176:191]
    s_add_u32 m0, s68, 65536
    ds_read_b64_tr_b16 v[56:57], v84 offset:16384
    ds_read_b64_tr_b16 v[58:59], v84 offset:16896
    buffer_load_dwordx4 v[116:119], v91, s[12:15], s70 offen offset:1024 sc1
    v_mfma_f32_32x32x16_bf16 v[192:207], v[68:71], v[120:123], v[192:207]
    ds_read_b64_tr_b16 v[60:61], v85 offset:16384
    ds_read_b64_tr_b16 v[62:63], v85 offset:16896
    buffer_load_dwordx4 v80, s[16:19], s69 offen lds
    s_waitcnt vmcnt(21)
    v_mfma_f32_32x32x16_bf16 v[176:191], v[48:51], v[124:127], v[176:191]
    ds_read_b64_tr_b16 v[64:65], v84 offset:18432
    ds_read_b64_tr_b16 v[66:67], v84 offset:18944
    buffer_load_dwordx4 v[120:123], v91, s[12:15], s70 offen offset:2048 sc1
    v_mfma_f32_32x32x16_bf16 v[192:207], v[52:55], v[124:127], v[192:207]
    ds_read_b64_tr_b16 v[68:69], v85 offset:18432
    ds_read_b64_tr_b16 v[70:71], v85 offset:18944
    buffer_load_dwordx4 v81, s[16:19], s69 offen offset:1024 lds
    s_add_u32 s69, s69, 221184
    s_waitcnt vmcnt(21) lgkmcnt(4)
    v_mfma_f32_32x32x16_bf16 v[176:191], v[56:59], v[128:131], v[176:191]
    s_add_u32 m0, s68, 73728
    ds_read_b64_tr_b16 v[48:49], v84 offset:20480
    ds_read_b64_tr_b16 v[50:51], v84 offset:20992
    buffer_load_dwordx4 v[124:127], v91, s[12:15], s70 offen offset:3072 sc1
    s_add_u32 s70, s70, 4096
    v_mfma_f32_32x32x16_bf16 v[192:207], v[60:63], v[128:131], v[192:207]
    ds_read_b64_tr_b16 v[52:53], v85 offset:20480
    ds_read_b64_tr_b16 v[54:55], v85 offset:20992
    buffer_load_dwordx4 v80, s[16:19], s69 offen lds
    s_waitcnt vmcnt(21) lgkmcnt(4)
    v_mfma_f32_32x32x16_bf16 v[176:191], v[64:67], v[132:135], v[176:191]
    ds_read_b64_tr_b16 v[56:57], v84 offset:22528
    ds_read_b64_tr_b16 v[58:59], v84 offset:23040
    buffer_load_dwordx4 v[128:131], v91, s[12:15], s70 offen offset:0 sc1
    v_mfma_f32_32x32x16_bf16 v[192:207], v[68:71], v[132:135], v[192:207]
    ds_read_b64_tr_b16 v[60:61], v85 offset:22528
    ds_read_b64_tr_b16 v[62:63], v85 offset:23040
    buffer_load_dwordx4 v81, s[16:19], s69 offen offset:1024 lds
    s_add_u32 s69, s69, 221184
    s_waitcnt vmcnt(22) lgkmcnt(4)
    v_mfma_f32_32x32x16_bf16 v[176:191], v[48:51], v[136:139], v[176:191]
    ds_read_b64_tr_b16 v[64:65], v84 offset:24576
    ds_read_b64_tr_b16 v[66:67], v84 offset:25088
    buffer_load_dwordx4 v[132:135], v91, s[12:15], s70 offen offset:1024 sc1
    v_mfma_f32_32x32x16_bf16 v[192:207], v[52:55], v[136:139], v[192:207]
    ds_read_b64_tr_b16 v[68:69], v85 offset:24576
    ds_read_b64_tr_b16 v[70:71], v85 offset:25088
    s_waitcnt vmcnt(22) lgkmcnt(4)
    v_mfma_f32_32x32x16_bf16 v[176:191], v[56:59], v[140:143], v[176:191]
    ds_read_b64_tr_b16 v[48:49], v84 offset:26624
    ds_read_b64_tr_b16 v[50:51], v84 offset:27136
    buffer_load_dwordx4 v[136:139], v91, s[12:15], s70 offen offset:2048 sc1
    v_mfma_f32_32x32x16_bf16 v[192:207], v[60:63], v[140:143], v[192:207]
    ds_read_b64_tr_b16 v[52:53], v85 offset:26624
    ds_read_b64_tr_b16 v[54:55], v85 offset:27136
    s_waitcnt vmcnt(22) lgkmcnt(4)
    v_mfma_f32_32x32x16_bf16 v[176:191], v[64:67], v[144:147], v[176:191]
    ds_read_b64_tr_b16 v[56:57], v84 offset:28672
    ds_read_b64_tr_b16 v[58:59], v84 offset:29184
    buffer_load_dwordx4 v[140:143], v91, s[12:15], s70 offen offset:3072 sc1
    s_add_u32 s70, s70, 4096
    v_mfma_f32_32x32x16_bf16 v[192:207], v[68:71], v[144:147], v[192:207]
    ds_read_b64_tr_b16 v[60:61], v85 offset:28672
    ds_read_b64_tr_b16 v[62:63], v85 offset:29184
    s_waitcnt vmcnt(22) lgkmcnt(4)
    v_mfma_f32_32x32x16_bf16 v[176:191], v[48:51], v[148:151], v[176:191]
    ds_read_b64_tr_b16 v[64:65], v84 offset:30720
    ds_read_b64_tr_b16 v[66:67], v84 offset:31232
    buffer_load_dwordx4 v[144:147], v91, s[12:15], s70 offen offset:0 sc1
    v_mfma_f32_32x32x16_bf16 v[192:207], v[52:55], v[148:151], v[192:207]
    ds_read_b64_tr_b16 v[68:69], v85 offset:30720
    ds_read_b64_tr_b16 v[70:71], v85 offset:31232
    s_waitcnt lgkmcnt(0)
    s_barrier
    s_waitcnt vmcnt(21)
    v_mfma_f32_32x32x16_bf16 v[176:191], v[56:59], v[152:155], v[176:191]
    s_add_u32 m0, s68, 81920
    ds_read_b64_tr_b16 v[48:49], v84 offset:32768
    ds_read_b64_tr_b16 v[50:51], v84 offset:33280
    buffer_load_dwordx4 v[148:151], v91, s[12:15], s70 offen offset:1024 sc1
    v_mfma_f32_32x32x16_bf16 v[192:207], v[60:63], v[152:155], v[192:207]
    ds_read_b64_tr_b16 v[52:53], v85 offset:32768
    ds_read_b64_tr_b16 v[54:55], v85 offset:33280
    buffer_load_dwordx4 v80, s[16:19], s69 offen lds
    s_waitcnt vmcnt(21)
    v_mfma_f32_32x32x16_bf16 v[176:191], v[64:67], v[156:159], v[176:191]
    ds_read_b64_tr_b16 v[56:57], v84 offset:34816
    ds_read_b64_tr_b16 v[58:59], v84 offset:35328
    buffer_load_dwordx4 v[152:155], v91, s[12:15], s70 offen offset:2048 sc1
    v_mfma_f32_32x32x16_bf16 v[192:207], v[68:71], v[156:159], v[192:207]
    ds_read_b64_tr_b16 v[60:61], v85 offset:34816
    ds_read_b64_tr_b16 v[62:63], v85 offset:35328
    buffer_load_dwordx4 v81, s[16:19], s69 offen offset:1024 lds
    s_add_u32 s69, s69, 221184
    s_waitcnt vmcnt(21) lgkmcnt(4)
    v_mfma_f32_32x32x16_bf16 v[176:191], v[48:51], v[96:99], v[176:191]
    s_add_u32 m0, s68, 90112
    ds_read_b64_tr_b16 v[64:65], v84 offset:36864
    ds_read_b64_tr_b16 v[66:67], v84 offset:37376
    buffer_load_dwordx4 v[156:159], v91, s[12:15], s70 offen offset:3072 sc1
    s_add_u32 s70, s70, 4096
    v_mfma_f32_32x32x16_bf16 v[192:207], v[52:55], v[96:99], v[192:207]
    ds_read_b64_tr_b16 v[68:69], v85 offset:36864
    ds_read_b64_tr_b16 v[70:71], v85 offset:37376
    buffer_load_dwordx4 v80, s[16:19], s69 offen lds
    s_waitcnt vmcnt(21) lgkmcnt(4)
    v_mfma_f32_32x32x16_bf16 v[176:191], v[56:59], v[100:103], v[176:191]
    ds_read_b64_tr_b16 v[48:49], v84 offset:38912
    ds_read_b64_tr_b16 v[50:51], v84 offset:39424
    buffer_load_dwordx4 v[96:99], v91, s[12:15], s70 offen offset:0 sc1
    v_mfma_f32_32x32x16_bf16 v[192:207], v[60:63], v[100:103], v[192:207]
    ds_read_b64_tr_b16 v[52:53], v85 offset:38912
    ds_read_b64_tr_b16 v[54:55], v85 offset:39424
    buffer_load_dwordx4 v81, s[16:19], s69 offen offset:1024 lds
    s_add_u32 s69, s69, 221184
    s_waitcnt vmcnt(22) lgkmcnt(4)
    v_mfma_f32_32x32x16_bf16 v[176:191], v[64:67], v[104:107], v[176:191]
    ds_read_b64_tr_b16 v[56:57], v84 offset:40960
    ds_read_b64_tr_b16 v[58:59], v84 offset:41472
    buffer_load_dwordx4 v[100:103], v91, s[12:15], s70 offen offset:1024 sc1
    v_mfma_f32_32x32x16_bf16 v[192:207], v[68:71], v[104:107], v[192:207]
    ds_read_b64_tr_b16 v[60:61], v85 offset:40960
    ds_read_b64_tr_b16 v[62:63], v85 offset:41472
    s_waitcnt vmcnt(22) lgkmcnt(4)
    v_mfma_f32_32x32x16_bf16 v[176:191], v[48:51], v[108:111], v[176:191]
    ds_read_b64_tr_b16 v[64:65], v84 offset:43008
    ds_read_b64_tr_b16 v[66:67], v84 offset:43520
    buffer_load_dwordx4 v[104:107], v91, s[12:15], s70 offen offset:2048 sc1
    v_mfma_f32_32x32x16_bf16 v[192:207], v[52:55], v[108:111], v[192:207]
    ds_read_b64_tr_b16 v[68:69], v85 offset:43008
    ds_read_b64_tr_b16 v[70:71], v85 offset:43520
    s_waitcnt vmcnt(22) lgkmcnt(4)
    v_mfma_f32_32x32x16_bf16 v[176:191], v[56:59], v[112:115], v[176:191]
    ds_read_b64_tr_b16 v[48:49], v84 offset:45056
    ds_read_b64_tr_b16 v[50:51], v84 offset:45568
    buffer_load_dwordx4 v[108:111], v91, s[12:15], s70 offen offset:3072 sc1
    s_add_u32 s70, s70, 4096
    v_mfma_f32_32x32x16_bf16 v[192:207], v[60:63], v[112:115], v[192:207]
    ds_read_b64_tr_b16 v[52:53], v85 offset:45056
    ds_read_b64_tr_b16 v[54:55], v85 offset:45568
    s_waitcnt vmcnt(22) lgkmcnt(4)
    v_mfma_f32_32x32x16_bf16 v[176:191], v[64:67], v[116:119], v[176:191]
    ds_read_b64_tr_b16 v[56:57], v84 offset:47104
    ds_read_b64_tr_b16 v[58:59], v84 offset:47616
    buffer_load_dwordx4 v[112:115], v91, s[12:15], s70 offen offset:0 sc1
    v_mfma_f32_32x32x16_bf16 v[192:207], v[68:71], v[116:119], v[192:207]
    ds_read_b64_tr_b16 v[60:61], v85 offset:47104
    ds_read_b64_tr_b16 v[62:63], v85 offset:47616
    s_waitcnt lgkmcnt(0)
    s_barrier
    s_waitcnt vmcnt(21)
    v_mfma_f32_32x32x16_bf16 v[176:191], v[48:51], v[120:123], v[176:191]
    s_add_u32 m0, s68, 98304
    ds_read_b64_tr_b16 v[64:65], v84 offset:49152
    ds_read_b64_tr_b16 v[66:67], v84 offset:49664
    buffer_load_dwordx4 v[116:119], v91, s[12:15], s70 offen offset:1024 sc1
    v_mfma_f32_32x32x16_bf16 v[192:207], v[52:55], v[120:123], v[192:207]
    ds_read_b64_tr_b16 v[68:69], v85 offset:49152
    ds_read_b64_tr_b16 v[70:71], v85 offset:49664
    buffer_load_dwordx4 v80, s[16:19], s69 offen lds
    s_waitcnt vmcnt(21)
    v_mfma_f32_32x32x16_bf16 v[176:191], v[56:59], v[124:127], v[176:191]
    ds_read_b64_tr_b16 v[48:49], v84 offset:51200
    ds_read_b64_tr_b16 v[50:51], v84 offset:51712
    buffer_load_dwordx4 v[120:123], v91, s[12:15], s70 offen offset:2048 sc1
    v_mfma_f32_32x32x16_bf16 v[192:207], v[60:63], v[124:127], v[192:207]
    ds_read_b64_tr_b16 v[52:53], v85 offset:51200
    ds_read_b64_tr_b16 v[54:55], v85 offset:51712
    buffer_load_dwordx4 v81, s[16:19], s69 offen offset:1024 lds
    s_add_u32 s69, s69, 221184
    s_waitcnt vmcnt(21) lgkmcnt(4)
    v_mfma_f32_32x32x16_bf16 v[176:191], v[64:67], v[128:131], v[176:191]
    s_add_u32 m0, s68, 106496
    ds_read_b64_tr_b16 v[56:57], v84 offset:53248
    ds_read_b64_tr_b16 v[58:59], v84 offset:53760
    buffer_load_dwordx4 v[124:127], v91, s[12:15], s70 offen offset:3072 sc1
    s_add_u32 s70, s70, 4096
    v_mfma_f32_32x32x16_bf16 v[192:207], v[68:71], v[128:131], v[192:207]
    ds_read_b64_tr_b16 v[60:61], v85 offset:53248
    ds_read_b64_tr_b16 v[62:63], v85 offset:53760
    buffer_load_dwordx4 v80, s[16:19], s69 offen lds
    s_waitcnt vmcnt(21) lgkmcnt(4)
    v_mfma_f32_32x32x16_bf16 v[176:191], v[48:51], v[132:135], v[176:191]
    ds_read_b64_tr_b16 v[64:65], v84 offset:55296
    ds_read_b64_tr_b16 v[66:67], v84 offset:55808
    buffer_load_dwordx4 v[128:131], v91, s[12:15], s70 offen offset:0 sc1
    v_mfma_f32_32x32x16_bf16 v[192:207], v[52:55], v[132:135], v[192:207]
    ds_read_b64_tr_b16 v[68:69], v85 offset:55296
    ds_read_b64_tr_b16 v[70:71], v85 offset:55808
    buffer_load_dwordx4 v81, s[16:19], s69 offen offset:1024 lds
    s_add_u32 s69, s69, 221184
    s_waitcnt vmcnt(22) lgkmcnt(4)
    v_mfma_f32_32x32x16_bf16 v[176:191], v[56:59], v[136:139], v[176:191]
    ds_read_b64_tr_b16 v[48:49], v84 offset:57344
    ds_read_b64_tr_b16 v[50:51], v84 offset:57856
    buffer_load_dwordx4 v[132:135], v91, s[12:15], s70 offen offset:1024 sc1
    v_mfma_f32_32x32x16_bf16 v[192:207], v[60:63], v[136:139], v[192:207]
    ds_read_b64_tr_b16 v[52:53], v85 offset:57344
    ds_read_b64_tr_b16 v[54:55], v85 offset:57856
    s_waitcnt vmcnt(22) lgkmcnt(4)
    v_mfma_f32_32x32x16_bf16 v[176:191], v[64:67], v[140:143], v[176:191]
    ds_read_b64_tr_b16 v[56:57], v84 offset:59392
    ds_read_b64_tr_b16 v[58:59], v84 offset:59904
    buffer_load_dwordx4 v[136:139], v91, s[12:15], s70 offen offset:2048 sc1
    v_mfma_f32_32x32x16_bf16 v[192:207], v[68:71], v[140:143], v[192:207]
    ds_read_b64_tr_b16 v[60:61], v85 offset:59392
    ds_read_b64_tr_b16 v[62:63], v85 offset:59904
    s_waitcnt vmcnt(22) lgkmcnt(4)
    v_mfma_f32_32x32x16_bf16 v[176:191], v[48:51], v[144:147], v[176:191]
    ds_read_b64_tr_b16 v[64:65], v84 offset:61440
    ds_read_b64_tr_b16 v[66:67], v84 offset:61952
    buffer_load_dwordx4 v[140:143], v91, s[12:15], s70 offen offset:3072 sc1
    s_add_u32 s70, s70, 4096
    v_mfma_f32_32x32x16_bf16 v[192:207], v[52:55], v[144:147], v[192:207]
    ds_read_b64_tr_b16 v[68:69], v85 offset:61440
    ds_read_b64_tr_b16 v[70:71], v85 offset:61952
    s_waitcnt vmcnt(22) lgkmcnt(4)
    v_mfma_f32_32x32x16_bf16 v[176:191], v[56:59], v[148:151], v[176:191]
    ds_read_b64_tr_b16 v[48:49], v84 offset:63488
    ds_read_b64_tr_b16 v[50:51], v84 offset:64000
    buffer_load_dwordx4 v[144:147], v91, s[12:15], s70 offen offset:0 sc1
    v_mfma_f32_32x32x16_bf16 v[192:207], v[60:63], v[148:151], v[192:207]
    ds_read_b64_tr_b16 v[52:53], v85 offset:63488
    ds_read_b64_tr_b16 v[54:55], v85 offset:64000
    s_waitcnt lgkmcnt(0)
    s_barrier
    s_waitcnt vmcnt(21)
    v_mfma_f32_32x32x16_bf16 v[176:191], v[64:67], v[152:155], v[176:191]
    ds_read_b64_tr_b16 v[56:57], v86 offset:0
    ds_read_b64_tr_b16 v[58:59], v86 offset:512
    buffer_load_dwordx4 v[148:151], v91, s[12:15], s70 offen offset:1024 sc1
    v_mfma_f32_32x32x16_bf16 v[192:207], v[68:71], v[152:155], v[192:207]
    ds_read_b64_tr_b16 v[60:61], v87 offset:0
    ds_read_b64_tr_b16 v[62:63], v87 offset:512
    s_waitcnt vmcnt(20)
    v_mfma_f32_32x32x16_bf16 v[176:191], v[48:51], v[156:159], v[176:191]
    ds_read_b64_tr_b16 v[64:65], v86 offset:2048
    ds_read_b64_tr_b16 v[66:67], v86 offset:2560
    buffer_load_dwordx4 v[152:155], v91, s[12:15], s70 offen offset:2048 sc1
    v_mfma_f32_32x32x16_bf16 v[192:207], v[52:55], v[156:159], v[192:207]
    ds_read_b64_tr_b16 v[68:69], v87 offset:2048
    ds_read_b64_tr_b16 v[70:71], v87 offset:2560
    s_waitcnt vmcnt(19) lgkmcnt(4)
    v_mfma_f32_32x32x16_bf16 v[176:191], v[56:59], v[96:99], v[176:191]
    ds_read_b64_tr_b16 v[48:49], v86 offset:4096
    ds_read_b64_tr_b16 v[50:51], v86 offset:4608
    buffer_load_dwordx4 v[156:159], v91, s[12:15], s70 offen offset:3072 sc1
    s_add_u32 s70, s70, 4096
    v_mfma_f32_32x32x16_bf16 v[192:207], v[60:63], v[96:99], v[192:207]
    ds_read_b64_tr_b16 v[52:53], v87 offset:4096
    ds_read_b64_tr_b16 v[54:55], v87 offset:4608
    s_waitcnt vmcnt(18) lgkmcnt(4)
    v_mfma_f32_32x32x16_bf16 v[176:191], v[64:67], v[100:103], v[176:191]
    ds_read_b64_tr_b16 v[56:57], v86 offset:6144
    ds_read_b64_tr_b16 v[58:59], v86 offset:6656
    buffer_load_dwordx4 v[96:99], v91, s[12:15], s70 offen offset:0 sc1
    v_mfma_f32_32x32x16_bf16 v[192:207], v[68:71], v[100:103], v[192:207]
    ds_read_b64_tr_b16 v[60:61], v87 offset:6144
    ds_read_b64_tr_b16 v[62:63], v87 offset:6656
    s_waitcnt vmcnt(18) lgkmcnt(4)
    v_mfma_f32_32x32x16_bf16 v[176:191], v[48:51], v[104:107], v[176:191]
    ds_read_b64_tr_b16 v[64:65], v86 offset:8192
    ds_read_b64_tr_b16 v[66:67], v86 offset:8704
    buffer_load_dwordx4 v[100:103], v91, s[12:15], s70 offen offset:1024 sc1
    v_mfma_f32_32x32x16_bf16 v[192:207], v[52:55], v[104:107], v[192:207]
    ds_read_b64_tr_b16 v[68:69], v87 offset:8192
    ds_read_b64_tr_b16 v[70:71], v87 offset:8704
    s_waitcnt vmcnt(18) lgkmcnt(4)
    v_mfma_f32_32x32x16_bf16 v[176:191], v[56:59], v[108:111], v[176:191]
    ds_read_b64_tr_b16 v[48:49], v86 offset:10240
    ds_read_b64_tr_b16 v[50:51], v86 offset:10752
    buffer_load_dwordx4 v[104:107], v91, s[12:15], s70 offen offset:2048 sc1
    v_mfma_f32_32x32x16_bf16 v[192:207], v[60:63], v[108:111], v[192:207]
    ds_read_b64_tr_b16 v[52:53], v87 offset:10240
    ds_read_b64_tr_b16 v[54:55], v87 offset:10752
    s_waitcnt vmcnt(18) lgkmcnt(4)
    v_mfma_f32_32x32x16_bf16 v[176:191], v[64:67], v[112:115], v[176:191]
    ds_read_b64_tr_b16 v[56:57], v86 offset:12288
    ds_read_b64_tr_b16 v[58:59], v86 offset:12800
    buffer_load_dwordx4 v[108:111], v91, s[12:15], s70 offen offset:3072 sc1
    s_add_u32 s70, s70, 4096
    v_mfma_f32_32x32x16_bf16 v[192:207], v[68:71], v[112:115], v[192:207]
    ds_read_b64_tr_b16 v[60:61], v87 offset:12288
    ds_read_b64_tr_b16 v[62:63], v87 offset:12800
    s_waitcnt vmcnt(18) lgkmcnt(4)
    v_mfma_f32_32x32x16_bf16 v[176:191], v[48:51], v[116:119], v[176:191]
    ds_read_b64_tr_b16 v[64:65], v86 offset:14336
    ds_read_b64_tr_b16 v[66:67], v86 offset:14848
    buffer_load_dwordx4 v[112:115], v91, s[12:15], s70 offen offset:0 sc1
    v_mfma_f32_32x32x16_bf16 v[192:207], v[52:55], v[116:119], v[192:207]
    ds_read_b64_tr_b16 v[68:69], v87 offset:14336
    ds_read_b64_tr_b16 v[70:71], v87 offset:14848
    s_waitcnt lgkmcnt(0)
    s_barrier
    s_waitcnt vmcnt(17)
    v_mfma_f32_32x32x16_bf16 v[176:191], v[56:59], v[120:123], v[176:191]
    ds_read_b64_tr_b16 v[48:49], v82 offset:0
    ds_read_b64_tr_b16 v[50:51], v82 offset:512
    buffer_load_dwordx4 v[116:119], v91, s[12:15], s70 offen offset:1024 sc1
    v_mfma_f32_32x32x16_bf16 v[192:207], v[60:63], v[120:123], v[192:207]
    ds_read_b64_tr_b16 v[52:53], v83 offset:0
    ds_read_b64_tr_b16 v[54:55], v83 offset:512
    s_waitcnt vmcnt(16)
    v_mfma_f32_32x32x16_bf16 v[176:191], v[64:67], v[124:127], v[176:191]
    ds_read_b64_tr_b16 v[56:57], v82 offset:2048
    ds_read_b64_tr_b16 v[58:59], v82 offset:2560
    buffer_load_dwordx4 v[120:123], v91, s[12:15], s70 offen offset:2048 sc1
    v_mfma_f32_32x32x16_bf16 v[192:207], v[68:71], v[124:127], v[192:207]
    ds_read_b64_tr_b16 v[60:61], v83 offset:2048
    ds_read_b64_tr_b16 v[62:63], v83 offset:2560
    s_waitcnt vmcnt(15) lgkmcnt(4)
    v_mfma_f32_32x32x16_bf16 v[176:191], v[48:51], v[128:131], v[176:191]
    ds_read_b64_tr_b16 v[64:65], v82 offset:4096
    ds_read_b64_tr_b16 v[66:67], v82 offset:4608
    buffer_load_dwordx4 v[124:127], v91, s[12:15], s70 offen offset:3072 sc1
    s_add_u32 s70, s70, 4096
    v_mfma_f32_32x32x16_bf16 v[192:207], v[52:55], v[128:131], v[192:207]
    ds_read_b64_tr_b16 v[68:69], v83 offset:4096
    ds_read_b64_tr_b16 v[70:71], v83 offset:4608
    s_waitcnt vmcnt(14) lgkmcnt(4)
    v_mfma_f32_32x32x16_bf16 v[176:191], v[56:59], v[132:135], v[176:191]
    ds_read_b64_tr_b16 v[48:49], v82 offset:6144
    ds_read_b64_tr_b16 v[50:51], v82 offset:6656
    buffer_load_dwordx4 v[128:131], v91, s[12:15], s70 offen offset:0 sc1
    v_mfma_f32_32x32x16_bf16 v[192:207], v[60:63], v[132:135], v[192:207]
    ds_read_b64_tr_b16 v[52:53], v83 offset:6144
    ds_read_b64_tr_b16 v[54:55], v83 offset:6656
    s_waitcnt vmcnt(14) lgkmcnt(4)
    v_mfma_f32_32x32x16_bf16 v[176:191], v[64:67], v[136:139], v[176:191]
    ds_read_b64_tr_b16 v[56:57], v82 offset:8192
    ds_read_b64_tr_b16 v[58:59], v82 offset:8704
    buffer_load_dwordx4 v[132:135], v91, s[12:15], s70 offen offset:1024 sc1
    v_mfma_f32_32x32x16_bf16 v[192:207], v[68:71], v[136:139], v[192:207]
    ds_read_b64_tr_b16 v[60:61], v83 offset:8192
    ds_read_b64_tr_b16 v[62:63], v83 offset:8704
    s_waitcnt vmcnt(14) lgkmcnt(4)
    v_mfma_f32_32x32x16_bf16 v[176:191], v[48:51], v[140:143], v[176:191]
    ds_read_b64_tr_b16 v[64:65], v82 offset:10240
    ds_read_b64_tr_b16 v[66:67], v82 offset:10752
    buffer_load_dwordx4 v[136:139], v91, s[12:15], s70 offen offset:2048 sc1
    v_mfma_f32_32x32x16_bf16 v[192:207], v[52:55], v[140:143], v[192:207]
    ds_read_b64_tr_b16 v[68:69], v83 offset:10240
    ds_read_b64_tr_b16 v[70:71], v83 offset:10752
    s_waitcnt vmcnt(14) lgkmcnt(4)
    v_mfma_f32_32x32x16_bf16 v[176:191], v[56:59], v[144:147], v[176:191]
    ds_read_b64_tr_b16 v[48:49], v82 offset:12288
    ds_read_b64_tr_b16 v[50:51], v82 offset:12800
    buffer_load_dwordx4 v[140:143], v91, s[12:15], s70 offen offset:3072 sc1
    s_add_u32 s70, s70, 4096
    v_mfma_f32_32x32x16_bf16 v[192:207], v[60:63], v[144:147], v[192:207]
    ds_read_b64_tr_b16 v[52:53], v83 offset:12288
    ds_read_b64_tr_b16 v[54:55], v83 offset:12800
    s_waitcnt vmcnt(14) lgkmcnt(4)
    v_mfma_f32_32x32x16_bf16 v[176:191], v[64:67], v[148:151], v[176:191]
    ds_read_b64_tr_b16 v[56:57], v82 offset:14336
    ds_read_b64_tr_b16 v[58:59], v82 offset:14848
    buffer_load_dwordx4 v[144:147], v91, s[12:15], s70 offen offset:0 sc1
    v_mfma_f32_32x32x16_bf16 v[192:207], v[68:71], v[148:151], v[192:207]
    ds_read_b64_tr_b16 v[60:61], v83 offset:14336
    ds_read_b64_tr_b16 v[62:63], v83 offset:14848
    s_waitcnt lgkmcnt(0)
    s_barrier
    s_waitcnt vmcnt(14)
    v_mfma_f32_32x32x16_bf16 v[176:191], v[48:51], v[152:155], v[176:191]
    ds_read_b64_tr_b16 v[64:65], v82 offset:16384
    ds_read_b64_tr_b16 v[66:67], v82 offset:16896
    buffer_load_dwordx4 v[148:151], v91, s[12:15], s70 offen offset:1024 sc1
    v_mfma_f32_32x32x16_bf16 v[192:207], v[52:55], v[152:155], v[192:207]
    ds_read_b64_tr_b16 v[68:69], v83 offset:16384
    ds_read_b64_tr_b16 v[70:71], v83 offset:16896
    s_waitcnt vmcnt(14)
    v_mfma_f32_32x32x16_bf16 v[176:191], v[56:59], v[156:159], v[176:191]
    ds_read_b64_tr_b16 v[48:49], v82 offset:18432
    ds_read_b64_tr_b16 v[50:51], v82 offset:18944
    buffer_load_dwordx4 v[152:155], v91, s[12:15], s70 offen offset:2048 sc1
    v_mfma_f32_32x32x16_bf16 v[192:207], v[60:63], v[156:159], v[192:207]
    ds_read_b64_tr_b16 v[52:53], v83 offset:18432
    ds_read_b64_tr_b16 v[54:55], v83 offset:18944
    s_waitcnt vmcnt(14) lgkmcnt(4)
    v_mfma_f32_32x32x16_bf16 v[176:191], v[64:67], v[96:99], v[176:191]
    ds_read_b64_tr_b16 v[56:57], v82 offset:20480
    ds_read_b64_tr_b16 v[58:59], v82 offset:20992
    buffer_load_dwordx4 v[156:159], v91, s[12:15], s70 offen offset:3072 sc1
    s_add_u32 s70, s70, 4096
    v_mfma_f32_32x32x16_bf16 v[192:207], v[68:71], v[96:99], v[192:207]
    ds_read_b64_tr_b16 v[60:61], v83 offset:20480
    ds_read_b64_tr_b16 v[62:63], v83 offset:20992
    s_waitcnt vmcnt(14) lgkmcnt(4)
    v_mfma_f32_32x32x16_bf16 v[176:191], v[48:51], v[100:103], v[176:191]
    ds_read_b64_tr_b16 v[64:65], v82 offset:22528
    ds_read_b64_tr_b16 v[66:67], v82 offset:23040
    buffer_load_dwordx4 v[96:99], v91, s[12:15], s70 offen offset:0 sc1
    v_mfma_f32_32x32x16_bf16 v[192:207], v[52:55], v[100:103], v[192:207]
    ds_read_b64_tr_b16 v[68:69], v83 offset:22528
    ds_read_b64_tr_b16 v[70:71], v83 offset:23040
    s_waitcnt vmcnt(14) lgkmcnt(4)
    v_mfma_f32_32x32x16_bf16 v[176:191], v[56:59], v[104:107], v[176:191]
    ds_read_b64_tr_b16 v[48:49], v82 offset:24576
    ds_read_b64_tr_b16 v[50:51], v82 offset:25088
    buffer_load_dwordx4 v[100:103], v91, s[12:15], s70 offen offset:1024 sc1
    v_mfma_f32_32x32x16_bf16 v[192:207], v[60:63], v[104:107], v[192:207]
    ds_read_b64_tr_b16 v[52:53], v83 offset:24576
    ds_read_b64_tr_b16 v[54:55], v83 offset:25088
    s_waitcnt vmcnt(14) lgkmcnt(4)
    v_mfma_f32_32x32x16_bf16 v[176:191], v[64:67], v[108:111], v[176:191]
    ds_read_b64_tr_b16 v[56:57], v82 offset:26624
    ds_read_b64_tr_b16 v[58:59], v82 offset:27136
    buffer_load_dwordx4 v[104:107], v91, s[12:15], s70 offen offset:2048 sc1
    v_mfma_f32_32x32x16_bf16 v[192:207], v[68:71], v[108:111], v[192:207]
    ds_read_b64_tr_b16 v[60:61], v83 offset:26624
    ds_read_b64_tr_b16 v[62:63], v83 offset:27136
    s_waitcnt vmcnt(14) lgkmcnt(4)
    v_mfma_f32_32x32x16_bf16 v[176:191], v[48:51], v[112:115], v[176:191]
    ds_read_b64_tr_b16 v[64:65], v82 offset:28672
    ds_read_b64_tr_b16 v[66:67], v82 offset:29184
    buffer_load_dwordx4 v[108:111], v91, s[12:15], s70 offen offset:3072 sc1
    s_add_u32 s70, s70, 4096
    v_mfma_f32_32x32x16_bf16 v[192:207], v[52:55], v[112:115], v[192:207]
    ds_read_b64_tr_b16 v[68:69], v83 offset:28672
    ds_read_b64_tr_b16 v[70:71], v83 offset:29184
    s_waitcnt vmcnt(14) lgkmcnt(4)
    v_mfma_f32_32x32x16_bf16 v[176:191], v[56:59], v[116:119], v[176:191]
    ds_read_b64_tr_b16 v[48:49], v82 offset:30720
    ds_read_b64_tr_b16 v[50:51], v82 offset:31232
    buffer_load_dwordx4 v[112:115], v91, s[12:15], s70 offen offset:0 sc1
    v_mfma_f32_32x32x16_bf16 v[192:207], v[60:63], v[116:119], v[192:207]
    ds_read_b64_tr_b16 v[52:53], v83 offset:30720
    ds_read_b64_tr_b16 v[54:55], v83 offset:31232
    s_waitcnt vmcnt(14) lgkmcnt(4)
    v_mfma_f32_32x32x16_bf16 v[176:191], v[64:67], v[120:123], v[176:191]
    ds_read_b64_tr_b16 v[56:57], v82 offset:32768
    ds_read_b64_tr_b16 v[58:59], v82 offset:33280
    buffer_load_dwordx4 v[116:119], v91, s[12:15], s70 offen offset:1024 sc1
    v_mfma_f32_32x32x16_bf16 v[192:207], v[68:71], v[120:123], v[192:207]
    ds_read_b64_tr_b16 v[60:61], v83 offset:32768
    ds_read_b64_tr_b16 v[62:63], v83 offset:33280
    s_waitcnt vmcnt(14) lgkmcnt(4)
    v_mfma_f32_32x32x16_bf16 v[176:191], v[48:51], v[124:127], v[176:191]
    ds_read_b64_tr_b16 v[64:65], v82 offset:34816
    ds_read_b64_tr_b16 v[66:67], v82 offset:35328
    buffer_load_dwordx4 v[120:123], v91, s[12:15], s70 offen offset:2048 sc1
    v_mfma_f32_32x32x16_bf16 v[192:207], v[52:55], v[124:127], v[192:207]
    ds_read_b64_tr_b16 v[68:69], v83 offset:34816
    ds_read_b64_tr_b16 v[70:71], v83 offset:35328
    s_waitcnt vmcnt(14) lgkmcnt(4)
    v_mfma_f32_32x32x16_bf16 v[176:191], v[56:59], v[128:131], v[176:191]
    ds_read_b64_tr_b16 v[48:49], v82 offset:36864
    ds_read_b64_tr_b16 v[50:51], v82 offset:37376
    buffer_load_dwordx4 v[124:127], v91, s[12:15], s70 offen offset:3072 sc1
    s_add_u32 s70, s70, 4096
    v_mfma_f32_32x32x16_bf16 v[192:207], v[60:63], v[128:131], v[192:207]
    ds_read_b64_tr_b16 v[52:53], v83 offset:36864
    ds_read_b64_tr_b16 v[54:55], v83 offset:37376
    s_waitcnt vmcnt(14) lgkmcnt(4)
    v_mfma_f32_32x32x16_bf16 v[176:191], v[64:67], v[132:135], v[176:191]
    ds_read_b64_tr_b16 v[56:57], v82 offset:38912
    ds_read_b64_tr_b16 v[58:59], v82 offset:39424
    buffer_load_dwordx4 v[128:131], v91, s[12:15], s70 offen offset:0 sc1
    v_mfma_f32_32x32x16_bf16 v[192:207], v[68:71], v[132:135], v[192:207]
    ds_read_b64_tr_b16 v[60:61], v83 offset:38912
    ds_read_b64_tr_b16 v[62:63], v83 offset:39424
    s_waitcnt vmcnt(14) lgkmcnt(4)
    v_mfma_f32_32x32x16_bf16 v[176:191], v[48:51], v[136:139], v[176:191]
    ds_read_b64_tr_b16 v[64:65], v82 offset:40960
    ds_read_b64_tr_b16 v[66:67], v82 offset:41472
    buffer_load_dwordx4 v[132:135], v91, s[12:15], s70 offen offset:1024 sc1
    v_mfma_f32_32x32x16_bf16 v[192:207], v[52:55], v[136:139], v[192:207]
    ds_read_b64_tr_b16 v[68:69], v83 offset:40960
    ds_read_b64_tr_b16 v[70:71], v83 offset:41472
    s_waitcnt vmcnt(14) lgkmcnt(4)
    v_mfma_f32_32x32x16_bf16 v[176:191], v[56:59], v[140:143], v[176:191]
    ds_read_b64_tr_b16 v[48:49], v82 offset:43008
    ds_read_b64_tr_b16 v[50:51], v82 offset:43520
    buffer_load_dwordx4 v[136:139], v91, s[12:15], s70 offen offset:2048 sc1
    v_mfma_f32_32x32x16_bf16 v[192:207], v[60:63], v[140:143], v[192:207]
    ds_read_b64_tr_b16 v[52:53], v83 offset:43008
    ds_read_b64_tr_b16 v[54:55], v83 offset:43520
    s_waitcnt vmcnt(14) lgkmcnt(4)
    v_mfma_f32_32x32x16_bf16 v[176:191], v[64:67], v[144:147], v[176:191]
    ds_read_b64_tr_b16 v[56:57], v82 offset:45056
    ds_read_b64_tr_b16 v[58:59], v82 offset:45568
    buffer_load_dwordx4 v[140:143], v91, s[12:15], s70 offen offset:3072 sc1
    s_add_u32 s70, s70, 4096
    v_mfma_f32_32x32x16_bf16 v[192:207], v[68:71], v[144:147], v[192:207]
    ds_read_b64_tr_b16 v[60:61], v83 offset:45056
    ds_read_b64_tr_b16 v[62:63], v83 offset:45568
    s_waitcnt vmcnt(14) lgkmcnt(4)
    v_mfma_f32_32x32x16_bf16 v[176:191], v[48:51], v[148:151], v[176:191]
    ds_read_b64_tr_b16 v[64:65], v82 offset:47104
    ds_read_b64_tr_b16 v[66:67], v82 offset:47616
    buffer_load_dwordx4 v[144:147], v91, s[12:15], s70 offen offset:0 sc1
    v_mfma_f32_32x32x16_bf16 v[192:207], v[52:55], v[148:151], v[192:207]
    ds_read_b64_tr_b16 v[68:69], v83 offset:47104
    ds_read_b64_tr_b16 v[70:71], v83 offset:47616
    s_waitcnt vmcnt(14) lgkmcnt(4)
    v_mfma_f32_32x32x16_bf16 v[176:191], v[56:59], v[152:155], v[176:191]
    ds_read_b64_tr_b16 v[48:49], v82 offset:49152
    ds_read_b64_tr_b16 v[50:51], v82 offset:49664
    buffer_load_dwordx4 v[148:151], v91, s[12:15], s70 offen offset:1024 sc1
    v_mfma_f32_32x32x16_bf16 v[192:207], v[60:63], v[152:155], v[192:207]
    ds_read_b64_tr_b16 v[52:53], v83 offset:49152
    ds_read_b64_tr_b16 v[54:55], v83 offset:49664
    s_waitcnt vmcnt(14) lgkmcnt(4)
    v_mfma_f32_32x32x16_bf16 v[176:191], v[64:67], v[156:159], v[176:191]
    ds_read_b64_tr_b16 v[56:57], v82 offset:51200
    ds_read_b64_tr_b16 v[58:59], v82 offset:51712
    buffer_load_dwordx4 v[152:155], v91, s[12:15], s70 offen offset:2048 sc1
    v_mfma_f32_32x32x16_bf16 v[192:207], v[68:71], v[156:159], v[192:207]
    ds_read_b64_tr_b16 v[60:61], v83 offset:51200
    ds_read_b64_tr_b16 v[62:63], v83 offset:51712
    s_waitcnt vmcnt(14) lgkmcnt(4)
    v_mfma_f32_32x32x16_bf16 v[176:191], v[48:51], v[96:99], v[176:191]
    ds_read_b64_tr_b16 v[64:65], v82 offset:53248
    ds_read_b64_tr_b16 v[66:67], v82 offset:53760
    buffer_load_dwordx4 v[156:159], v91, s[12:15], s70 offen offset:3072 sc1
    s_add_u32 s70, s70, 4096
    v_mfma_f32_32x32x16_bf16 v[192:207], v[52:55], v[96:99], v[192:207]
    ds_read_b64_tr_b16 v[68:69], v83 offset:53248
    ds_read_b64_tr_b16 v[70:71], v83 offset:53760
    s_waitcnt vmcnt(14) lgkmcnt(4)
    v_mfma_f32_32x32x16_bf16 v[176:191], v[56:59], v[100:103], v[176:191]
    ds_read_b64_tr_b16 v[48:49], v82 offset:55296
    ds_read_b64_tr_b16 v[50:51], v82 offset:55808
    buffer_load_dwordx4 v[96:99], v91, s[12:15], s70 offen offset:0 sc1
    v_mfma_f32_32x32x16_bf16 v[192:207], v[60:63], v[100:103], v[192:207]
    ds_read_b64_tr_b16 v[52:53], v83 offset:55296
    ds_read_b64_tr_b16 v[54:55], v83 offset:55808
    s_waitcnt vmcnt(14) lgkmcnt(4)
    v_mfma_f32_32x32x16_bf16 v[176:191], v[64:67], v[104:107], v[176:191]
    ds_read_b64_tr_b16 v[56:57], v82 offset:57344
    ds_read_b64_tr_b16 v[58:59], v82 offset:57856
    buffer_load_dwordx4 v[100:103], v91, s[12:15], s70 offen offset:1024 sc1
    v_mfma_f32_32x32x16_bf16 v[192:207], v[68:71], v[104:107], v[192:207]
    ds_read_b64_tr_b16 v[60:61], v83 offset:57344
    ds_read_b64_tr_b16 v[62:63], v83 offset:57856
    s_waitcnt vmcnt(14) lgkmcnt(4)
    v_mfma_f32_32x32x16_bf16 v[176:191], v[48:51], v[108:111], v[176:191]
    ds_read_b64_tr_b16 v[64:65], v82 offset:59392
    ds_read_b64_tr_b16 v[66:67], v82 offset:59904
    buffer_load_dwordx4 v[104:107], v91, s[12:15], s70 offen offset:2048 sc1
    v_mfma_f32_32x32x16_bf16 v[192:207], v[52:55], v[108:111], v[192:207]
    ds_read_b64_tr_b16 v[68:69], v83 offset:59392
    ds_read_b64_tr_b16 v[70:71], v83 offset:59904
    s_waitcnt vmcnt(14) lgkmcnt(4)
    v_mfma_f32_32x32x16_bf16 v[176:191], v[56:59], v[112:115], v[176:191]
    ds_read_b64_tr_b16 v[48:49], v82 offset:61440
    ds_read_b64_tr_b16 v[50:51], v82 offset:61952
    buffer_load_dwordx4 v[108:111], v91, s[12:15], s70 offen offset:3072 sc1
    s_add_u32 s70, s70, 4096
    v_mfma_f32_32x32x16_bf16 v[192:207], v[60:63], v[112:115], v[192:207]
    ds_read_b64_tr_b16 v[52:53], v83 offset:61440
    ds_read_b64_tr_b16 v[54:55], v83 offset:61952
    s_waitcnt vmcnt(14) lgkmcnt(4)
    v_mfma_f32_32x32x16_bf16 v[176:191], v[64:67], v[116:119], v[176:191]
    ds_read_b64_tr_b16 v[56:57], v82 offset:63488
    ds_read_b64_tr_b16 v[58:59], v82 offset:64000
    buffer_load_dwordx4 v[112:115], v91, s[12:15], s70 offen offset:0 sc1
    v_mfma_f32_32x32x16_bf16 v[192:207], v[68:71], v[116:119], v[192:207]
    ds_read_b64_tr_b16 v[60:61], v83 offset:63488
    ds_read_b64_tr_b16 v[62:63], v83 offset:64000
    s_waitcnt lgkmcnt(0)
    s_barrier
    s_waitcnt vmcnt(14)
    v_mfma_f32_32x32x16_bf16 v[176:191], v[48:51], v[120:123], v[176:191]
    ds_read_b64_tr_b16 v[64:65], v84 offset:0
    ds_read_b64_tr_b16 v[66:67], v84 offset:512
    buffer_load_dwordx4 v[116:119], v91, s[12:15], s70 offen offset:1024 sc1
    v_mfma_f32_32x32x16_bf16 v[192:207], v[52:55], v[120:123], v[192:207]
    ds_read_b64_tr_b16 v[68:69], v85 offset:0
    ds_read_b64_tr_b16 v[70:71], v85 offset:512
    s_waitcnt vmcnt(14)
    v_mfma_f32_32x32x16_bf16 v[176:191], v[56:59], v[124:127], v[176:191]
    ds_read_b64_tr_b16 v[48:49], v84 offset:2048
    ds_read_b64_tr_b16 v[50:51], v84 offset:2560
    buffer_load_dwordx4 v[120:123], v91, s[12:15], s70 offen offset:2048 sc1
    v_mfma_f32_32x32x16_bf16 v[192:207], v[60:63], v[124:127], v[192:207]
    ds_read_b64_tr_b16 v[52:53], v85 offset:2048
    ds_read_b64_tr_b16 v[54:55], v85 offset:2560
    s_waitcnt vmcnt(14) lgkmcnt(4)
    v_mfma_f32_32x32x16_bf16 v[176:191], v[64:67], v[128:131], v[176:191]
    ds_read_b64_tr_b16 v[56:57], v84 offset:4096
    ds_read_b64_tr_b16 v[58:59], v84 offset:4608
    buffer_load_dwordx4 v[124:127], v91, s[12:15], s70 offen offset:3072 sc1
    s_add_u32 s70, s70, 4096
    v_mfma_f32_32x32x16_bf16 v[192:207], v[68:71], v[128:131], v[192:207]
    ds_read_b64_tr_b16 v[60:61], v85 offset:4096
    ds_read_b64_tr_b16 v[62:63], v85 offset:4608
    s_waitcnt vmcnt(14) lgkmcnt(4)
    v_mfma_f32_32x32x16_bf16 v[176:191], v[48:51], v[132:135], v[176:191]
    ds_read_b64_tr_b16 v[64:65], v84 offset:6144
    ds_read_b64_tr_b16 v[66:67], v84 offset:6656
    buffer_load_dwordx4 v[128:131], v91, s[12:15], s70 offen offset:0 sc1
    v_mfma_f32_32x32x16_bf16 v[192:207], v[52:55], v[132:135], v[192:207]
    ds_read_b64_tr_b16 v[68:69], v85 offset:6144
    ds_read_b64_tr_b16 v[70:71], v85 offset:6656
    s_waitcnt vmcnt(14) lgkmcnt(4)
    v_mfma_f32_32x32x16_bf16 v[176:191], v[56:59], v[136:139], v[176:191]
    ds_read_b64_tr_b16 v[48:49], v84 offset:8192
    ds_read_b64_tr_b16 v[50:51], v84 offset:8704
    buffer_load_dwordx4 v[132:135], v91, s[12:15], s70 offen offset:1024 sc1
    v_mfma_f32_32x32x16_bf16 v[192:207], v[60:63], v[136:139], v[192:207]
    ds_read_b64_tr_b16 v[52:53], v85 offset:8192
    ds_read_b64_tr_b16 v[54:55], v85 offset:8704
    s_waitcnt vmcnt(14) lgkmcnt(4)
    v_mfma_f32_32x32x16_bf16 v[176:191], v[64:67], v[140:143], v[176:191]
    ds_read_b64_tr_b16 v[56:57], v84 offset:10240
    ds_read_b64_tr_b16 v[58:59], v84 offset:10752
    buffer_load_dwordx4 v[136:139], v91, s[12:15], s70 offen offset:2048 sc1
    v_mfma_f32_32x32x16_bf16 v[192:207], v[68:71], v[140:143], v[192:207]
    ds_read_b64_tr_b16 v[60:61], v85 offset:10240
    ds_read_b64_tr_b16 v[62:63], v85 offset:10752
    s_waitcnt vmcnt(14) lgkmcnt(4)
    v_mfma_f32_32x32x16_bf16 v[176:191], v[48:51], v[144:147], v[176:191]
    ds_read_b64_tr_b16 v[64:65], v84 offset:12288
    ds_read_b64_tr_b16 v[66:67], v84 offset:12800
    buffer_load_dwordx4 v[140:143], v91, s[12:15], s70 offen offset:3072 sc1
    s_add_u32 s70, s70, 4096
    v_mfma_f32_32x32x16_bf16 v[192:207], v[52:55], v[144:147], v[192:207]
    ds_read_b64_tr_b16 v[68:69], v85 offset:12288
    ds_read_b64_tr_b16 v[70:71], v85 offset:12800
    s_waitcnt vmcnt(14) lgkmcnt(4)
    v_mfma_f32_32x32x16_bf16 v[176:191], v[56:59], v[148:151], v[176:191]
    ds_read_b64_tr_b16 v[48:49], v84 offset:14336
    ds_read_b64_tr_b16 v[50:51], v84 offset:14848
    buffer_load_dwordx4 v[144:147], v91, s[12:15], s70 offen offset:0 sc1
    v_mfma_f32_32x32x16_bf16 v[192:207], v[60:63], v[148:151], v[192:207]
    ds_read_b64_tr_b16 v[52:53], v85 offset:14336
    ds_read_b64_tr_b16 v[54:55], v85 offset:14848
    s_waitcnt vmcnt(14) lgkmcnt(4)
    v_mfma_f32_32x32x16_bf16 v[176:191], v[64:67], v[152:155], v[176:191]
    ds_read_b64_tr_b16 v[56:57], v84 offset:16384
    ds_read_b64_tr_b16 v[58:59], v84 offset:16896
    buffer_load_dwordx4 v[148:151], v91, s[12:15], s70 offen offset:1024 sc1
    v_mfma_f32_32x32x16_bf16 v[192:207], v[68:71], v[152:155], v[192:207]
    ds_read_b64_tr_b16 v[60:61], v85 offset:16384
    ds_read_b64_tr_b16 v[62:63], v85 offset:16896
    s_waitcnt vmcnt(14) lgkmcnt(4)
    v_mfma_f32_32x32x16_bf16 v[176:191], v[48:51], v[156:159], v[176:191]
    ds_read_b64_tr_b16 v[64:65], v84 offset:18432
    ds_read_b64_tr_b16 v[66:67], v84 offset:18944
    buffer_load_dwordx4 v[152:155], v91, s[12:15], s70 offen offset:2048 sc1
    v_mfma_f32_32x32x16_bf16 v[192:207], v[52:55], v[156:159], v[192:207]
    ds_read_b64_tr_b16 v[68:69], v85 offset:18432
    ds_read_b64_tr_b16 v[70:71], v85 offset:18944
    s_waitcnt vmcnt(14) lgkmcnt(4)
    v_mfma_f32_32x32x16_bf16 v[176:191], v[56:59], v[96:99], v[176:191]
    ds_read_b64_tr_b16 v[48:49], v84 offset:20480
    ds_read_b64_tr_b16 v[50:51], v84 offset:20992
    buffer_load_dwordx4 v[156:159], v91, s[12:15], s70 offen offset:3072 sc1
    s_add_u32 s70, s70, 4096
    v_mfma_f32_32x32x16_bf16 v[192:207], v[60:63], v[96:99], v[192:207]
    ds_read_b64_tr_b16 v[52:53], v85 offset:20480
    ds_read_b64_tr_b16 v[54:55], v85 offset:20992
    s_waitcnt vmcnt(14) lgkmcnt(4)
    v_mfma_f32_32x32x16_bf16 v[176:191], v[64:67], v[100:103], v[176:191]
    ds_read_b64_tr_b16 v[56:57], v84 offset:22528
    ds_read_b64_tr_b16 v[58:59], v84 offset:23040
    v_mfma_f32_32x32x16_bf16 v[192:207], v[68:71], v[100:103], v[192:207]
    ds_read_b64_tr_b16 v[60:61], v85 offset:22528
    ds_read_b64_tr_b16 v[62:63], v85 offset:23040
    s_waitcnt vmcnt(13) lgkmcnt(4)
    v_mfma_f32_32x32x16_bf16 v[176:191], v[48:51], v[104:107], v[176:191]
    ds_read_b64_tr_b16 v[64:65], v84 offset:24576
    ds_read_b64_tr_b16 v[66:67], v84 offset:25088
    v_mfma_f32_32x32x16_bf16 v[192:207], v[52:55], v[104:107], v[192:207]
    ds_read_b64_tr_b16 v[68:69], v85 offset:24576
    ds_read_b64_tr_b16 v[70:71], v85 offset:25088
    s_waitcnt vmcnt(12) lgkmcnt(4)
    v_mfma_f32_32x32x16_bf16 v[176:191], v[56:59], v[108:111], v[176:191]
    ds_read_b64_tr_b16 v[48:49], v84 offset:26624
    ds_read_b64_tr_b16 v[50:51], v84 offset:27136
    v_mfma_f32_32x32x16_bf16 v[192:207], v[60:63], v[108:111], v[192:207]
    ds_read_b64_tr_b16 v[52:53], v85 offset:26624
    ds_read_b64_tr_b16 v[54:55], v85 offset:27136
    s_waitcnt vmcnt(11) lgkmcnt(4)
    v_mfma_f32_32x32x16_bf16 v[176:191], v[64:67], v[112:115], v[176:191]
    ds_read_b64_tr_b16 v[56:57], v84 offset:28672
    ds_read_b64_tr_b16 v[58:59], v84 offset:29184
    v_mfma_f32_32x32x16_bf16 v[192:207], v[68:71], v[112:115], v[192:207]
    ds_read_b64_tr_b16 v[60:61], v85 offset:28672
    ds_read_b64_tr_b16 v[62:63], v85 offset:29184
    s_waitcnt vmcnt(10) lgkmcnt(4)
    v_mfma_f32_32x32x16_bf16 v[176:191], v[48:51], v[116:119], v[176:191]
    ds_read_b64_tr_b16 v[64:65], v84 offset:30720
    ds_read_b64_tr_b16 v[66:67], v84 offset:31232
    v_mfma_f32_32x32x16_bf16 v[192:207], v[52:55], v[116:119], v[192:207]
    ds_read_b64_tr_b16 v[68:69], v85 offset:30720
    ds_read_b64_tr_b16 v[70:71], v85 offset:31232
    s_waitcnt vmcnt(9) lgkmcnt(4)
    v_mfma_f32_32x32x16_bf16 v[176:191], v[56:59], v[120:123], v[176:191]
    ds_read_b64_tr_b16 v[48:49], v84 offset:32768
    ds_read_b64_tr_b16 v[50:51], v84 offset:33280
    v_mfma_f32_32x32x16_bf16 v[192:207], v[60:63], v[120:123], v[192:207]
    ds_read_b64_tr_b16 v[52:53], v85 offset:32768
    ds_read_b64_tr_b16 v[54:55], v85 offset:33280
    s_waitcnt vmcnt(8) lgkmcnt(4)
    v_mfma_f32_32x32x16_bf16 v[176:191], v[64:67], v[124:127], v[176:191]
    ds_read_b64_tr_b16 v[56:57], v84 offset:34816
    ds_read_b64_tr_b16 v[58:59], v84 offset:35328
    v_mfma_f32_32x32x16_bf16 v[192:207], v[68:71], v[124:127], v[192:207]
    ds_read_b64_tr_b16 v[60:61], v85 offset:34816
    ds_read_b64_tr_b16 v[62:63], v85 offset:35328
    s_waitcnt vmcnt(7) lgkmcnt(4)
    v_mfma_f32_32x32x16_bf16 v[176:191], v[48:51], v[128:131], v[176:191]
    ds_read_b64_tr_b16 v[64:65], v84 offset:36864
    ds_read_b64_tr_b16 v[66:67], v84 offset:37376
    v_mfma_f32_32x32x16_bf16 v[192:207], v[52:55], v[128:131], v[192:207]
    ds_read_b64_tr_b16 v[68:69], v85 offset:36864
    ds_read_b64_tr_b16 v[70:71], v85 offset:37376
    s_waitcnt vmcnt(6) lgkmcnt(4)
    v_mfma_f32_32x32x16_bf16 v[176:191], v[56:59], v[132:135], v[176:191]
    ds_read_b64_tr_b16 v[48:49], v84 offset:38912
    ds_read_b64_tr_b16 v[50:51], v84 offset:39424
    v_mfma_f32_32x32x16_bf16 v[192:207], v[60:63], v[132:135], v[192:207]
    ds_read_b64_tr_b16 v[52:53], v85 offset:38912
    ds_read_b64_tr_b16 v[54:55], v85 offset:39424
    s_waitcnt vmcnt(5) lgkmcnt(4)
    v_mfma_f32_32x32x16_bf16 v[176:191], v[64:67], v[136:139], v[176:191]
    ds_read_b64_tr_b16 v[56:57], v84 offset:40960
    ds_read_b64_tr_b16 v[58:59], v84 offset:41472
    v_mfma_f32_32x32x16_bf16 v[192:207], v[68:71], v[136:139], v[192:207]
    ds_read_b64_tr_b16 v[60:61], v85 offset:40960
    ds_read_b64_tr_b16 v[62:63], v85 offset:41472
    s_waitcnt vmcnt(4) lgkmcnt(4)
    v_mfma_f32_32x32x16_bf16 v[176:191], v[48:51], v[140:143], v[176:191]
    ds_read_b64_tr_b16 v[64:65], v84 offset:43008
    ds_read_b64_tr_b16 v[66:67], v84 offset:43520
    v_mfma_f32_32x32x16_bf16 v[192:207], v[52:55], v[140:143], v[192:207]
    ds_read_b64_tr_b16 v[68:69], v85 offset:43008
    ds_read_b64_tr_b16 v[70:71], v85 offset:43520
    s_waitcnt vmcnt(3) lgkmcnt(4)
    v_mfma_f32_32x32x16_bf16 v[176:191], v[56:59], v[144:147], v[176:191]
    ds_read_b64_tr_b16 v[48:49], v84 offset:45056
    ds_read_b64_tr_b16 v[50:51], v84 offset:45568
    v_mfma_f32_32x32x16_bf16 v[192:207], v[60:63], v[144:147], v[192:207]
    ds_read_b64_tr_b16 v[52:53], v85 offset:45056
    ds_read_b64_tr_b16 v[54:55], v85 offset:45568
    s_waitcnt vmcnt(2) lgkmcnt(4)
    v_mfma_f32_32x32x16_bf16 v[176:191], v[64:67], v[148:151], v[176:191]
    ds_read_b64_tr_b16 v[56:57], v84 offset:47104
    ds_read_b64_tr_b16 v[58:59], v84 offset:47616
    v_mfma_f32_32x32x16_bf16 v[192:207], v[68:71], v[148:151], v[192:207]
    ds_read_b64_tr_b16 v[60:61], v85 offset:47104
    ds_read_b64_tr_b16 v[62:63], v85 offset:47616
    v_mov_b32 v10, 160456
    v_mov_b32 v11, 1
    s_mov_b64 exec, 1
    ds_add_u32 v10, v11
    s_mov_b64 exec, -1
    s_waitcnt vmcnt(1) lgkmcnt(5)
    v_mfma_f32_32x32x16_bf16 v[176:191], v[48:51], v[152:155], v[176:191]
    v_mfma_f32_32x32x16_bf16 v[192:207], v[52:55], v[152:155], v[192:207]
    s_waitcnt vmcnt(0) lgkmcnt(1)
    v_mfma_f32_32x32x16_bf16 v[176:191], v[56:59], v[156:159], v[176:191]
    v_mfma_f32_32x32x16_bf16 v[192:207], v[60:63], v[156:159], v[192:207]
    s_setprio 3
    v_mov_b32 v68, 0xbdd2d3e8
    v_mov_b32 v70, 0xc0135761
    s_mul_i32 s58, s47, 80
    s_lshl_b32 s59, s48, 2
    s_add_u32 s59, s59, s44
    s_lshl_b32 s59, s59, 1
    s_add_u32 s58, s58, s59
    s_lshl_b32 s58, s58, 10
    s_add_u32 s58, s58, 14745600
    s_add_u32 s59, s58, 40960
    v_pk_mul_f32 v[96:97], v[176:177], v[176:177]
    v_pk_mul_f32 v[98:99], v[178:179], v[178:179]
    v_pk_mul_f32 v[100:101], v[180:181], v[180:181]
    v_pk_mul_f32 v[102:103], v[182:183], v[182:183]
    v_pk_fma_f32 v[96:97], v[96:97], v[68:69], v[70:71] op_sel_hi:[1,0,0]
    v_pk_fma_f32 v[98:99], v[98:99], v[68:69], v[70:71] op_sel_hi:[1,0,0]
    v_pk_fma_f32 v[100:101], v[100:101], v[68:69], v[70:71] op_sel_hi:[1,0,0]
    v_pk_fma_f32 v[102:103], v[102:103], v[68:69], v[70:71] op_sel_hi:[1,0,0]
    v_pk_mul_f32 v[96:97], v[96:97], v[176:177]
    v_pk_mul_f32 v[98:99], v[98:99], v[178:179]
    v_pk_mul_f32 v[100:101], v[100:101], v[180:181]
    v_pk_mul_f32 v[102:103], v[102:103], v[182:183]
    v_exp_f32 v96, v96
    v_exp_f32 v97, v97
    v_exp_f32 v98, v98
    v_exp_f32 v99, v99
    v_exp_f32 v100, v100
    v_exp_f32 v101, v101
    v_exp_f32 v102, v102
    v_exp_f32 v103, v103
    v_pk_add_f32 v[96:97], v[96:97], 1.0 op_sel_hi:[1,0]
    v_pk_add_f32 v[98:99], v[98:99], 1.0 op_sel_hi:[1,0]
    v_pk_add_f32 v[100:101], v[100:101], 1.0 op_sel_hi:[1,0]
    v_pk_add_f32 v[102:103], v[102:103], 1.0 op_sel_hi:[1,0]
    v_rcp_f32 v96, v96
    v_rcp_f32 v97, v97
    v_rcp_f32 v98, v98
    v_rcp_f32 v99, v99
    v_rcp_f32 v100, v100
    v_rcp_f32 v101, v101
    v_rcp_f32 v102, v102
    v_rcp_f32 v103, v103
    v_pk_mul_f32 v[176:177], v[176:177], v[96:97]
    v_pk_mul_f32 v[178:179], v[178:179], v[98:99]
    v_pk_mul_f32 v[180:181], v[180:181], v[100:101]
    v_pk_mul_f32 v[182:183], v[182:183], v[102:103]
    v_cvt_pk_bf16_f32 v176, v176, v177
    v_cvt_pk_bf16_f32 v177, v178, v179
    v_cvt_pk_bf16_f32 v178, v180, v181
    v_cvt_pk_bf16_f32 v179, v182, v183
    buffer_store_dwordx4 v[176:179], v88, s[12:15], s58 offen offset:0 sc1
    v_pk_mul_f32 v[104:105], v[184:185], v[184:185]
    v_pk_mul_f32 v[106:107], v[186:187], v[186:187]
    v_pk_mul_f32 v[108:109], v[188:189], v[188:189]
    v_pk_mul_f32 v[110:111], v[190:191], v[190:191]
    v_pk_fma_f32 v[104:105], v[104:105], v[68:69], v[70:71] op_sel_hi:[1,0,0]
    v_pk_fma_f32 v[106:107], v[106:107], v[68:69], v[70:71] op_sel_hi:[1,0,0]
    v_pk_fma_f32 v[108:109], v[108:109], v[68:69], v[70:71] op_sel_hi:[1,0,0]
    v_pk_fma_f32 v[110:111], v[110:111], v[68:69], v[70:71] op_sel_hi:[1,0,0]
    v_pk_mul_f32 v[104:105], v[104:105], v[184:185]
    v_pk_mul_f32 v[106:107], v[106:107], v[186:187]
    v_pk_mul_f32 v[108:109], v[108:109], v[188:189]
    v_pk_mul_f32 v[110:111], v[110:111], v[190:191]
    v_exp_f32 v104, v104
    v_exp_f32 v105, v105
    v_exp_f32 v106, v106
    v_exp_f32 v107, v107
    v_exp_f32 v108, v108
    v_exp_f32 v109, v109
    v_exp_f32 v110, v110
    v_exp_f32 v111, v111
    v_pk_add_f32 v[104:105], v[104:105], 1.0 op_sel_hi:[1,0]
    v_pk_add_f32 v[106:107], v[106:107], 1.0 op_sel_hi:[1,0]
    v_pk_add_f32 v[108:109], v[108:109], 1.0 op_sel_hi:[1,0]
    v_pk_add_f32 v[110:111], v[110:111], 1.0 op_sel_hi:[1,0]
    v_rcp_f32 v104, v104
    v_rcp_f32 v105, v105
    v_rcp_f32 v106, v106
    v_rcp_f32 v107, v107
    v_rcp_f32 v108, v108
    v_rcp_f32 v109, v109
    v_rcp_f32 v110, v110
    v_rcp_f32 v111, v111
    v_pk_mul_f32 v[184:185], v[184:185], v[104:105]
    v_pk_mul_f32 v[186:187], v[186:187], v[106:107]
    v_pk_mul_f32 v[188:189], v[188:189], v[108:109]
    v_pk_mul_f32 v[190:191], v[190:191], v[110:111]
    v_cvt_pk_bf16_f32 v184, v184, v185
    v_cvt_pk_bf16_f32 v185, v186, v187
    v_cvt_pk_bf16_f32 v186, v188, v189
    v_cvt_pk_bf16_f32 v187, v190, v191
    buffer_store_dwordx4 v[184:187], v88, s[12:15], s58 offen offset:512 sc1
    v_pk_mul_f32 v[112:113], v[192:193], v[192:193]
    v_pk_mul_f32 v[114:115], v[194:195], v[194:195]
    v_pk_mul_f32 v[116:117], v[196:197], v[196:197]
    v_pk_mul_f32 v[118:119], v[198:199], v[198:199]
    v_pk_fma_f32 v[112:113], v[112:113], v[68:69], v[70:71] op_sel_hi:[1,0,0]
    v_pk_fma_f32 v[114:115], v[114:115], v[68:69], v[70:71] op_sel_hi:[1,0,0]
    v_pk_fma_f32 v[116:117], v[116:117], v[68:69], v[70:71] op_sel_hi:[1,0,0]
    v_pk_fma_f32 v[118:119], v[118:119], v[68:69], v[70:71] op_sel_hi:[1,0,0]
    v_pk_mul_f32 v[112:113], v[112:113], v[192:193]
    v_pk_mul_f32 v[114:115], v[114:115], v[194:195]
    v_pk_mul_f32 v[116:117], v[116:117], v[196:197]
    v_pk_mul_f32 v[118:119], v[118:119], v[198:199]
    v_exp_f32 v112, v112
    v_exp_f32 v113, v113
    v_exp_f32 v114, v114
    v_exp_f32 v115, v115
    v_exp_f32 v116, v116
    v_exp_f32 v117, v117
    v_exp_f32 v118, v118
    v_exp_f32 v119, v119
    v_pk_add_f32 v[112:113], v[112:113], 1.0 op_sel_hi:[1,0]
    v_pk_add_f32 v[114:115], v[114:115], 1.0 op_sel_hi:[1,0]
    v_pk_add_f32 v[116:117], v[116:117], 1.0 op_sel_hi:[1,0]
    v_pk_add_f32 v[118:119], v[118:119], 1.0 op_sel_hi:[1,0]
    v_rcp_f32 v112, v112
    v_rcp_f32 v113, v113
    v_rcp_f32 v114, v114
    v_rcp_f32 v115, v115
    v_rcp_f32 v116, v116
    v_rcp_f32 v117, v117
    v_rcp_f32 v118, v118
    v_rcp_f32 v119, v119
    v_pk_mul_f32 v[192:193], v[192:193], v[112:113]
    v_pk_mul_f32 v[194:195], v[194:195], v[114:115]
    v_pk_mul_f32 v[196:197], v[196:197], v[116:117]
    v_pk_mul_f32 v[198:199], v[198:199], v[118:119]
    v_cvt_pk_bf16_f32 v192, v192, v193
    v_cvt_pk_bf16_f32 v193, v194, v195
    v_cvt_pk_bf16_f32 v194, v196, v197
    v_cvt_pk_bf16_f32 v195, v198, v199
    buffer_store_dwordx4 v[192:195], v88, s[12:15], s59 offen offset:0 sc1
    v_pk_mul_f32 v[120:121], v[200:201], v[200:201]
    v_pk_mul_f32 v[122:123], v[202:203], v[202:203]
    v_pk_mul_f32 v[124:125], v[204:205], v[204:205]
    v_pk_mul_f32 v[126:127], v[206:207], v[206:207]
    v_pk_fma_f32 v[120:121], v[120:121], v[68:69], v[70:71] op_sel_hi:[1,0,0]
    v_pk_fma_f32 v[122:123], v[122:123], v[68:69], v[70:71] op_sel_hi:[1,0,0]
    v_pk_fma_f32 v[124:125], v[124:125], v[68:69], v[70:71] op_sel_hi:[1,0,0]
    v_pk_fma_f32 v[126:127], v[126:127], v[68:69], v[70:71] op_sel_hi:[1,0,0]
    v_pk_mul_f32 v[120:121], v[120:121], v[200:201]
    v_pk_mul_f32 v[122:123], v[122:123], v[202:203]
    v_pk_mul_f32 v[124:125], v[124:125], v[204:205]
    v_pk_mul_f32 v[126:127], v[126:127], v[206:207]
    v_exp_f32 v120, v120
    v_exp_f32 v121, v121
    v_exp_f32 v122, v122
    v_exp_f32 v123, v123
    v_exp_f32 v124, v124
    v_exp_f32 v125, v125
    v_exp_f32 v126, v126
    v_exp_f32 v127, v127
    v_pk_add_f32 v[120:121], v[120:121], 1.0 op_sel_hi:[1,0]
    v_pk_add_f32 v[122:123], v[122:123], 1.0 op_sel_hi:[1,0]
    v_pk_add_f32 v[124:125], v[124:125], 1.0 op_sel_hi:[1,0]
    v_pk_add_f32 v[126:127], v[126:127], 1.0 op_sel_hi:[1,0]
    v_rcp_f32 v120, v120
    v_rcp_f32 v121, v121
    v_rcp_f32 v122, v122
    v_rcp_f32 v123, v123
    v_rcp_f32 v124, v124
    v_rcp_f32 v125, v125
    v_rcp_f32 v126, v126
    v_rcp_f32 v127, v127
    v_pk_mul_f32 v[200:201], v[200:201], v[120:121]
    v_pk_mul_f32 v[202:203], v[202:203], v[122:123]
    v_pk_mul_f32 v[204:205], v[204:205], v[124:125]
    v_pk_mul_f32 v[206:207], v[206:207], v[126:127]
    v_cvt_pk_bf16_f32 v200, v200, v201
    v_cvt_pk_bf16_f32 v201, v202, v203
    v_cvt_pk_bf16_f32 v202, v204, v205
    v_cvt_pk_bf16_f32 v203, v206, v207
    buffer_store_dwordx4 v[200:203], v88, s[12:15], s59 offen offset:512 sc1
    s_mul_i32 s59, s48, 13
    s_lshr_b32 s59, s59, 3
    s_lshl_b32 s59, s59, 10
    s_add_u32 s59, s59, 393344
    s_cmp_ge_u32 s52, 135
    s_cselect_b32 s59, 0x70000000, s59
    v_and_b32 v4, 31, v1
    v_lshrrev_b32 v5, 5, v1
    v_lshlrev_b32 v4, 13, v4
    v_lshl_add_u32 v4, v5, 10, v4
    v_add_u32 v252, s59, v4
    v_add_u32 v253, 2048, v252
    s_and_b32 s58, s48, 1
    s_lshl_b32 s58, s58, 5
    v_mov_b32 v5, 0x7f000000
    v_cmp_gt_u32 vcc, s58, v1
    s_nop 1
    v_cndmask_b32 v253, v5, v253, vcc
    s_mov_b32 s97, 8000000
ls_28:
    ds_read_b32 v12, v10
    s_waitcnt lgkmcnt(0)
    v_readfirstlane_b32 s100, v12
    s_cmp_ge_u32 s100, 4
    s_cbranch_scc1 ok_29
    s_sub_u32 s97, s97, 1
    s_cbranch_scc0 ls_28
    v_mov_b32 v14, 32
    v_mov_b32 v15, 228
    buffer_store_dword v15, v14, s[40:43], 0 offen
ok_29:
    v_lshlrev_b32 v20, 4, v1
    v_add_u32 v21, 4096, v20
    s_mul_i32 s71, s44, 36864
    s_lshr_b32 s57, s45, 1
    s_lshl_b32 s57, s57, 3
    s_bfe_u32 s58, s46, 0x30001
    s_add_u32 s72, s57, s58
    s_lshr_b32 s57, s46, 4
    s_xor_b32 s58, s58, s57
    s_and_b32 s58, s58, 1
    s_and_b32 s57, s46, 1
    s_lshl_b32 s57, s57, 1
    s_add_u32 s58, s58, s57
    s_and_b32 s57, s45, 1
    s_lshl_b32 s57, s57, 2
    s_add_u32 s73, s57, s58
    s_lshl_b32 s74, s44, 17
    s_lshl_b32 s57, s72, 7
    s_add_u32 s74, s74, s57
    v_lshrrev_b32 v6, 4, v1
    v_lshrrev_b32 v4, 3, v1
    v_lshlrev_b32 v4, 12, v4
    v_bfe_u32 v5, v1, 1, 2
    v_xor_b32 v5, v5, v6
    v_lshl_add_u32 v4, v5, 5, v4
    v_and_b32 v5, 1, v1
    v_lshl_add_u32 v16, v5, 4, v4
    v_add_u32 v17, 31744, v16
    v_add_u32 v18, 63488, v16
    v_add_u32 v19, 95232, v16
    s_waitcnt vmcnt(0)
    v_mov_b32 v10, 160460
    v_mov_b32 v11, 1
    s_mov_b64 exec, 1
    ds_add_rtn_u32 v12, v10, v11
    s_mov_b64 exec, -1
    s_waitcnt lgkmcnt(0)
    v_readfirstlane_b32 s100, v12
    s_cmp_eq_u32 s100, 3
    s_cbranch_scc0 L_30
    v_mov_b32 v10, 1
    buffer_atomic_add v10, v252, s[12:15], 0 offen sc1
    v_mov_b32 v10, 1
    buffer_atomic_add v10, v253, s[12:15], 0 offen sc1
L_30:
    s_setprio 0
    s_branch L_C0
L_YB:
    s_setprio 2
    s_cmp_lt_u32 s52, 120
    s_cbranch_scc0 L_31
    s_mul_i32 s53, s52, 137
    s_lshr_b32 s53, s53, 11
    s_mul_i32 s54, s53, 15
    s_sub_u32 s54, s52, s54
    s_lshl_b32 s59, s53, 2
    s_add_u32 s59, s59, s62
    s_mul_i32 s59, s59, 76800
    s_lshl_b32 s56, s54, 8
    s_add_u32 s59, s59, s56
    v_lshrrev_b32 v10, 4, v1
    v_mul_u32_u24 v10, 3840, v10
    v_and_b32 v5, 15, v1
    v_lshl_add_u32 v10, v5, 4, v10
    buffer_load_dwordx4 v[176:179], v10, s[8:11], s59 offen
    s_add_u32 s59, s59, 15360
    buffer_load_dwordx4 v[180:183], v10, s[8:11], s59 offen
    s_add_u32 s59, s59, 15360
    buffer_load_dwordx4 v[184:187], v10, s[8:11], s59 offen
    s_add_u32 s59, s59, 15360
    buffer_load_dwordx4 v[188:191], v10, s[8:11], s59 offen
    s_add_u32 s59, s59, 15360
    buffer_load_dwordx4 v[192:195], v10, s[8:11], s59 offen
    s_add_u32 s59, s59, 15360
L_31:
    s_and_b32 s57, s52, 31
    s_lshl_b32 s57, s57, 2
    s_add_u32 s57, s57, s62
    s_lshl_b32 s57, s57, 7
    s_add_u32 s57, s57, 36864
    s_add_u32 s58, s57, 64
    s_mov_b32 s98, s50
    s_mov_b32 s99, s50
    s_mov_b32 s97, 400000
hp_32:
    s_load_dwordx16 s[64:79], s[12:13], s57 glc
    s_load_dwordx8 s[80:87], s[12:13], s58 glc
    s_waitcnt lgkmcnt(0)
    s_xor_b64 s[64:65], s[64:65], s[98:99]
    s_xor_b64 s[66:67], s[66:67], s[98:99]
    s_or_b64 s[64:65], s[64:65], s[66:67]
    s_xor_b64 s[68:69], s[68:69], s[98:99]
    s_or_b64 s[64:65], s[64:65], s[68:69]
    s_xor_b64 s[70:71], s[70:71], s[98:99]
    s_or_b64 s[64:65], s[64:65], s[70:71]
    s_xor_b64 s[72:73], s[72:73], s[98:99]
    s_or_b64 s[64:65], s[64:65], s[72:73]
    s_xor_b64 s[74:75], s[74:75], s[98:99]
    s_or_b64 s[64:65], s[64:65], s[74:75]
    s_xor_b64 s[76:77], s[76:77], s[98:99]
    s_or_b64 s[64:65], s[64:65], s[76:77]
    s_xor_b64 s[78:79], s[78:79], s[98:99]
    s_or_b64 s[64:65], s[64:65], s[78:79]
    s_xor_b64 s[80:81], s[80:81], s[98:99]
    s_or_b64 s[64:65], s[64:65], s[80:81]
    s_xor_b64 s[82:83], s[82:83], s[98:99]
    s_or_b64 s[64:65], s[64:65], s[82:83]
    s_xor_b64 s[84:85], s[84:85], s[98:99]
    s_or_b64 s[64:65], s[64:65], s[84:85]
    s_cbranch_scc0 ok_33
    s_sleep 4
    s_sub_u32 s97, s97, 1
    s_cbranch_scc0 hp_32
    v_mov_b32 v14, 28
    v_mov_b32 v15, 227
    buffer_store_dword v15, v14, s[40:43], 0 offen
ok_33:
    s_cmp_lt_u32 s52, 120
    s_cbranch_scc0 L_34
    v_and_b32 v5, 15, v1
    s_lshl_b32 s57, s53, 4
    s_add_u32 s57, s57, s54
    s_lshl_b32 s57, s57, 2
    s_add_u32 s57, s57, s62
    s_lshl_b32 s57, s57, 8
    s_add_u32 s57, s57, 655360
    v_mov_b32 v6, 0x3f80
    v_mov_b32 v7, 0x3f800000
    v_mov_b32 v9, 0
    v_cmp_eq_u32 vcc, 0, v5
    s_nop 1
    v_cndmask_b32 v10, v9, v6, vcc
    v_cmp_eq_u32 vcc, 1, v5
    s_nop 1
    v_cndmask_b32 v76, v10, v7, vcc
    v_cmp_eq_u32 vcc, 2, v5
    s_nop 1
    v_cndmask_b32 v10, v9, v6, vcc
    v_cmp_eq_u32 vcc, 3, v5
    s_nop 1
    v_cndmask_b32 v77, v10, v7, vcc
    v_cmp_eq_u32 vcc, 4, v5
    s_nop 1
    v_cndmask_b32 v10, v9, v6, vcc
    v_cmp_eq_u32 vcc, 5, v5
    s_nop 1
    v_cndmask_b32 v78, v10, v7, vcc
    v_cmp_eq_u32 vcc, 6, v5
    s_nop 1
    v_cndmask_b32 v10, v9, v6, vcc
    v_cmp_eq_u32 vcc, 7, v5
    s_nop 1
    v_cndmask_b32 v79, v10, v7, vcc
    v_lshrrev_b32 v6, 4, v1
    v_lshlrev_b32 v6, 7, v6
    v_lshl_add_u32 v6, v5, 2, v6
    s_lshl_b32 s58, s62, 9
    s_add_u32 s58, s58, 151552
    v_add_u32 v4, s58, v6
    s_waitcnt vmcnt(0)
    v_mfma_f32_16x16x32_bf16 v[72:75], v[176:179], v[76:79], 0
    v_mfma_f32_16x16x32_bf16 v[72:75], v[180:183], v[76:79], v[72:75]
    v_mfma_f32_16x16x32_bf16 v[72:75], v[184:187], v[76:79], v[72:75]
    v_mfma_f32_16x16x32_bf16 v[72:75], v[188:191], v[76:79], v[72:75]
    v_mfma_f32_16x16x32_bf16 v[72:75], v[192:195], v[76:79], v[72:75]
    s_mov_b32 exec_lo, 0x00ff00ff
    s_mov_b32 exec_hi, 0x00ff00ff
    s_nop 5
    ds_write_b32 v4, v72
    ds_write_b32 v4, v73 offset:32
    ds_write_b32 v4, v74 offset:64
    ds_write_b32 v4, v75 offset:96
    s_mov_b64 exec, -1
    s_lshl_b32 s58, s62, 7
    s_add_u32 s58, s58, 151552
    v_lshl_add_u32 v4, v5, 3, s58
    v_lshlrev_b32 v5, 4, v5
    v_mov_b32 v10, 160472
    v_mov_b32 v11, 1
    s_mov_b64 exec, 1
    ds_add_u32 v10, v11
    s_mov_b64 exec, -1
    s_mov_b32 s97, 8000000
ls_35:
    ds_read_b32 v12, v10
    s_waitcnt lgkmcnt(0)
    v_readfirstlane_b32 s100, v12
    s_cmp_ge_u32 s100, 4
    s_cbranch_scc1 ok_36
    s_sub_u32 s97, s97, 1
    s_cbranch_scc0 ls_35
    v_mov_b32 v14, 52
    v_mov_b32 v15, 233
    buffer_store_dword v15, v14, s[40:43], 0 offen
ok_36:
    ds_read_b64 v[160:161], v4 offset:0
    ds_read_b64 v[162:163], v4 offset:512
    ds_read_b64 v[164:165], v4 offset:1024
    ds_read_b64 v[166:167], v4 offset:1536
    v_mov_b32 v74, s50
    v_mov_b32 v75, s51
    s_waitcnt lgkmcnt(0)
    v_pk_add_f32 v[160:161], v[160:161], v[162:163]
    v_pk_add_f32 v[164:165], v[164:165], v[166:167]
    v_pk_add_f32 v[72:73], v[160:161], v[164:165]
    s_mov_b64 exec, 0xffff
    buffer_store_dwordx4 v[72:75], v5, s[12:15], s57 offen sc1
    s_mov_b64 exec, -1
L_34:
    s_setprio 0
    s_mul_i32 s57, s62, 320
    s_add_u32 s57, s57, s48
    s_add_u32 s57, s57, 1152
    s_mul_i32 s57, s57, 3456
    s_lshl_b32 s58, s47, 7
    s_add_u32 s57, s57, s58
    v_mul_u32_u24 v10, 17280, v1
    buffer_load_dword v255, v10, s[16:19], s57 offen
    s_add_u32 s57, s57, 4423680
    buffer_load_dword v255, v10, s[16:19], s57 offen
    s_barrier
    s_barrier
    s_barrier
    s_barrier
    s_barrier
    s_barrier
    s_barrier
    s_barrier
    s_barrier
    s_barrier
    s_barrier
    s_barrier
    s_branch L_att2
L_YQ:
    s_setprio 2
    v_bfe_u32 v8, v1, 2, 2
    s_and_b32 s60, s62, 1
    s_lshr_b32 s61, s62, 1
    v_and_b32 v3, 31, v1
    v_lshrrev_b32 v4, 5, v1
    s_mul_i32 s56, s60, 24576
    v_lshl_add_u32 v6, v3, 7, s56
    v_bfe_u32 v7, v1, 1, 3
    v_xor_b32 v7, v7, v4
    v_mul_u32_u24 v9, 6144, v4
    v_lshl_add_u32 v9, v8, 8, v9
    v_bfe_u32 v5, v1, 4, 1
    v_lshl_add_u32 v9, v5, 5, v9
    v_and_b32 v10, 3, v1
    v_lshl_add_u32 v9, v10, 3, v9
    v_add_u32 v9, 4096, v9
    s_lshl_b32 s56, s61, 1
    v_xor_b32 v10, s56, v8
    v_lshl_add_u32 v204, v10, 6, v9
    v_xor_b32 v10, 1, v10
    v_lshl_add_u32 v205, v10, 6, v9
    v_add_u32 v206, 49152, v204
    v_add_u32 v207, 49152, v205
    v_add_u32 v208, 98304, v204
    v_add_u32 v209, 98304, v205
    v_xor_b32 v10, 0, v7
    v_lshl_add_u32 v192, v10, 4, v6
    v_add_u32 v196, 49152, v192
    v_add_u32 v200, 98304, v192
    v_xor_b32 v10, 2, v7
    v_lshl_add_u32 v193, v10, 4, v6
    v_add_u32 v197, 49152, v193
    v_add_u32 v201, 98304, v193
    v_xor_b32 v10, 4, v7
    v_lshl_add_u32 v194, v10, 4, v6
    v_add_u32 v198, 49152, v194
    v_add_u32 v202, 98304, v194
    v_xor_b32 v10, 6, v7
    v_lshl_add_u32 v195, v10, 4, v6
    v_add_u32 v199, 49152, v195
    v_add_u32 v203, 98304, v195
    s_lshl_b32 s57, s47, 1
    s_add_u32 s57, s57, s60
    s_lshl_b32 s57, s57, 11
    s_add_u32 s57, s57, 0
    v_lshl_add_u32 v210, v3, 4, s57
    s_cmp_ge_u32 s48, 10
    s_cbranch_scc1 L_modeV
    s_waitcnt lgkmcnt(0)
    s_cmp_lt_u32 s46, 4
    s_cselect_b32 s56, s62, 1
    s_cmp_eq_u32 s56, 0
    s_cbranch_scc0 L_37
    s_lshl_b32 s56, s45, 2
    s_add_u32 s56, s56, s46
    s_lshl_b32 s56, s56, 9
    s_add_u32 s56, s56, 36864
    v_and_b32 v254, 3, v1
    v_lshlrev_b32 v254, 7, v254
    buffer_load_dword v255, v254, s[12:15], s56 offen sc1
L_37:
    s_barrier
    ds_read_b64_tr_b16 v[160:161], v204 offset:0
    ds_read_b64_tr_b16 v[162:163], v204 offset:1024
    ds_read_b64_tr_b16 v[164:165], v205 offset:0
    ds_read_b64_tr_b16 v[166:167], v205 offset:1024
    ds_read_b128 v[144:147], v192 offset:0
    ds_read_b128 v[148:151], v192 offset:6144
    ds_read_b128 v[152:155], v192 offset:12288
    ds_read_b128 v[156:159], v192 offset:18432
    s_waitcnt lgkmcnt(0)
    v_mfma_f32_32x32x16_bf16 v[16:31], v[160:163], v[144:147], 0
    ds_read_b64_tr_b16 v[184:185], v204 offset:12288
    ds_read_b64_tr_b16 v[186:187], v204 offset:13312
    v_mfma_f32_32x32x16_bf16 v[32:47], v[164:167], v[144:147], 0
    ds_read_b64_tr_b16 v[188:189], v205 offset:12288
    ds_read_b64_tr_b16 v[190:191], v205 offset:13312
    v_mfma_f32_32x32x16_bf16 v[48:63], v[160:163], v[148:151], 0
    ds_read_b128 v[168:171], v193 offset:0
    ds_read_b128 v[172:175], v193 offset:6144
    v_mfma_f32_32x32x16_bf16 v[64:79], v[164:167], v[148:151], 0
    ds_read_b128 v[176:179], v193 offset:12288
    ds_read_b128 v[180:183], v193 offset:18432
    v_mfma_f32_32x32x16_bf16 v[80:95], v[160:163], v[152:155], 0
    v_mfma_f32_32x32x16_bf16 v[96:111], v[164:167], v[152:155], 0
    v_mfma_f32_32x32x16_bf16 v[112:127], v[160:163], v[156:159], 0
    v_mfma_f32_32x32x16_bf16 v[128:143], v[164:167], v[156:159], 0
    s_waitcnt lgkmcnt(0)
    v_mfma_f32_32x32x16_bf16 v[16:31], v[184:187], v[168:171], v[16:31]
    ds_read_b64_tr_b16 v[160:161], v204 offset:24576
    ds_read_b64_tr_b16 v[162:163], v204 offset:25600
    v_mfma_f32_32x32x16_bf16 v[32:47], v[188:191], v[168:171], v[32:47]
    ds_read_b64_tr_b16 v[164:165], v205 offset:24576
    ds_read_b64_tr_b16 v[166:167], v205 offset:25600
    v_mfma_f32_32x32x16_bf16 v[48:63], v[184:187], v[172:175], v[48:63]
    ds_read_b128 v[144:147], v194 offset:0
    ds_read_b128 v[148:151], v194 offset:6144
    v_mfma_f32_32x32x16_bf16 v[64:79], v[188:191], v[172:175], v[64:79]
    ds_read_b128 v[152:155], v194 offset:12288
    ds_read_b128 v[156:159], v194 offset:18432
    v_mfma_f32_32x32x16_bf16 v[80:95], v[184:187], v[176:179], v[80:95]
    v_mfma_f32_32x32x16_bf16 v[96:111], v[188:191], v[176:179], v[96:111]
    v_mfma_f32_32x32x16_bf16 v[112:127], v[184:187], v[180:183], v[112:127]
    v_mfma_f32_32x32x16_bf16 v[128:143], v[188:191], v[180:183], v[128:143]
    s_waitcnt lgkmcnt(0)
    v_mfma_f32_32x32x16_bf16 v[16:31], v[160:163], v[144:147], v[16:31]
    ds_read_b64_tr_b16 v[184:185], v204 offset:36864
    ds_read_b64_tr_b16 v[186:187], v204 offset:37888
    v_mfma_f32_32x32x16_bf16 v[32:47], v[164:167], v[144:147], v[32:47]
    ds_read_b64_tr_b16 v[188:189], v205 offset:36864
    ds_read_b64_tr_b16 v[190:191], v205 offset:37888
    v_mfma_f32_32x32x16_bf16 v[48:63], v[160:163], v[148:151], v[48:63]
    ds_read_b128 v[168:171], v195 offset:0
    ds_read_b128 v[172:175], v195 offset:6144
    v_mfma_f32_32x32x16_bf16 v[64:79], v[164:167], v[148:151], v[64:79]
    ds_read_b128 v[176:179], v195 offset:12288
    ds_read_b128 v[180:183], v195 offset:18432
    v_mfma_f32_32x32x16_bf16 v[80:95], v[160:163], v[152:155], v[80:95]
    v_mfma_f32_32x32x16_bf16 v[96:111], v[164:167], v[152:155], v[96:111]
    v_mfma_f32_32x32x16_bf16 v[112:127], v[160:163], v[156:159], v[112:127]
    v_mfma_f32_32x32x16_bf16 v[128:143], v[164:167], v[156:159], v[128:143]
    s_waitcnt lgkmcnt(0)
    s_barrier
    v_mfma_f32_32x32x16_bf16 v[16:31], v[184:187], v[168:171], v[16:31]
    ds_read_b64_tr_b16 v[160:161], v206 offset:0
    ds_read_b64_tr_b16 v[162:163], v206 offset:1024
    v_mfma_f32_32x32x16_bf16 v[32:47], v[188:191], v[168:171], v[32:47]
    ds_read_b64_tr_b16 v[164:165], v207 offset:0
    ds_read_b64_tr_b16 v[166:167], v207 offset:1024
    v_mfma_f32_32x32x16_bf16 v[48:63], v[184:187], v[172:175], v[48:63]
    ds_read_b128 v[144:147], v196 offset:0
    ds_read_b128 v[148:151], v196 offset:6144
    v_mfma_f32_32x32x16_bf16 v[64:79], v[188:191], v[172:175], v[64:79]
    ds_read_b128 v[152:155], v196 offset:12288
    ds_read_b128 v[156:159], v196 offset:18432
    v_mfma_f32_32x32x16_bf16 v[80:95], v[184:187], v[176:179], v[80:95]
    v_mfma_f32_32x32x16_bf16 v[96:111], v[188:191], v[176:179], v[96:111]
    v_mfma_f32_32x32x16_bf16 v[112:127], v[184:187], v[180:183], v[112:127]
    v_mfma_f32_32x32x16_bf16 v[128:143], v[188:191], v[180:183], v[128:143]
    s_waitcnt lgkmcnt(0)
    v_mfma_f32_32x32x16_bf16 v[16:31], v[160:163], v[144:147], v[16:31]
    ds_read_b64_tr_b16 v[184:185], v206 offset:12288
    ds_read_b64_tr_b16 v[186:187], v206 offset:13312
    v_mfma_f32_32x32x16_bf16 v[32:47], v[164:167], v[144:147], v[32:47]
    ds_read_b64_tr_b16 v[188:189], v207 offset:12288
    ds_read_b64_tr_b16 v[190:191], v207 offset:13312
    v_mfma_f32_32x32x16_bf16 v[48:63], v[160:163], v[148:151], v[48:63]
    ds_read_b128 v[168:171], v197 offset:0
    ds_read_b128 v[172:175], v197 offset:6144
    v_mfma_f32_32x32x16_bf16 v[64:79], v[164:167], v[148:151], v[64:79]
    ds_read_b128 v[176:179], v197 offset:12288
    ds_read_b128 v[180:183], v197 offset:18432
    v_mfma_f32_32x32x16_bf16 v[80:95], v[160:163], v[152:155], v[80:95]
    v_mfma_f32_32x32x16_bf16 v[96:111], v[164:167], v[152:155], v[96:111]
    v_mfma_f32_32x32x16_bf16 v[112:127], v[160:163], v[156:159], v[112:127]
    v_mfma_f32_32x32x16_bf16 v[128:143], v[164:167], v[156:159], v[128:143]
    s_waitcnt lgkmcnt(0)
    v_mfma_f32_32x32x16_bf16 v[16:31], v[184:187], v[168:171], v[16:31]
    ds_read_b64_tr_b16 v[160:161], v206 offset:24576
    ds_read_b64_tr_b16 v[162:163], v206 offset:25600
    v_mfma_f32_32x32x16_bf16 v[32:47], v[188:191], v[168:171], v[32:47]
    ds_read_b64_tr_b16 v[164:165], v207 offset:24576
    ds_read_b64_tr_b16 v[166:167], v207 offset:25600
    v_mfma_f32_32x32x16_bf16 v[48:63], v[184:187], v[172:175], v[48:63]
    ds_read_b128 v[144:147], v198 offset:0
    ds_read_b128 v[148:151], v198 offset:6144
    v_mfma_f32_32x32x16_bf16 v[64:79], v[188:191], v[172:175], v[64:79]
    ds_read_b128 v[152:155], v198 offset:12288
    ds_read_b128 v[156:159], v198 offset:18432
    v_mfma_f32_32x32x16_bf16 v[80:95], v[184:187], v[176:179], v[80:95]
    v_mfma_f32_32x32x16_bf16 v[96:111], v[188:191], v[176:179], v[96:111]
    v_mfma_f32_32x32x16_bf16 v[112:127], v[184:187], v[180:183], v[112:127]
    v_mfma_f32_32x32x16_bf16 v[128:143], v[188:191], v[180:183], v[128:143]
    s_waitcnt lgkmcnt(0)
    v_mfma_f32_32x32x16_bf16 v[16:31], v[160:163], v[144:147], v[16:31]
    ds_read_b64_tr_b16 v[184:185], v206 offset:36864
    ds_read_b64_tr_b16 v[186:187], v206 offset:37888
    v_mfma_f32_32x32x16_bf16 v[32:47], v[164:167], v[144:147], v[32:47]
    ds_read_b64_tr_b16 v[188:189], v207 offset:36864
    ds_read_b64_tr_b16 v[190:191], v207 offset:37888
    v_mfma_f32_32x32x16_bf16 v[48:63], v[160:163], v[148:151], v[48:63]
    ds_read_b128 v[168:171], v199 offset:0
    ds_read_b128 v[172:175], v199 offset:6144
    v_mfma_f32_32x32x16_bf16 v[64:79], v[164:167], v[148:151], v[64:79]
    ds_read_b128 v[176:179], v199 offset:12288
    ds_read_b128 v[180:183], v199 offset:18432
    v_mfma_f32_32x32x16_bf16 v[80:95], v[160:163], v[152:155], v[80:95]
    v_mfma_f32_32x32x16_bf16 v[96:111], v[164:167], v[152:155], v[96:111]
    v_mfma_f32_32x32x16_bf16 v[112:127], v[160:163], v[156:159], v[112:127]
    v_mfma_f32_32x32x16_bf16 v[128:143], v[164:167], v[156:159], v[128:143]
    s_waitcnt lgkmcnt(0)
    s_barrier
    v_mfma_f32_32x32x16_bf16 v[16:31], v[184:187], v[168:171], v[16:31]
    ds_read_b64_tr_b16 v[160:161], v208 offset:0
    ds_read_b64_tr_b16 v[162:163], v208 offset:1024
    v_mfma_f32_32x32x16_bf16 v[32:47], v[188:191], v[168:171], v[32:47]
    ds_read_b64_tr_b16 v[164:165], v209 offset:0
    ds_read_b64_tr_b16 v[166:167], v209 offset:1024
    v_mfma_f32_32x32x16_bf16 v[48:63], v[184:187], v[172:175], v[48:63]
    ds_read_b128 v[144:147], v200 offset:0
    ds_read_b128 v[148:151], v200 offset:6144
    v_mfma_f32_32x32x16_bf16 v[64:79], v[188:191], v[172:175], v[64:79]
    ds_read_b128 v[152:155], v200 offset:12288
    ds_read_b128 v[156:159], v200 offset:18432
    v_mfma_f32_32x32x16_bf16 v[80:95], v[184:187], v[176:179], v[80:95]
    v_mfma_f32_32x32x16_bf16 v[96:111], v[188:191], v[176:179], v[96:111]
    v_mfma_f32_32x32x16_bf16 v[112:127], v[184:187], v[180:183], v[112:127]
    v_mfma_f32_32x32x16_bf16 v[128:143], v[188:191], v[180:183], v[128:143]
    s_waitcnt lgkmcnt(0)
    v_mfma_f32_32x32x16_bf16 v[16:31], v[160:163], v[144:147], v[16:31]
    ds_read_b64_tr_b16 v[184:185], v208 offset:12288
    ds_read_b64_tr_b16 v[186:187], v208 offset:13312
    v_mfma_f32_32x32x16_bf16 v[32:47], v[164:167], v[144:147], v[32:47]
    ds_read_b64_tr_b16 v[188:189], v209 offset:12288
    ds_read_b64_tr_b16 v[190:191], v209 offset:13312
    v_mfma_f32_32x32x16_bf16 v[48:63], v[160:163], v[148:151], v[48:63]
    ds_read_b128 v[168:171], v201 offset:0
    ds_read_b128 v[172:175], v201 offset:6144
    v_mfma_f32_32x32x16_bf16 v[64:79], v[164:167], v[148:151], v[64:79]
    ds_read_b128 v[176:179], v201 offset:12288
    ds_read_b128 v[180:183], v201 offset:18432
    v_mfma_f32_32x32x16_bf16 v[80:95], v[160:163], v[152:155], v[80:95]
    v_mfma_f32_32x32x16_bf16 v[96:111], v[164:167], v[152:155], v[96:111]
    v_mfma_f32_32x32x16_bf16 v[112:127], v[160:163], v[156:159], v[112:127]
    v_mfma_f32_32x32x16_bf16 v[128:143], v[164:167], v[156:159], v[128:143]
    s_waitcnt lgkmcnt(0)
    v_mfma_f32_32x32x16_bf16 v[16:31], v[184:187], v[168:171], v[16:31]
    ds_read_b64_tr_b16 v[160:161], v208 offset:24576
    ds_read_b64_tr_b16 v[162:163], v208 offset:25600
    v_mfma_f32_32x32x16_bf16 v[32:47], v[188:191], v[168:171], v[32:47]
    ds_read_b64_tr_b16 v[164:165], v209 offset:24576
    ds_read_b64_tr_b16 v[166:167], v209 offset:25600
    v_mfma_f32_32x32x16_bf16 v[48:63], v[184:187], v[172:175], v[48:63]
    ds_read_b128 v[144:147], v202 offset:0
    ds_read_b128 v[148:151], v202 offset:6144
    v_mfma_f32_32x32x16_bf16 v[64:79], v[188:191], v[172:175], v[64:79]
    ds_read_b128 v[152:155], v202 offset:12288
    ds_read_b128 v[156:159], v202 offset:18432
    v_mfma_f32_32x32x16_bf16 v[80:95], v[184:187], v[176:179], v[80:95]
    v_mfma_f32_32x32x16_bf16 v[96:111], v[188:191], v[176:179], v[96:111]
    v_mfma_f32_32x32x16_bf16 v[112:127], v[184:187], v[180:183], v[112:127]
    v_mfma_f32_32x32x16_bf16 v[128:143], v[188:191], v[180:183], v[128:143]
    s_waitcnt lgkmcnt(0)
    v_mfma_f32_32x32x16_bf16 v[16:31], v[160:163], v[144:147], v[16:31]
    ds_read_b64_tr_b16 v[184:185], v208 offset:36864
    ds_read_b64_tr_b16 v[186:187], v208 offset:37888
    v_mfma_f32_32x32x16_bf16 v[32:47], v[164:167], v[144:147], v[32:47]
    ds_read_b64_tr_b16 v[188:189], v209 offset:36864
    ds_read_b64_tr_b16 v[190:191], v209 offset:37888
    v_mfma_f32_32x32x16_bf16 v[48:63], v[160:163], v[148:151], v[48:63]
    ds_read_b128 v[168:171], v203 offset:0
    ds_read_b128 v[172:175], v203 offset:6144
    v_mfma_f32_32x32x16_bf16 v[64:79], v[164:167], v[148:151], v[64:79]
    ds_read_b128 v[176:179], v203 offset:12288
    ds_read_b128 v[180:183], v203 offset:18432
    v_mfma_f32_32x32x16_bf16 v[80:95], v[160:163], v[152:155], v[80:95]
    v_mfma_f32_32x32x16_bf16 v[96:111], v[164:167], v[152:155], v[96:111]
    v_mfma_f32_32x32x16_bf16 v[112:127], v[160:163], v[156:159], v[112:127]
    v_mfma_f32_32x32x16_bf16 v[128:143], v[164:167], v[156:159], v[128:143]
    s_waitcnt lgkmcnt(0)
    s_barrier
    v_mfma_f32_32x32x16_bf16 v[16:31], v[184:187], v[168:171], v[16:31]
    ds_read_b64_tr_b16 v[160:161], v204 offset:0
    ds_read_b64_tr_b16 v[162:163], v204 offset:1024
    v_mfma_f32_32x32x16_bf16 v[32:47], v[188:191], v[168:171], v[32:47]
    ds_read_b64_tr_b16 v[164:165], v205 offset:0
    ds_read_b64_tr_b16 v[166:167], v205 offset:1024
    v_mfma_f32_32x32x16_bf16 v[48:63], v[184:187], v[172:175], v[48:63]
    ds_read_b128 v[144:147], v192 offset:0
    ds_read_b128 v[148:151], v192 offset:6144
    v_mfma_f32_32x32x16_bf16 v[64:79], v[188:191], v[172:175], v[64:79]
    ds_read_b128 v[152:155], v192 offset:12288
    ds_read_b128 v[156:159], v192 offset:18432
    v_mfma_f32_32x32x16_bf16 v[80:95], v[184:187], v[176:179], v[80:95]
    v_mfma_f32_32x32x16_bf16 v[96:111], v[188:191], v[176:179], v[96:111]
    v_mfma_f32_32x32x16_bf16 v[112:127], v[184:187], v[180:183], v[112:127]
    v_mfma_f32_32x32x16_bf16 v[128:143], v[188:191], v[180:183], v[128:143]
    s_waitcnt lgkmcnt(0)
    v_mfma_f32_32x32x16_bf16 v[16:31], v[160:163], v[144:147], v[16:31]
    ds_read_b64_tr_b16 v[184:185], v204 offset:12288
    ds_read_b64_tr_b16 v[186:187], v204 offset:13312
    v_mfma_f32_32x32x16_bf16 v[32:47], v[164:167], v[144:147], v[32:47]
    ds_read_b64_tr_b16 v[188:189], v205 offset:12288
    ds_read_b64_tr_b16 v[190:191], v205 offset:13312
    v_mfma_f32_32x32x16_bf16 v[48:63], v[160:163], v[148:151], v[48:63]
    ds_read_b128 v[168:171], v193 offset:0
    ds_read_b128 v[172:175], v193 offset:6144
    v_mfma_f32_32x32x16_bf16 v[64:79], v[164:167], v[148:151], v[64:79]
    ds_read_b128 v[176:179], v193 offset:12288
    ds_read_b128 v[180:183], v193 offset:18432
    v_mfma_f32_32x32x16_bf16 v[80:95], v[160:163], v[152:155], v[80:95]
    v_mfma_f32_32x32x16_bf16 v[96:111], v[164:167], v[152:155], v[96:111]
    v_mfma_f32_32x32x16_bf16 v[112:127], v[160:163], v[156:159], v[112:127]
    v_mfma_f32_32x32x16_bf16 v[128:143], v[164:167], v[156:159], v[128:143]
    s_waitcnt lgkmcnt(0)
    v_mfma_f32_32x32x16_bf16 v[16:31], v[184:187], v[168:171], v[16:31]
    ds_read_b64_tr_b16 v[160:161], v204 offset:24576
    ds_read_b64_tr_b16 v[162:163], v204 offset:25600
    v_mfma_f32_32x32x16_bf16 v[32:47], v[188:191], v[168:171], v[32:47]
    ds_read_b64_tr_b16 v[164:165], v205 offset:24576
    ds_read_b64_tr_b16 v[166:167], v205 offset:25600
    v_mfma_f32_32x32x16_bf16 v[48:63], v[184:187], v[172:175], v[48:63]
    ds_read_b128 v[144:147], v194 offset:0
    ds_read_b128 v[148:151], v194 offset:6144
    v_mfma_f32_32x32x16_bf16 v[64:79], v[188:191], v[172:175], v[64:79]
    ds_read_b128 v[152:155], v194 offset:12288
    ds_read_b128 v[156:159], v194 offset:18432
    v_mfma_f32_32x32x16_bf16 v[80:95], v[184:187], v[176:179], v[80:95]
    v_mfma_f32_32x32x16_bf16 v[96:111], v[188:191], v[176:179], v[96:111]
    v_mfma_f32_32x32x16_bf16 v[112:127], v[184:187], v[180:183], v[112:127]
    v_mfma_f32_32x32x16_bf16 v[128:143], v[188:191], v[180:183], v[128:143]
    s_waitcnt lgkmcnt(0)
    v_mfma_f32_32x32x16_bf16 v[16:31], v[160:163], v[144:147], v[16:31]
    ds_read_b64_tr_b16 v[184:185], v204 offset:36864
    ds_read_b64_tr_b16 v[186:187], v204 offset:37888
    v_mfma_f32_32x32x16_bf16 v[32:47], v[164:167], v[144:147], v[32:47]
    ds_read_b64_tr_b16 v[188:189], v205 offset:36864
    ds_read_b64_tr_b16 v[190:191], v205 offset:37888
    v_mfma_f32_32x32x16_bf16 v[48:63], v[160:163], v[148:151], v[48:63]
    ds_read_b128 v[168:171], v195 offset:0
    ds_read_b128 v[172:175], v195 offset:6144
    v_mfma_f32_32x32x16_bf16 v[64:79], v[164:167], v[148:151], v[64:79]
    ds_read_b128 v[176:179], v195 offset:12288
    ds_read_b128 v[180:183], v195 offset:18432
    v_mfma_f32_32x32x16_bf16 v[80:95], v[160:163], v[152:155], v[80:95]
    v_mfma_f32_32x32x16_bf16 v[96:111], v[164:167], v[152:155], v[96:111]
    v_mfma_f32_32x32x16_bf16 v[112:127], v[160:163], v[156:159], v[112:127]
    v_mfma_f32_32x32x16_bf16 v[128:143], v[164:167], v[156:159], v[128:143]
    s_waitcnt lgkmcnt(0)
    s_barrier
    v_mfma_f32_32x32x16_bf16 v[16:31], v[184:187], v[168:171], v[16:31]
    v_mov_b32 v254, 0
    buffer_load_dwordx2 v[250:251], v254, s[40:43], 0 offen sc1
    ds_read_b64_tr_b16 v[160:161], v206 offset:0
    ds_read_b64_tr_b16 v[162:163], v206 offset:1024
    v_mfma_f32_32x32x16_bf16 v[32:47], v[188:191], v[168:171], v[32:47]
    ds_read_b64_tr_b16 v[164:165], v207 offset:0
    ds_read_b64_tr_b16 v[166:167], v207 offset:1024
    v_mfma_f32_32x32x16_bf16 v[48:63], v[184:187], v[172:175], v[48:63]
    ds_read_b128 v[144:147], v196 offset:0
    ds_read_b128 v[148:151], v196 offset:6144
    v_mfma_f32_32x32x16_bf16 v[64:79], v[188:191], v[172:175], v[64:79]
    ds_read_b128 v[152:155], v196 offset:12288
    ds_read_b128 v[156:159], v196 offset:18432
    v_mfma_f32_32x32x16_bf16 v[80:95], v[184:187], v[176:179], v[80:95]
    v_mfma_f32_32x32x16_bf16 v[96:111], v[188:191], v[176:179], v[96:111]
    v_mfma_f32_32x32x16_bf16 v[112:127], v[184:187], v[180:183], v[112:127]
    v_mfma_f32_32x32x16_bf16 v[128:143], v[188:191], v[180:183], v[128:143]
    s_waitcnt lgkmcnt(0)
    v_mfma_f32_32x32x16_bf16 v[16:31], v[160:163], v[144:147], v[16:31]
    ds_read_b64_tr_b16 v[184:185], v206 offset:12288
    ds_read_b64_tr_b16 v[186:187], v206 offset:13312
    v_mfma_f32_32x32x16_bf16 v[32:47], v[164:167], v[144:147], v[32:47]
    ds_read_b64_tr_b16 v[188:189], v207 offset:12288
    ds_read_b64_tr_b16 v[190:191], v207 offset:13312
    v_mfma_f32_32x32x16_bf16 v[48:63], v[160:163], v[148:151], v[48:63]
    ds_read_b128 v[168:171], v197 offset:0
    ds_read_b128 v[172:175], v197 offset:6144
    v_mfma_f32_32x32x16_bf16 v[64:79], v[164:167], v[148:151], v[64:79]
    ds_read_b128 v[176:179], v197 offset:12288
    ds_read_b128 v[180:183], v197 offset:18432
    v_mfma_f32_32x32x16_bf16 v[80:95], v[160:163], v[152:155], v[80:95]
    v_mfma_f32_32x32x16_bf16 v[96:111], v[164:167], v[152:155], v[96:111]
    v_mfma_f32_32x32x16_bf16 v[112:127], v[160:163], v[156:159], v[112:127]
    v_mfma_f32_32x32x16_bf16 v[128:143], v[164:167], v[156:159], v[128:143]
    s_waitcnt lgkmcnt(0)
    v_mfma_f32_32x32x16_bf16 v[16:31], v[184:187], v[168:171], v[16:31]
    ds_read_b64_tr_b16 v[160:161], v206 offset:24576
    ds_read_b64_tr_b16 v[162:163], v206 offset:25600
    v_mfma_f32_32x32x16_bf16 v[32:47], v[188:191], v[168:171], v[32:47]
    ds_read_b64_tr_b16 v[164:165], v207 offset:24576
    ds_read_b64_tr_b16 v[166:167], v207 offset:25600
    v_mfma_f32_32x32x16_bf16 v[48:63], v[184:187], v[172:175], v[48:63]
    ds_read_b128 v[144:147], v198 offset:0
    ds_read_b128 v[148:151], v198 offset:6144
    v_mfma_f32_32x32x16_bf16 v[64:79], v[188:191], v[172:175], v[64:79]
    ds_read_b128 v[152:155], v198 offset:12288
    ds_read_b128 v[156:159], v198 offset:18432
    v_mfma_f32_32x32x16_bf16 v[80:95], v[184:187], v[176:179], v[80:95]
    v_mfma_f32_32x32x16_bf16 v[96:111], v[188:191], v[176:179], v[96:111]
    v_mfma_f32_32x32x16_bf16 v[112:127], v[184:187], v[180:183], v[112:127]
    v_mfma_f32_32x32x16_bf16 v[128:143], v[188:191], v[180:183], v[128:143]
    s_waitcnt lgkmcnt(0)
    v_mfma_f32_32x32x16_bf16 v[16:31], v[160:163], v[144:147], v[16:31]
    ds_read_b64_tr_b16 v[184:185], v206 offset:36864
    ds_read_b64_tr_b16 v[186:187], v206 offset:37888
    v_mfma_f32_32x32x16_bf16 v[32:47], v[164:167], v[144:147], v[32:47]
    ds_read_b64_tr_b16 v[188:189], v207 offset:36864
    ds_read_b64_tr_b16 v[190:191], v207 offset:37888
    v_mfma_f32_32x32x16_bf16 v[48:63], v[160:163], v[148:151], v[48:63]
    ds_read_b128 v[168:171], v199 offset:0
    ds_read_b128 v[172:175], v199 offset:6144
    v_mfma_f32_32x32x16_bf16 v[64:79], v[164:167], v[148:151], v[64:79]
    ds_read_b128 v[176:179], v199 offset:12288
    ds_read_b128 v[180:183], v199 offset:18432
    v_mfma_f32_32x32x16_bf16 v[80:95], v[160:163], v[152:155], v[80:95]
    v_mfma_f32_32x32x16_bf16 v[96:111], v[164:167], v[152:155], v[96:111]
    v_mfma_f32_32x32x16_bf16 v[112:127], v[160:163], v[156:159], v[112:127]
    v_mfma_f32_32x32x16_bf16 v[128:143], v[164:167], v[156:159], v[128:143]
    s_waitcnt lgkmcnt(0)
    s_barrier
    v_mfma_f32_32x32x16_bf16 v[16:31], v[184:187], v[168:171], v[16:31]
    s_waitcnt vmcnt(0)
    v_mov_b32 v254, 0
    s_mov_b32 s97, 400000
nl_38:
    v_readfirstlane_b32 s50, v250
    v_readfirstlane_b32 s51, v251
    s_cmp_lg_u32 s50, 0
    s_cbranch_scc1 ok_39
    s_sleep 2
    buffer_load_dwordx2 v[250:251], v254, s[40:43], 0 offen sc1
    s_waitcnt vmcnt(0)
    s_sub_u32 s97, s97, 1
    s_cbranch_scc0 nl_38
    v_mov_b32 v14, 48
    v_mov_b32 v15, 232
    buffer_store_dword v15, v14, s[40:43], 0 offen
ok_39:
    ds_read_b64_tr_b16 v[160:161], v208 offset:0
    ds_read_b64_tr_b16 v[162:163], v208 offset:1024
    v_mfma_f32_32x32x16_bf16 v[32:47], v[188:191], v[168:171], v[32:47]
    ds_read_b64_tr_b16 v[164:165], v209 offset:0
    ds_read_b64_tr_b16 v[166:167], v209 offset:1024
    v_mfma_f32_32x32x16_bf16 v[48:63], v[184:187], v[172:175], v[48:63]
    ds_read_b128 v[144:147], v200 offset:0
    ds_read_b128 v[148:151], v200 offset:6144
    v_mfma_f32_32x32x16_bf16 v[64:79], v[188:191], v[172:175], v[64:79]
    ds_read_b128 v[152:155], v200 offset:12288
    ds_read_b128 v[156:159], v200 offset:18432
    v_mfma_f32_32x32x16_bf16 v[80:95], v[184:187], v[176:179], v[80:95]
    v_mfma_f32_32x32x16_bf16 v[96:111], v[188:191], v[176:179], v[96:111]
    v_mfma_f32_32x32x16_bf16 v[112:127], v[184:187], v[180:183], v[112:127]
    v_mfma_f32_32x32x16_bf16 v[128:143], v[188:191], v[180:183], v[128:143]
    s_waitcnt lgkmcnt(0)
    v_mfma_f32_32x32x16_bf16 v[16:31], v[160:163], v[144:147], v[16:31]
    ds_read_b64_tr_b16 v[184:185], v208 offset:12288
    ds_read_b64_tr_b16 v[186:187], v208 offset:13312
    v_mfma_f32_32x32x16_bf16 v[32:47], v[164:167], v[144:147], v[32:47]
    ds_read_b64_tr_b16 v[188:189], v209 offset:12288
    ds_read_b64_tr_b16 v[190:191], v209 offset:13312
    v_mfma_f32_32x32x16_bf16 v[48:63], v[160:163], v[148:151], v[48:63]
    ds_read_b128 v[168:171], v201 offset:0
    ds_read_b128 v[172:175], v201 offset:6144
    v_mfma_f32_32x32x16_bf16 v[64:79], v[164:167], v[148:151], v[64:79]
    ds_read_b128 v[176:179], v201 offset:12288
    ds_read_b128 v[180:183], v201 offset:18432
    v_mfma_f32_32x32x16_bf16 v[80:95], v[160:163], v[152:155], v[80:95]
    v_mfma_f32_32x32x16_bf16 v[96:111], v[164:167], v[152:155], v[96:111]
    v_mfma_f32_32x32x16_bf16 v[112:127], v[160:163], v[156:159], v[112:127]
    v_mfma_f32_32x32x16_bf16 v[128:143], v[164:167], v[156:159], v[128:143]
    s_waitcnt lgkmcnt(0)
    v_mfma_f32_32x32x16_bf16 v[16:31], v[184:187], v[168:171], v[16:31]
    ds_read_b64_tr_b16 v[160:161], v208 offset:24576
    ds_read_b64_tr_b16 v[162:163], v208 offset:25600
    v_mfma_f32_32x32x16_bf16 v[32:47], v[188:191], v[168:171], v[32:47]
    ds_read_b64_tr_b16 v[164:165], v209 offset:24576
    ds_read_b64_tr_b16 v[166:167], v209 offset:25600
    v_mfma_f32_32x32x16_bf16 v[48:63], v[184:187], v[172:175], v[48:63]
    ds_read_b128 v[144:147], v202 offset:0
    ds_read_b128 v[148:151], v202 offset:6144
    v_mfma_f32_32x32x16_bf16 v[64:79], v[188:191], v[172:175], v[64:79]
    ds_read_b128 v[152:155], v202 offset:12288
    ds_read_b128 v[156:159], v202 offset:18432
    v_mfma_f32_32x32x16_bf16 v[80:95], v[184:187], v[176:179], v[80:95]
    v_mfma_f32_32x32x16_bf16 v[96:111], v[188:191], v[176:179], v[96:111]
    v_mfma_f32_32x32x16_bf16 v[112:127], v[184:187], v[180:183], v[112:127]
    v_mfma_f32_32x32x16_bf16 v[128:143], v[188:191], v[180:183], v[128:143]
    s_waitcnt lgkmcnt(0)
    v_mfma_f32_32x32x16_bf16 v[16:31], v[160:163], v[144:147], v[16:31]
    ds_read_b64_tr_b16 v[184:185], v208 offset:36864
    ds_read_b64_tr_b16 v[186:187], v208 offset:37888
    v_mfma_f32_32x32x16_bf16 v[32:47], v[164:167], v[144:147], v[32:47]
    ds_read_b64_tr_b16 v[188:189], v209 offset:36864
    ds_read_b64_tr_b16 v[190:191], v209 offset:37888
    v_mfma_f32_32x32x16_bf16 v[48:63], v[160:163], v[148:151], v[48:63]
    ds_read_b128 v[168:171], v203 offset:0
    ds_read_b128 v[172:175], v203 offset:6144
    v_mfma_f32_32x32x16_bf16 v[64:79], v[164:167], v[148:151], v[64:79]
    ds_read_b128 v[176:179], v203 offset:12288
    ds_read_b128 v[180:183], v203 offset:18432
    v_mfma_f32_32x32x16_bf16 v[80:95], v[160:163], v[152:155], v[80:95]
    v_mfma_f32_32x32x16_bf16 v[96:111], v[164:167], v[152:155], v[96:111]
    v_mfma_f32_32x32x16_bf16 v[112:127], v[160:163], v[156:159], v[112:127]
    v_mfma_f32_32x32x16_bf16 v[128:143], v[164:167], v[156:159], v[128:143]
    s_waitcnt lgkmcnt(0)
    s_barrier
    v_mfma_f32_32x32x16_bf16 v[16:31], v[184:187], v[168:171], v[16:31]
    ds_read_b64_tr_b16 v[160:161], v204 offset:0
    ds_read_b64_tr_b16 v[162:163], v204 offset:1024
    v_mfma_f32_32x32x16_bf16 v[32:47], v[188:191], v[168:171], v[32:47]
    ds_read_b64_tr_b16 v[164:165], v205 offset:0
    ds_read_b64_tr_b16 v[166:167], v205 offset:1024
    v_mfma_f32_32x32x16_bf16 v[48:63], v[184:187], v[172:175], v[48:63]
    ds_read_b128 v[144:147], v192 offset:0
    ds_read_b128 v[148:151], v192 offset:6144
    v_mfma_f32_32x32x16_bf16 v[64:79], v[188:191], v[172:175], v[64:79]
    ds_read_b128 v[152:155], v192 offset:12288
    ds_read_b128 v[156:159], v192 offset:18432
    v_mfma_f32_32x32x16_bf16 v[80:95], v[184:187], v[176:179], v[80:95]
    v_mfma_f32_32x32x16_bf16 v[96:111], v[188:191], v[176:179], v[96:111]
    v_mfma_f32_32x32x16_bf16 v[112:127], v[184:187], v[180:183], v[112:127]
    v_mfma_f32_32x32x16_bf16 v[128:143], v[188:191], v[180:183], v[128:143]
    s_waitcnt lgkmcnt(0)
    v_mfma_f32_32x32x16_bf16 v[16:31], v[160:163], v[144:147], v[16:31]
    ds_read_b64_tr_b16 v[184:185], v204 offset:12288
    ds_read_b64_tr_b16 v[186:187], v204 offset:13312
    v_mfma_f32_32x32x16_bf16 v[32:47], v[164:167], v[144:147], v[32:47]
    ds_read_b64_tr_b16 v[188:189], v205 offset:12288
    ds_read_b64_tr_b16 v[190:191], v205 offset:13312
    v_mfma_f32_32x32x16_bf16 v[48:63], v[160:163], v[148:151], v[48:63]
    ds_read_b128 v[168:171], v193 offset:0
    ds_read_b128 v[172:175], v193 offset:6144
    v_mfma_f32_32x32x16_bf16 v[64:79], v[164:167], v[148:151], v[64:79]
    ds_read_b128 v[176:179], v193 offset:12288
    ds_read_b128 v[180:183], v193 offset:18432
    v_mfma_f32_32x32x16_bf16 v[80:95], v[160:163], v[152:155], v[80:95]
    v_mfma_f32_32x32x16_bf16 v[96:111], v[164:167], v[152:155], v[96:111]
    v_mfma_f32_32x32x16_bf16 v[112:127], v[160:163], v[156:159], v[112:127]
    v_mfma_f32_32x32x16_bf16 v[128:143], v[164:167], v[156:159], v[128:143]
    s_waitcnt lgkmcnt(0)
    v_mfma_f32_32x32x16_bf16 v[16:31], v[184:187], v[168:171], v[16:31]
    ds_read_b64_tr_b16 v[160:161], v204 offset:24576
    ds_read_b64_tr_b16 v[162:163], v204 offset:25600
    v_mfma_f32_32x32x16_bf16 v[32:47], v[188:191], v[168:171], v[32:47]
    ds_read_b64_tr_b16 v[164:165], v205 offset:24576
    ds_read_b64_tr_b16 v[166:167], v205 offset:25600
    v_mfma_f32_32x32x16_bf16 v[48:63], v[184:187], v[172:175], v[48:63]
    ds_read_b128 v[144:147], v194 offset:0
    ds_read_b128 v[148:151], v194 offset:6144
    v_mfma_f32_32x32x16_bf16 v[64:79], v[188:191], v[172:175], v[64:79]
    ds_read_b128 v[152:155], v194 offset:12288
    ds_read_b128 v[156:159], v194 offset:18432
    v_mfma_f32_32x32x16_bf16 v[80:95], v[184:187], v[176:179], v[80:95]
    v_mfma_f32_32x32x16_bf16 v[96:111], v[188:191], v[176:179], v[96:111]
    v_mfma_f32_32x32x16_bf16 v[112:127], v[184:187], v[180:183], v[112:127]
    v_mfma_f32_32x32x16_bf16 v[128:143], v[188:191], v[180:183], v[128:143]
    s_waitcnt lgkmcnt(0)
    v_mfma_f32_32x32x16_bf16 v[16:31], v[160:163], v[144:147], v[16:31]
    ds_read_b64_tr_b16 v[184:185], v204 offset:36864
    ds_read_b64_tr_b16 v[186:187], v204 offset:37888
    v_mfma_f32_32x32x16_bf16 v[32:47], v[164:167], v[144:147], v[32:47]
    ds_read_b64_tr_b16 v[188:189], v205 offset:36864
    ds_read_b64_tr_b16 v[190:191], v205 offset:37888
    v_mfma_f32_32x32x16_bf16 v[48:63], v[160:163], v[148:151], v[48:63]
    ds_read_b128 v[168:171], v195 offset:0
    ds_read_b128 v[172:175], v195 offset:6144
    v_mfma_f32_32x32x16_bf16 v[64:79], v[164:167], v[148:151], v[64:79]
    ds_read_b128 v[176:179], v195 offset:12288
    ds_read_b128 v[180:183], v195 offset:18432
    v_mfma_f32_32x32x16_bf16 v[80:95], v[160:163], v[152:155], v[80:95]
    v_mfma_f32_32x32x16_bf16 v[96:111], v[164:167], v[152:155], v[96:111]
    v_mfma_f32_32x32x16_bf16 v[112:127], v[160:163], v[156:159], v[112:127]
    v_mfma_f32_32x32x16_bf16 v[128:143], v[164:167], v[156:159], v[128:143]
    s_waitcnt lgkmcnt(0)
    s_barrier
    v_mfma_f32_32x32x16_bf16 v[16:31], v[184:187], v[168:171], v[16:31]
    ds_read_b64_tr_b16 v[160:161], v206 offset:0
    ds_read_b64_tr_b16 v[162:163], v206 offset:1024
    v_mfma_f32_32x32x16_bf16 v[32:47], v[188:191], v[168:171], v[32:47]
    ds_read_b64_tr_b16 v[164:165], v207 offset:0
    ds_read_b64_tr_b16 v[166:167], v207 offset:1024
    v_mfma_f32_32x32x16_bf16 v[48:63], v[184:187], v[172:175], v[48:63]
    ds_read_b128 v[144:147], v196 offset:0
    ds_read_b128 v[148:151], v196 offset:6144
    v_mfma_f32_32x32x16_bf16 v[64:79], v[188:191], v[172:175], v[64:79]
    ds_read_b128 v[152:155], v196 offset:12288
    ds_read_b128 v[156:159], v196 offset:18432
    v_mfma_f32_32x32x16_bf16 v[80:95], v[184:187], v[176:179], v[80:95]
    v_mfma_f32_32x32x16_bf16 v[96:111], v[188:191], v[176:179], v[96:111]
    v_mfma_f32_32x32x16_bf16 v[112:127], v[184:187], v[180:183], v[112:127]
    v_mfma_f32_32x32x16_bf16 v[128:143], v[188:191], v[180:183], v[128:143]
    s_waitcnt lgkmcnt(0)
    v_mfma_f32_32x32x16_bf16 v[16:31], v[160:163], v[144:147], v[16:31]
    ds_read_b64_tr_b16 v[184:185], v206 offset:12288
    ds_read_b64_tr_b16 v[186:187], v206 offset:13312
    v_mfma_f32_32x32x16_bf16 v[32:47], v[164:167], v[144:147], v[32:47]
    ds_read_b64_tr_b16 v[188:189], v207 offset:12288
    ds_read_b64_tr_b16 v[190:191], v207 offset:13312
    v_mfma_f32_32x32x16_bf16 v[48:63], v[160:163], v[148:151], v[48:63]
    ds_read_b128 v[168:171], v197 offset:0
    ds_read_b128 v[172:175], v197 offset:6144
    v_mfma_f32_32x32x16_bf16 v[64:79], v[164:167], v[148:151], v[64:79]
    ds_read_b128 v[176:179], v197 offset:12288
    ds_read_b128 v[180:183], v197 offset:18432
    v_mfma_f32_32x32x16_bf16 v[80:95], v[160:163], v[152:155], v[80:95]
    v_mfma_f32_32x32x16_bf16 v[96:111], v[164:167], v[152:155], v[96:111]
    v_mfma_f32_32x32x16_bf16 v[112:127], v[160:163], v[156:159], v[112:127]
    v_mfma_f32_32x32x16_bf16 v[128:143], v[164:167], v[156:159], v[128:143]
    s_waitcnt lgkmcnt(0)
    v_mfma_f32_32x32x16_bf16 v[16:31], v[184:187], v[168:171], v[16:31]
    ds_read_b64_tr_b16 v[160:161], v206 offset:24576
    ds_read_b64_tr_b16 v[162:163], v206 offset:25600
    v_mfma_f32_32x32x16_bf16 v[32:47], v[188:191], v[168:171], v[32:47]
    ds_read_b64_tr_b16 v[164:165], v207 offset:24576
    ds_read_b64_tr_b16 v[166:167], v207 offset:25600
    v_mfma_f32_32x32x16_bf16 v[48:63], v[184:187], v[172:175], v[48:63]
    ds_read_b128 v[144:147], v198 offset:0
    ds_read_b128 v[148:151], v198 offset:6144
    v_mfma_f32_32x32x16_bf16 v[64:79], v[188:191], v[172:175], v[64:79]
    ds_read_b128 v[152:155], v198 offset:12288
    ds_read_b128 v[156:159], v198 offset:18432
    v_mfma_f32_32x32x16_bf16 v[80:95], v[184:187], v[176:179], v[80:95]
    v_mfma_f32_32x32x16_bf16 v[96:111], v[188:191], v[176:179], v[96:111]
    v_mfma_f32_32x32x16_bf16 v[112:127], v[184:187], v[180:183], v[112:127]
    v_mfma_f32_32x32x16_bf16 v[128:143], v[188:191], v[180:183], v[128:143]
    s_waitcnt lgkmcnt(0)
    v_mfma_f32_32x32x16_bf16 v[16:31], v[160:163], v[144:147], v[16:31]
    ds_read_b64_tr_b16 v[184:185], v206 offset:36864
    ds_read_b64_tr_b16 v[186:187], v206 offset:37888
    v_mfma_f32_32x32x16_bf16 v[32:47], v[164:167], v[144:147], v[32:47]
    ds_read_b64_tr_b16 v[188:189], v207 offset:36864
    ds_read_b64_tr_b16 v[190:191], v207 offset:37888
    v_mfma_f32_32x32x16_bf16 v[48:63], v[160:163], v[148:151], v[48:63]
    ds_read_b128 v[168:171], v199 offset:0
    ds_read_b128 v[172:175], v199 offset:6144
    v_mfma_f32_32x32x16_bf16 v[64:79], v[164:167], v[148:151], v[64:79]
    ds_read_b128 v[176:179], v199 offset:12288
    ds_read_b128 v[180:183], v199 offset:18432
    v_mfma_f32_32x32x16_bf16 v[80:95], v[160:163], v[152:155], v[80:95]
    v_mfma_f32_32x32x16_bf16 v[96:111], v[164:167], v[152:155], v[96:111]
    v_mfma_f32_32x32x16_bf16 v[112:127], v[160:163], v[156:159], v[112:127]
    v_mfma_f32_32x32x16_bf16 v[128:143], v[164:167], v[156:159], v[128:143]
    s_waitcnt lgkmcnt(0)
    s_barrier
    v_mfma_f32_32x32x16_bf16 v[16:31], v[184:187], v[168:171], v[16:31]
    ds_read_b64_tr_b16 v[160:161], v208 offset:0
    ds_read_b64_tr_b16 v[162:163], v208 offset:1024
    v_mfma_f32_32x32x16_bf16 v[32:47], v[188:191], v[168:171], v[32:47]
    ds_read_b64_tr_b16 v[164:165], v209 offset:0
    ds_read_b64_tr_b16 v[166:167], v209 offset:1024
    v_mfma_f32_32x32x16_bf16 v[48:63], v[184:187], v[172:175], v[48:63]
    ds_read_b128 v[144:147], v200 offset:0
    ds_read_b128 v[148:151], v200 offset:6144
    v_mfma_f32_32x32x16_bf16 v[64:79], v[188:191], v[172:175], v[64:79]
    ds_read_b128 v[152:155], v200 offset:12288
    ds_read_b128 v[156:159], v200 offset:18432
    v_mfma_f32_32x32x16_bf16 v[80:95], v[184:187], v[176:179], v[80:95]
    v_mfma_f32_32x32x16_bf16 v[96:111], v[188:191], v[176:179], v[96:111]
    v_mfma_f32_32x32x16_bf16 v[112:127], v[184:187], v[180:183], v[112:127]
    v_mfma_f32_32x32x16_bf16 v[128:143], v[188:191], v[180:183], v[128:143]
    s_waitcnt lgkmcnt(0)
    v_mfma_f32_32x32x16_bf16 v[16:31], v[160:163], v[144:147], v[16:31]
    ds_read_b64_tr_b16 v[184:185], v208 offset:12288
    ds_read_b64_tr_b16 v[186:187], v208 offset:13312
    v_mfma_f32_32x32x16_bf16 v[32:47], v[164:167], v[144:147], v[32:47]
    ds_read_b64_tr_b16 v[188:189], v209 offset:12288
    ds_read_b64_tr_b16 v[190:191], v209 offset:13312
    v_mfma_f32_32x32x16_bf16 v[48:63], v[160:163], v[148:151], v[48:63]
    ds_read_b128 v[168:171], v201 offset:0
    ds_read_b128 v[172:175], v201 offset:6144
    v_mfma_f32_32x32x16_bf16 v[64:79], v[164:167], v[148:151], v[64:79]
    ds_read_b128 v[176:179], v201 offset:12288
    ds_read_b128 v[180:183], v201 offset:18432
    v_mfma_f32_32x32x16_bf16 v[80:95], v[160:163], v[152:155], v[80:95]
    v_mfma_f32_32x32x16_bf16 v[96:111], v[164:167], v[152:155], v[96:111]
    v_mfma_f32_32x32x16_bf16 v[112:127], v[160:163], v[156:159], v[112:127]
    v_mfma_f32_32x32x16_bf16 v[128:143], v[164:167], v[156:159], v[128:143]
    s_waitcnt lgkmcnt(0)
    v_mfma_f32_32x32x16_bf16 v[16:31], v[184:187], v[168:171], v[16:31]
    ds_read_b64_tr_b16 v[160:161], v208 offset:24576
    ds_read_b64_tr_b16 v[162:163], v208 offset:25600
    v_mfma_f32_32x32x16_bf16 v[32:47], v[188:191], v[168:171], v[32:47]
    ds_read_b64_tr_b16 v[164:165], v209 offset:24576
    ds_read_b64_tr_b16 v[166:167], v209 offset:25600
    v_mfma_f32_32x32x16_bf16 v[48:63], v[184:187], v[172:175], v[48:63]
    ds_read_b128 v[144:147], v202 offset:0
    ds_read_b128 v[148:151], v202 offset:6144
    v_mfma_f32_32x32x16_bf16 v[64:79], v[188:191], v[172:175], v[64:79]
    ds_read_b128 v[152:155], v202 offset:12288
    ds_read_b128 v[156:159], v202 offset:18432
    v_mfma_f32_32x32x16_bf16 v[80:95], v[184:187], v[176:179], v[80:95]
    v_mfma_f32_32x32x16_bf16 v[96:111], v[188:191], v[176:179], v[96:111]
    v_mfma_f32_32x32x16_bf16 v[112:127], v[184:187], v[180:183], v[112:127]
    v_mfma_f32_32x32x16_bf16 v[128:143], v[188:191], v[180:183], v[128:143]
    s_waitcnt lgkmcnt(0)
    v_mfma_f32_32x32x16_bf16 v[16:31], v[160:163], v[144:147], v[16:31]
    ds_read_b64_tr_b16 v[184:185], v208 offset:36864
    ds_read_b64_tr_b16 v[186:187], v208 offset:37888
    v_mfma_f32_32x32x16_bf16 v[32:47], v[164:167], v[144:147], v[32:47]
    ds_read_b64_tr_b16 v[188:189], v209 offset:36864
    ds_read_b64_tr_b16 v[190:191], v209 offset:37888
    v_mfma_f32_32x32x16_bf16 v[48:63], v[160:163], v[148:151], v[48:63]
    ds_read_b128 v[168:171], v203 offset:0
    ds_read_b128 v[172:175], v203 offset:6144
    v_mfma_f32_32x32x16_bf16 v[64:79], v[164:167], v[148:151], v[64:79]
    ds_read_b128 v[176:179], v203 offset:12288
    ds_read_b128 v[180:183], v203 offset:18432
    v_mfma_f32_32x32x16_bf16 v[80:95], v[160:163], v[152:155], v[80:95]
    v_mfma_f32_32x32x16_bf16 v[96:111], v[164:167], v[152:155], v[96:111]
    v_mfma_f32_32x32x16_bf16 v[112:127], v[160:163], v[156:159], v[112:127]
    v_mfma_f32_32x32x16_bf16 v[128:143], v[164:167], v[156:159], v[128:143]
    s_waitcnt lgkmcnt(0)
    s_barrier
    v_mfma_f32_32x32x16_bf16 v[16:31], v[184:187], v[168:171], v[16:31]
    ds_read_b64_tr_b16 v[160:161], v204 offset:0
    ds_read_b64_tr_b16 v[162:163], v204 offset:1024
    v_mfma_f32_32x32x16_bf16 v[32:47], v[188:191], v[168:171], v[32:47]
    ds_read_b64_tr_b16 v[164:165], v205 offset:0
    ds_read_b64_tr_b16 v[166:167], v205 offset:1024
    v_mfma_f32_32x32x16_bf16 v[48:63], v[184:187], v[172:175], v[48:63]
    ds_read_b128 v[144:147], v192 offset:0
    ds_read_b128 v[148:151], v192 offset:6144
    v_mfma_f32_32x32x16_bf16 v[64:79], v[188:191], v[172:175], v[64:79]
    ds_read_b128 v[152:155], v192 offset:12288
    ds_read_b128 v[156:159], v192 offset:18432
    v_mfma_f32_32x32x16_bf16 v[80:95], v[184:187], v[176:179], v[80:95]
    buffer_load_dwordx4 v[212:215], v210, s[12:15], 0 offen offset:0 sc1
    v_mfma_f32_32x32x16_bf16 v[96:111], v[188:191], v[176:179], v[96:111]
    buffer_load_dwordx4 v[216:219], v210, s[12:15], 0 offen offset:512 sc1
    v_mfma_f32_32x32x16_bf16 v[112:127], v[184:187], v[180:183], v[112:127]
    buffer_load_dwordx4 v[220:223], v210, s[12:15], 0 offen offset:1024 sc1
    v_mfma_f32_32x32x16_bf16 v[128:143], v[188:191], v[180:183], v[128:143]
    buffer_load_dwordx4 v[224:227], v210, s[12:15], 0 offen offset:1536 sc1
    s_waitcnt lgkmcnt(0)
    v_mfma_f32_32x32x16_bf16 v[16:31], v[160:163], v[144:147], v[16:31]
    ds_read_b64_tr_b16 v[184:185], v204 offset:12288
    ds_read_b64_tr_b16 v[186:187], v204 offset:13312
    v_mfma_f32_32x32x16_bf16 v[32:47], v[164:167], v[144:147], v[32:47]
    ds_read_b64_tr_b16 v[188:189], v205 offset:12288
    ds_read_b64_tr_b16 v[190:191], v205 offset:13312
    v_mfma_f32_32x32x16_bf16 v[48:63], v[160:163], v[148:151], v[48:63]
    ds_read_b128 v[168:171], v193 offset:0
    ds_read_b128 v[172:175], v193 offset:6144
    v_mfma_f32_32x32x16_bf16 v[64:79], v[164:167], v[148:151], v[64:79]
    ds_read_b128 v[176:179], v193 offset:12288
    ds_read_b128 v[180:183], v193 offset:18432
    v_mfma_f32_32x32x16_bf16 v[80:95], v[160:163], v[152:155], v[80:95]
    v_mfma_f32_32x32x16_bf16 v[96:111], v[164:167], v[152:155], v[96:111]
    v_mfma_f32_32x32x16_bf16 v[112:127], v[160:163], v[156:159], v[112:127]
    v_mfma_f32_32x32x16_bf16 v[128:143], v[164:167], v[156:159], v[128:143]
    s_waitcnt lgkmcnt(0)
    v_mfma_f32_32x32x16_bf16 v[16:31], v[184:187], v[168:171], v[16:31]
    ds_read_b64_tr_b16 v[160:161], v204 offset:24576
    ds_read_b64_tr_b16 v[162:163], v204 offset:25600
    v_mfma_f32_32x32x16_bf16 v[32:47], v[188:191], v[168:171], v[32:47]
    ds_read_b64_tr_b16 v[164:165], v205 offset:24576
    ds_read_b64_tr_b16 v[166:167], v205 offset:25600
    v_mfma_f32_32x32x16_bf16 v[48:63], v[184:187], v[172:175], v[48:63]
    ds_read_b128 v[144:147], v194 offset:0
    ds_read_b128 v[148:151], v194 offset:6144
    v_mfma_f32_32x32x16_bf16 v[64:79], v[188:191], v[172:175], v[64:79]
    ds_read_b128 v[152:155], v194 offset:12288
    ds_read_b128 v[156:159], v194 offset:18432
    v_mfma_f32_32x32x16_bf16 v[80:95], v[184:187], v[176:179], v[80:95]
    v_mfma_f32_32x32x16_bf16 v[96:111], v[188:191], v[176:179], v[96:111]
    v_mfma_f32_32x32x16_bf16 v[112:127], v[184:187], v[180:183], v[112:127]
    v_mfma_f32_32x32x16_bf16 v[128:143], v[188:191], v[180:183], v[128:143]
    s_waitcnt lgkmcnt(0)
    v_mfma_f32_32x32x16_bf16 v[16:31], v[160:163], v[144:147], v[16:31]
    ds_read_b64_tr_b16 v[184:185], v204 offset:36864
    ds_read_b64_tr_b16 v[186:187], v204 offset:37888
    v_mfma_f32_32x32x16_bf16 v[32:47], v[164:167], v[144:147], v[32:47]
    ds_read_b64_tr_b16 v[188:189], v205 offset:36864
    ds_read_b64_tr_b16 v[190:191], v205 offset:37888
    v_mfma_f32_32x32x16_bf16 v[48:63], v[160:163], v[148:151], v[48:63]
    ds_read_b128 v[168:171], v195 offset:0
    ds_read_b128 v[172:175], v195 offset:6144
    v_mfma_f32_32x32x16_bf16 v[64:79], v[164:167], v[148:151], v[64:79]
    ds_read_b128 v[176:179], v195 offset:12288
    ds_read_b128 v[180:183], v195 offset:18432
    v_mfma_f32_32x32x16_bf16 v[80:95], v[160:163], v[152:155], v[80:95]
    v_mfma_f32_32x32x16_bf16 v[96:111], v[164:167], v[152:155], v[96:111]
    v_mfma_f32_32x32x16_bf16 v[112:127], v[160:163], v[156:159], v[112:127]
    v_mfma_f32_32x32x16_bf16 v[128:143], v[164:167], v[156:159], v[128:143]
    s_waitcnt lgkmcnt(0)
    s_barrier
    v_mfma_f32_32x32x16_bf16 v[16:31], v[184:187], v[168:171], v[16:31]
    v_mfma_f32_32x32x16_bf16 v[32:47], v[188:191], v[168:171], v[32:47]
    v_mfma_f32_32x32x16_bf16 v[48:63], v[184:187], v[172:175], v[48:63]
    v_mfma_f32_32x32x16_bf16 v[64:79], v[188:191], v[172:175], v[64:79]
    v_mfma_f32_32x32x16_bf16 v[80:95], v[184:187], v[176:179], v[80:95]
    v_mfma_f32_32x32x16_bf16 v[96:111], v[188:191], v[176:179], v[96:111]
    v_mfma_f32_32x32x16_bf16 v[112:127], v[184:187], v[180:183], v[112:127]
    v_mfma_f32_32x32x16_bf16 v[128:143], v[188:191], v[180:183], v[128:143]
    s_lshl_b32 s57, s47, 1
    s_add_u32 s57, s57, s60
    s_mul_i32 s57, s57, 163840
    v_lshrrev_b32 v4, 5, v1
    s_lshl_b32 s58, s61, 8
    s_add_u32 s58, s58, 159744
    v_lshl_add_u32 v5, v4, 4, s58
    ds_read_b128 v[144:147], v5 offset:0
    ds_read_b128 v[148:151], v5 offset:32
    ds_read_b128 v[152:155], v5 offset:64
    ds_read_b128 v[156:159], v5 offset:96
    ds_read_b128 v[160:163], v5 offset:128
    ds_read_b128 v[164:167], v5 offset:160
    ds_read_b128 v[168:171], v5 offset:192
    ds_read_b128 v[172:175], v5 offset:224
    s_cmp_lt_u32 s48, 5
    s_cselect_b32 s58, 0x3ea52b5c, 1.0
    s_cselect_b32 s59, 0, 5
    s_cselect_b32 s55, 0, 2621440
    s_sub_u32 s59, s48, s59
    s_lshl_b32 s59, s59, 1
    s_add_u32 s59, s59, s61
    s_lshl_b32 s59, s59, 12
    s_add_u32 s57, s57, s59
    s_add_u32 s57, s57, s55
    s_add_u32 s57, s57, 4259840
    v_and_b32 v5, 31, v1
    v_lshlrev_b32 v5, 4, v5
    v_lshl_add_u32 v5, v4, 9, v5
    s_waitcnt vmcnt(0)
    v_cmp_ne_u64 vcc, v[214:215], s[50:51]
    v_cmp_ne_u64 s[98:99], v[218:219], s[50:51]
    s_or_b64 vcc, vcc, s[98:99]
    v_cmp_ne_u64 s[98:99], v[222:223], s[50:51]
    s_or_b64 vcc, vcc, s[98:99]
    v_cmp_ne_u64 s[98:99], v[226:227], s[50:51]
    s_or_b64 vcc, vcc, s[98:99]
    s_and_b64 vcc, vcc, exec
    s_cbranch_scc0 ok_40
    s_mov_b32 s97, 400000
sp_41:
    s_sleep 2
    buffer_load_dwordx4 v[212:215], v210, s[12:15], 0 offen offset:0 sc1
    buffer_load_dwordx4 v[216:219], v210, s[12:15], 0 offen offset:512 sc1
    buffer_load_dwordx4 v[220:223], v210, s[12:15], 0 offen offset:1024 sc1
    buffer_load_dwordx4 v[224:227], v210, s[12:15], 0 offen offset:1536 sc1
    s_waitcnt vmcnt(0)
    v_cmp_ne_u64 vcc, v[214:215], s[50:51]
    v_cmp_ne_u64 s[98:99], v[218:219], s[50:51]
    s_or_b64 vcc, vcc, s[98:99]
    v_cmp_ne_u64 s[98:99], v[222:223], s[50:51]
    s_or_b64 vcc, vcc, s[98:99]
    v_cmp_ne_u64 s[98:99], v[226:227], s[50:51]
    s_or_b64 vcc, vcc, s[98:99]
    s_and_b64 vcc, vcc, exec
    s_cbranch_scc0 ok_40
    s_sub_u32 s97, s97, 1
    s_cbranch_scc0 sp_41
    v_mov_b32 v14, 20
    v_mov_b32 v15, 225
    buffer_store_dword v15, v14, s[40:43], 0 offen
ok_40:
    v_mul_f32 v213, s58, v213
    v_mul_f32 v217, s58, v217
    v_mul_f32 v221, s58, v221
    v_mul_f32 v225, s58, v225
    s_waitcnt lgkmcnt(6)
    v_pk_fma_f32 v[16:17], v[144:145], v[212:213], v[16:17] op_sel_hi:[1,0,1] neg_lo:[0,1,0] neg_hi:[0,1,0]
    v_pk_fma_f32 v[18:19], v[146:147], v[212:213], v[18:19] op_sel_hi:[1,0,1] neg_lo:[0,1,0] neg_hi:[0,1,0]
    v_pk_fma_f32 v[20:21], v[148:149], v[212:213], v[20:21] op_sel_hi:[1,0,1] neg_lo:[0,1,0] neg_hi:[0,1,0]
    v_pk_fma_f32 v[22:23], v[150:151], v[212:213], v[22:23] op_sel_hi:[1,0,1] neg_lo:[0,1,0] neg_hi:[0,1,0]
    v_pk_mul_f32 v[16:17], v[16:17], v[212:213] op_sel:[0,1] op_sel_hi:[1,1]
    v_pk_mul_f32 v[18:19], v[18:19], v[212:213] op_sel:[0,1] op_sel_hi:[1,1]
    v_pk_mul_f32 v[20:21], v[20:21], v[212:213] op_sel:[0,1] op_sel_hi:[1,1]
    v_pk_mul_f32 v[22:23], v[22:23], v[212:213] op_sel:[0,1] op_sel_hi:[1,1]
    v_cvt_pk_bf16_f32 v16, v16, v17
    v_cvt_pk_bf16_f32 v17, v18, v19
    v_cvt_pk_bf16_f32 v18, v20, v21
    v_cvt_pk_bf16_f32 v19, v22, v23
    s_nop 0
    v_permlane32_swap_b32 v16, v18
    v_permlane32_swap_b32 v17, v19
    buffer_store_dwordx4 v[16:19], v5, s[12:15], s57 offen offset:0 sc1
    s_waitcnt lgkmcnt(4)
    v_pk_fma_f32 v[24:25], v[152:153], v[212:213], v[24:25] op_sel_hi:[1,0,1] neg_lo:[0,1,0] neg_hi:[0,1,0]
    v_pk_fma_f32 v[26:27], v[154:155], v[212:213], v[26:27] op_sel_hi:[1,0,1] neg_lo:[0,1,0] neg_hi:[0,1,0]
    v_pk_fma_f32 v[28:29], v[156:157], v[212:213], v[28:29] op_sel_hi:[1,0,1] neg_lo:[0,1,0] neg_hi:[0,1,0]
    v_pk_fma_f32 v[30:31], v[158:159], v[212:213], v[30:31] op_sel_hi:[1,0,1] neg_lo:[0,1,0] neg_hi:[0,1,0]
    v_pk_mul_f32 v[24:25], v[24:25], v[212:213] op_sel:[0,1] op_sel_hi:[1,1]
    v_pk_mul_f32 v[26:27], v[26:27], v[212:213] op_sel:[0,1] op_sel_hi:[1,1]
    v_pk_mul_f32 v[28:29], v[28:29], v[212:213] op_sel:[0,1] op_sel_hi:[1,1]
    v_pk_mul_f32 v[30:31], v[30:31], v[212:213] op_sel:[0,1] op_sel_hi:[1,1]
    v_cvt_pk_bf16_f32 v24, v24, v25
    v_cvt_pk_bf16_f32 v25, v26, v27
    v_cvt_pk_bf16_f32 v26, v28, v29
    v_cvt_pk_bf16_f32 v27, v30, v31
    s_nop 0
    v_permlane32_swap_b32 v24, v26
    v_permlane32_swap_b32 v25, v27
    buffer_store_dwordx4 v[24:27], v5, s[12:15], s57 offen offset:1024 sc1
    s_waitcnt lgkmcnt(2)
    v_pk_fma_f32 v[32:33], v[160:161], v[212:213], v[32:33] op_sel_hi:[1,0,1] neg_lo:[0,1,0] neg_hi:[0,1,0]
    v_pk_fma_f32 v[34:35], v[162:163], v[212:213], v[34:35] op_sel_hi:[1,0,1] neg_lo:[0,1,0] neg_hi:[0,1,0]
    v_pk_fma_f32 v[36:37], v[164:165], v[212:213], v[36:37] op_sel_hi:[1,0,1] neg_lo:[0,1,0] neg_hi:[0,1,0]
    v_pk_fma_f32 v[38:39], v[166:167], v[212:213], v[38:39] op_sel_hi:[1,0,1] neg_lo:[0,1,0] neg_hi:[0,1,0]
    v_pk_mul_f32 v[32:33], v[32:33], v[212:213] op_sel:[0,1] op_sel_hi:[1,1]
    v_pk_mul_f32 v[34:35], v[34:35], v[212:213] op_sel:[0,1] op_sel_hi:[1,1]
    v_pk_mul_f32 v[36:37], v[36:37], v[212:213] op_sel:[0,1] op_sel_hi:[1,1]
    v_pk_mul_f32 v[38:39], v[38:39], v[212:213] op_sel:[0,1] op_sel_hi:[1,1]
    v_cvt_pk_bf16_f32 v32, v32, v33
    v_cvt_pk_bf16_f32 v33, v34, v35
    v_cvt_pk_bf16_f32 v34, v36, v37
    v_cvt_pk_bf16_f32 v35, v38, v39
    s_nop 0
    v_permlane32_swap_b32 v32, v34
    v_permlane32_swap_b32 v33, v35
    buffer_store_dwordx4 v[32:35], v5, s[12:15], s57 offen offset:2048 sc1
    s_waitcnt lgkmcnt(0)
    v_pk_fma_f32 v[40:41], v[168:169], v[212:213], v[40:41] op_sel_hi:[1,0,1] neg_lo:[0,1,0] neg_hi:[0,1,0]
    v_pk_fma_f32 v[42:43], v[170:171], v[212:213], v[42:43] op_sel_hi:[1,0,1] neg_lo:[0,1,0] neg_hi:[0,1,0]
    v_pk_fma_f32 v[44:45], v[172:173], v[212:213], v[44:45] op_sel_hi:[1,0,1] neg_lo:[0,1,0] neg_hi:[0,1,0]
    v_pk_fma_f32 v[46:47], v[174:175], v[212:213], v[46:47] op_sel_hi:[1,0,1] neg_lo:[0,1,0] neg_hi:[0,1,0]
    v_pk_mul_f32 v[40:41], v[40:41], v[212:213] op_sel:[0,1] op_sel_hi:[1,1]
    v_pk_mul_f32 v[42:43], v[42:43], v[212:213] op_sel:[0,1] op_sel_hi:[1,1]
    v_pk_mul_f32 v[44:45], v[44:45], v[212:213] op_sel:[0,1] op_sel_hi:[1,1]
    v_pk_mul_f32 v[46:47], v[46:47], v[212:213] op_sel:[0,1] op_sel_hi:[1,1]
    v_cvt_pk_bf16_f32 v40, v40, v41
    v_cvt_pk_bf16_f32 v41, v42, v43
    v_cvt_pk_bf16_f32 v42, v44, v45
    v_cvt_pk_bf16_f32 v43, v46, v47
    s_nop 0
    v_permlane32_swap_b32 v40, v42
    v_permlane32_swap_b32 v41, v43
    buffer_store_dwordx4 v[40:43], v5, s[12:15], s57 offen offset:3072 sc1
    s_add_u32 s57, s57, 40960
    v_pk_fma_f32 v[48:49], v[144:145], v[216:217], v[48:49] op_sel_hi:[1,0,1] neg_lo:[0,1,0] neg_hi:[0,1,0]
    v_pk_fma_f32 v[50:51], v[146:147], v[216:217], v[50:51] op_sel_hi:[1,0,1] neg_lo:[0,1,0] neg_hi:[0,1,0]
    v_pk_fma_f32 v[52:53], v[148:149], v[216:217], v[52:53] op_sel_hi:[1,0,1] neg_lo:[0,1,0] neg_hi:[0,1,0]
    v_pk_fma_f32 v[54:55], v[150:151], v[216:217], v[54:55] op_sel_hi:[1,0,1] neg_lo:[0,1,0] neg_hi:[0,1,0]
    v_pk_mul_f32 v[48:49], v[48:49], v[216:217] op_sel:[0,1] op_sel_hi:[1,1]
    v_pk_mul_f32 v[50:51], v[50:51], v[216:217] op_sel:[0,1] op_sel_hi:[1,1]
    v_pk_mul_f32 v[52:53], v[52:53], v[216:217] op_sel:[0,1] op_sel_hi:[1,1]
    v_pk_mul_f32 v[54:55], v[54:55], v[216:217] op_sel:[0,1] op_sel_hi:[1,1]
    v_cvt_pk_bf16_f32 v48, v48, v49
    v_cvt_pk_bf16_f32 v49, v50, v51
    v_cvt_pk_bf16_f32 v50, v52, v53
    v_cvt_pk_bf16_f32 v51, v54, v55
    s_nop 0
    v_permlane32_swap_b32 v48, v50
    v_permlane32_swap_b32 v49, v51
    buffer_store_dwordx4 v[48:51], v5, s[12:15], s57 offen offset:0 sc1
    v_pk_fma_f32 v[56:57], v[152:153], v[216:217], v[56:57] op_sel_hi:[1,0,1] neg_lo:[0,1,0] neg_hi:[0,1,0]
    v_pk_fma_f32 v[58:59], v[154:155], v[216:217], v[58:59] op_sel_hi:[1,0,1] neg_lo:[0,1,0] neg_hi:[0,1,0]
    v_pk_fma_f32 v[60:61], v[156:157], v[216:217], v[60:61] op_sel_hi:[1,0,1] neg_lo:[0,1,0] neg_hi:[0,1,0]
    v_pk_fma_f32 v[62:63], v[158:159], v[216:217], v[62:63] op_sel_hi:[1,0,1] neg_lo:[0,1,0] neg_hi:[0,1,0]
    v_pk_mul_f32 v[56:57], v[56:57], v[216:217] op_sel:[0,1] op_sel_hi:[1,1]
    v_pk_mul_f32 v[58:59], v[58:59], v[216:217] op_sel:[0,1] op_sel_hi:[1,1]
    v_pk_mul_f32 v[60:61], v[60:61], v[216:217] op_sel:[0,1] op_sel_hi:[1,1]
    v_pk_mul_f32 v[62:63], v[62:63], v[216:217] op_sel:[0,1] op_sel_hi:[1,1]
    v_cvt_pk_bf16_f32 v56, v56, v57
    v_cvt_pk_bf16_f32 v57, v58, v59
    v_cvt_pk_bf16_f32 v58, v60, v61
    v_cvt_pk_bf16_f32 v59, v62, v63
    s_nop 0
    v_permlane32_swap_b32 v56, v58
    v_permlane32_swap_b32 v57, v59
    buffer_store_dwordx4 v[56:59], v5, s[12:15], s57 offen offset:1024 sc1
    v_pk_fma_f32 v[64:65], v[160:161], v[216:217], v[64:65] op_sel_hi:[1,0,1] neg_lo:[0,1,0] neg_hi:[0,1,0]
    v_pk_fma_f32 v[66:67], v[162:163], v[216:217], v[66:67] op_sel_hi:[1,0,1] neg_lo:[0,1,0] neg_hi:[0,1,0]
    v_pk_fma_f32 v[68:69], v[164:165], v[216:217], v[68:69] op_sel_hi:[1,0,1] neg_lo:[0,1,0] neg_hi:[0,1,0]
    v_pk_fma_f32 v[70:71], v[166:167], v[216:217], v[70:71] op_sel_hi:[1,0,1] neg_lo:[0,1,0] neg_hi:[0,1,0]
    v_pk_mul_f32 v[64:65], v[64:65], v[216:217] op_sel:[0,1] op_sel_hi:[1,1]
    v_pk_mul_f32 v[66:67], v[66:67], v[216:217] op_sel:[0,1] op_sel_hi:[1,1]
    v_pk_mul_f32 v[68:69], v[68:69], v[216:217] op_sel:[0,1] op_sel_hi:[1,1]
    v_pk_mul_f32 v[70:71], v[70:71], v[216:217] op_sel:[0,1] op_sel_hi:[1,1]
    v_cvt_pk_bf16_f32 v64, v64, v65
    v_cvt_pk_bf16_f32 v65, v66, v67
    v_cvt_pk_bf16_f32 v66, v68, v69
    v_cvt_pk_bf16_f32 v67, v70, v71
    s_nop 0
    v_permlane32_swap_b32 v64, v66
    v_permlane32_swap_b32 v65, v67
    buffer_store_dwordx4 v[64:67], v5, s[12:15], s57 offen offset:2048 sc1
    v_pk_fma_f32 v[72:73], v[168:169], v[216:217], v[72:73] op_sel_hi:[1,0,1] neg_lo:[0,1,0] neg_hi:[0,1,0]
    v_pk_fma_f32 v[74:75], v[170:171], v[216:217], v[74:75] op_sel_hi:[1,0,1] neg_lo:[0,1,0] neg_hi:[0,1,0]
    v_pk_fma_f32 v[76:77], v[172:173], v[216:217], v[76:77] op_sel_hi:[1,0,1] neg_lo:[0,1,0] neg_hi:[0,1,0]
    v_pk_fma_f32 v[78:79], v[174:175], v[216:217], v[78:79] op_sel_hi:[1,0,1] neg_lo:[0,1,0] neg_hi:[0,1,0]
    v_pk_mul_f32 v[72:73], v[72:73], v[216:217] op_sel:[0,1] op_sel_hi:[1,1]
    v_pk_mul_f32 v[74:75], v[74:75], v[216:217] op_sel:[0,1] op_sel_hi:[1,1]
    v_pk_mul_f32 v[76:77], v[76:77], v[216:217] op_sel:[0,1] op_sel_hi:[1,1]
    v_pk_mul_f32 v[78:79], v[78:79], v[216:217] op_sel:[0,1] op_sel_hi:[1,1]
    v_cvt_pk_bf16_f32 v72, v72, v73
    v_cvt_pk_bf16_f32 v73, v74, v75
    v_cvt_pk_bf16_f32 v74, v76, v77
    v_cvt_pk_bf16_f32 v75, v78, v79
    s_nop 0
    v_permlane32_swap_b32 v72, v74
    v_permlane32_swap_b32 v73, v75
    buffer_store_dwordx4 v[72:75], v5, s[12:15], s57 offen offset:3072 sc1
    s_add_u32 s57, s57, 40960
    v_pk_fma_f32 v[80:81], v[144:145], v[220:221], v[80:81] op_sel_hi:[1,0,1] neg_lo:[0,1,0] neg_hi:[0,1,0]
    v_pk_fma_f32 v[82:83], v[146:147], v[220:221], v[82:83] op_sel_hi:[1,0,1] neg_lo:[0,1,0] neg_hi:[0,1,0]
    v_pk_fma_f32 v[84:85], v[148:149], v[220:221], v[84:85] op_sel_hi:[1,0,1] neg_lo:[0,1,0] neg_hi:[0,1,0]
    v_pk_fma_f32 v[86:87], v[150:151], v[220:221], v[86:87] op_sel_hi:[1,0,1] neg_lo:[0,1,0] neg_hi:[0,1,0]
    v_pk_mul_f32 v[80:81], v[80:81], v[220:221] op_sel:[0,1] op_sel_hi:[1,1]
    v_pk_mul_f32 v[82:83], v[82:83], v[220:221] op_sel:[0,1] op_sel_hi:[1,1]
    v_pk_mul_f32 v[84:85], v[84:85], v[220:221] op_sel:[0,1] op_sel_hi:[1,1]
    v_pk_mul_f32 v[86:87], v[86:87], v[220:221] op_sel:[0,1] op_sel_hi:[1,1]
    v_cvt_pk_bf16_f32 v80, v80, v81
    v_cvt_pk_bf16_f32 v81, v82, v83
    v_cvt_pk_bf16_f32 v82, v84, v85
    v_cvt_pk_bf16_f32 v83, v86, v87
    s_nop 0
    v_permlane32_swap_b32 v80, v82
    v_permlane32_swap_b32 v81, v83
    buffer_store_dwordx4 v[80:83], v5, s[12:15], s57 offen offset:0 sc1
    v_pk_fma_f32 v[88:89], v[152:153], v[220:221], v[88:89] op_sel_hi:[1,0,1] neg_lo:[0,1,0] neg_hi:[0,1,0]
    v_pk_fma_f32 v[90:91], v[154:155], v[220:221], v[90:91] op_sel_hi:[1,0,1] neg_lo:[0,1,0] neg_hi:[0,1,0]
    v_pk_fma_f32 v[92:93], v[156:157], v[220:221], v[92:93] op_sel_hi:[1,0,1] neg_lo:[0,1,0] neg_hi:[0,1,0]
    v_pk_fma_f32 v[94:95], v[158:159], v[220:221], v[94:95] op_sel_hi:[1,0,1] neg_lo:[0,1,0] neg_hi:[0,1,0]
    v_pk_mul_f32 v[88:89], v[88:89], v[220:221] op_sel:[0,1] op_sel_hi:[1,1]
    v_pk_mul_f32 v[90:91], v[90:91], v[220:221] op_sel:[0,1] op_sel_hi:[1,1]
    v_pk_mul_f32 v[92:93], v[92:93], v[220:221] op_sel:[0,1] op_sel_hi:[1,1]
    v_pk_mul_f32 v[94:95], v[94:95], v[220:221] op_sel:[0,1] op_sel_hi:[1,1]
    v_cvt_pk_bf16_f32 v88, v88, v89
    v_cvt_pk_bf16_f32 v89, v90, v91
    v_cvt_pk_bf16_f32 v90, v92, v93
    v_cvt_pk_bf16_f32 v91, v94, v95
    s_nop 0
    v_permlane32_swap_b32 v88, v90
    v_permlane32_swap_b32 v89, v91
    buffer_store_dwordx4 v[88:91], v5, s[12:15], s57 offen offset:1024 sc1
    v_pk_fma_f32 v[96:97], v[160:161], v[220:221], v[96:97] op_sel_hi:[1,0,1] neg_lo:[0,1,0] neg_hi:[0,1,0]
    v_pk_fma_f32 v[98:99], v[162:163], v[220:221], v[98:99] op_sel_hi:[1,0,1] neg_lo:[0,1,0] neg_hi:[0,1,0]
    v_pk_fma_f32 v[100:101], v[164:165], v[220:221], v[100:101] op_sel_hi:[1,0,1] neg_lo:[0,1,0] neg_hi:[0,1,0]
    v_pk_fma_f32 v[102:103], v[166:167], v[220:221], v[102:103] op_sel_hi:[1,0,1] neg_lo:[0,1,0] neg_hi:[0,1,0]
    v_pk_mul_f32 v[96:97], v[96:97], v[220:221] op_sel:[0,1] op_sel_hi:[1,1]
    v_pk_mul_f32 v[98:99], v[98:99], v[220:221] op_sel:[0,1] op_sel_hi:[1,1]
    v_pk_mul_f32 v[100:101], v[100:101], v[220:221] op_sel:[0,1] op_sel_hi:[1,1]
    v_pk_mul_f32 v[102:103], v[102:103], v[220:221] op_sel:[0,1] op_sel_hi:[1,1]
    v_cvt_pk_bf16_f32 v96, v96, v97
    v_cvt_pk_bf16_f32 v97, v98, v99
    v_cvt_pk_bf16_f32 v98, v100, v101
    v_cvt_pk_bf16_f32 v99, v102, v103
    s_nop 0
    v_permlane32_swap_b32 v96, v98
    v_permlane32_swap_b32 v97, v99
    buffer_store_dwordx4 v[96:99], v5, s[12:15], s57 offen offset:2048 sc1
    v_pk_fma_f32 v[104:105], v[168:169], v[220:221], v[104:105] op_sel_hi:[1,0,1] neg_lo:[0,1,0] neg_hi:[0,1,0]
    v_pk_fma_f32 v[106:107], v[170:171], v[220:221], v[106:107] op_sel_hi:[1,0,1] neg_lo:[0,1,0] neg_hi:[0,1,0]
    v_pk_fma_f32 v[108:109], v[172:173], v[220:221], v[108:109] op_sel_hi:[1,0,1] neg_lo:[0,1,0] neg_hi:[0,1,0]
    v_pk_fma_f32 v[110:111], v[174:175], v[220:221], v[110:111] op_sel_hi:[1,0,1] neg_lo:[0,1,0] neg_hi:[0,1,0]
    v_pk_mul_f32 v[104:105], v[104:105], v[220:221] op_sel:[0,1] op_sel_hi:[1,1]
    v_pk_mul_f32 v[106:107], v[106:107], v[220:221] op_sel:[0,1] op_sel_hi:[1,1]
    v_pk_mul_f32 v[108:109], v[108:109], v[220:221] op_sel:[0,1] op_sel_hi:[1,1]
    v_pk_mul_f32 v[110:111], v[110:111], v[220:221] op_sel:[0,1] op_sel_hi:[1,1]
    v_cvt_pk_bf16_f32 v104, v104, v105
    v_cvt_pk_bf16_f32 v105, v106, v107
    v_cvt_pk_bf16_f32 v106, v108, v109
    v_cvt_pk_bf16_f32 v107, v110, v111
    s_nop 0
    v_permlane32_swap_b32 v104, v106
    v_permlane32_swap_b32 v105, v107
    buffer_store_dwordx4 v[104:107], v5, s[12:15], s57 offen offset:3072 sc1
    s_add_u32 s57, s57, 40960
    v_pk_fma_f32 v[112:113], v[144:145], v[224:225], v[112:113] op_sel_hi:[1,0,1] neg_lo:[0,1,0] neg_hi:[0,1,0]
    v_pk_fma_f32 v[114:115], v[146:147], v[224:225], v[114:115] op_sel_hi:[1,0,1] neg_lo:[0,1,0] neg_hi:[0,1,0]
    v_pk_fma_f32 v[116:117], v[148:149], v[224:225], v[116:117] op_sel_hi:[1,0,1] neg_lo:[0,1,0] neg_hi:[0,1,0]
    v_pk_fma_f32 v[118:119], v[150:151], v[224:225], v[118:119] op_sel_hi:[1,0,1] neg_lo:[0,1,0] neg_hi:[0,1,0]
    v_pk_mul_f32 v[112:113], v[112:113], v[224:225] op_sel:[0,1] op_sel_hi:[1,1]
    v_pk_mul_f32 v[114:115], v[114:115], v[224:225] op_sel:[0,1] op_sel_hi:[1,1]
    v_pk_mul_f32 v[116:117], v[116:117], v[224:225] op_sel:[0,1] op_sel_hi:[1,1]
    v_pk_mul_f32 v[118:119], v[118:119], v[224:225] op_sel:[0,1] op_sel_hi:[1,1]
    v_cvt_pk_bf16_f32 v112, v112, v113
    v_cvt_pk_bf16_f32 v113, v114, v115
    v_cvt_pk_bf16_f32 v114, v116, v117
    v_cvt_pk_bf16_f32 v115, v118, v119
    s_nop 0
    v_permlane32_swap_b32 v112, v114
    v_permlane32_swap_b32 v113, v115
    buffer_store_dwordx4 v[112:115], v5, s[12:15], s57 offen offset:0 sc1
    v_pk_fma_f32 v[120:121], v[152:153], v[224:225], v[120:121] op_sel_hi:[1,0,1] neg_lo:[0,1,0] neg_hi:[0,1,0]
    v_pk_fma_f32 v[122:123], v[154:155], v[224:225], v[122:123] op_sel_hi:[1,0,1] neg_lo:[0,1,0] neg_hi:[0,1,0]
    v_pk_fma_f32 v[124:125], v[156:157], v[224:225], v[124:125] op_sel_hi:[1,0,1] neg_lo:[0,1,0] neg_hi:[0,1,0]
    v_pk_fma_f32 v[126:127], v[158:159], v[224:225], v[126:127] op_sel_hi:[1,0,1] neg_lo:[0,1,0] neg_hi:[0,1,0]
    v_pk_mul_f32 v[120:121], v[120:121], v[224:225] op_sel:[0,1] op_sel_hi:[1,1]
    v_pk_mul_f32 v[122:123], v[122:123], v[224:225] op_sel:[0,1] op_sel_hi:[1,1]
    v_pk_mul_f32 v[124:125], v[124:125], v[224:225] op_sel:[0,1] op_sel_hi:[1,1]
    v_pk_mul_f32 v[126:127], v[126:127], v[224:225] op_sel:[0,1] op_sel_hi:[1,1]
    v_cvt_pk_bf16_f32 v120, v120, v121
    v_cvt_pk_bf16_f32 v121, v122, v123
    v_cvt_pk_bf16_f32 v122, v124, v125
    v_cvt_pk_bf16_f32 v123, v126, v127
    s_nop 0
    v_permlane32_swap_b32 v120, v122
    v_permlane32_swap_b32 v121, v123
    buffer_store_dwordx4 v[120:123], v5, s[12:15], s57 offen offset:1024 sc1
    v_pk_fma_f32 v[128:129], v[160:161], v[224:225], v[128:129] op_sel_hi:[1,0,1] neg_lo:[0,1,0] neg_hi:[0,1,0]
    v_pk_fma_f32 v[130:131], v[162:163], v[224:225], v[130:131] op_sel_hi:[1,0,1] neg_lo:[0,1,0] neg_hi:[0,1,0]
    v_pk_fma_f32 v[132:133], v[164:165], v[224:225], v[132:133] op_sel_hi:[1,0,1] neg_lo:[0,1,0] neg_hi:[0,1,0]
    v_pk_fma_f32 v[134:135], v[166:167], v[224:225], v[134:135] op_sel_hi:[1,0,1] neg_lo:[0,1,0] neg_hi:[0,1,0]
    v_pk_mul_f32 v[128:129], v[128:129], v[224:225] op_sel:[0,1] op_sel_hi:[1,1]
    v_pk_mul_f32 v[130:131], v[130:131], v[224:225] op_sel:[0,1] op_sel_hi:[1,1]
    v_pk_mul_f32 v[132:133], v[132:133], v[224:225] op_sel:[0,1] op_sel_hi:[1,1]
    v_pk_mul_f32 v[134:135], v[134:135], v[224:225] op_sel:[0,1] op_sel_hi:[1,1]
    v_cvt_pk_bf16_f32 v128, v128, v129
    v_cvt_pk_bf16_f32 v129, v130, v131
    v_cvt_pk_bf16_f32 v130, v132, v133
    v_cvt_pk_bf16_f32 v131, v134, v135
    s_nop 0
    v_permlane32_swap_b32 v128, v130
    v_permlane32_swap_b32 v129, v131
    buffer_store_dwordx4 v[128:131], v5, s[12:15], s57 offen offset:2048 sc1
    v_pk_fma_f32 v[136:137], v[168:169], v[224:225], v[136:137] op_sel_hi:[1,0,1] neg_lo:[0,1,0] neg_hi:[0,1,0]
    v_pk_fma_f32 v[138:139], v[170:171], v[224:225], v[138:139] op_sel_hi:[1,0,1] neg_lo:[0,1,0] neg_hi:[0,1,0]
    v_pk_fma_f32 v[140:141], v[172:173], v[224:225], v[140:141] op_sel_hi:[1,0,1] neg_lo:[0,1,0] neg_hi:[0,1,0]
    v_pk_fma_f32 v[142:143], v[174:175], v[224:225], v[142:143] op_sel_hi:[1,0,1] neg_lo:[0,1,0] neg_hi:[0,1,0]
    v_pk_mul_f32 v[136:137], v[136:137], v[224:225] op_sel:[0,1] op_sel_hi:[1,1]
    v_pk_mul_f32 v[138:139], v[138:139], v[224:225] op_sel:[0,1] op_sel_hi:[1,1]
    v_pk_mul_f32 v[140:141], v[140:141], v[224:225] op_sel:[0,1] op_sel_hi:[1,1]
    v_pk_mul_f32 v[142:143], v[142:143], v[224:225] op_sel:[0,1] op_sel_hi:[1,1]
    v_cvt_pk_bf16_f32 v136, v136, v137
    v_cvt_pk_bf16_f32 v137, v138, v139
    v_cvt_pk_bf16_f32 v138, v140, v141
    v_cvt_pk_bf16_f32 v139, v142, v143
    s_nop 0
    v_permlane32_swap_b32 v136, v138
    v_permlane32_swap_b32 v137, v139
    buffer_store_dwordx4 v[136:139], v5, s[12:15], s57 offen offset:3072 sc1
    s_add_u32 s57, s57, 40960
    s_branch L_qdone
L_modeV:
    s_waitcnt lgkmcnt(0)
    s_cmp_lt_u32 s46, 4
    s_cselect_b32 s56, s62, 1
    s_cmp_eq_u32 s56, 0
    s_cbranch_scc0 L_42
    s_lshl_b32 s56, s45, 2
    s_add_u32 s56, s56, s46
    s_lshl_b32 s56, s56, 9
    s_add_u32 s56, s56, 36864
    v_and_b32 v254, 3, v1
    v_lshlrev_b32 v254, 7, v254
    buffer_load_dword v255, v254, s[12:15], s56 offen sc1
L_42:
    s_barrier
    ds_read_b64_tr_b16 v[160:161], v204 offset:0
    ds_read_b64_tr_b16 v[162:163], v204 offset:1024
    ds_read_b64_tr_b16 v[164:165], v205 offset:0
    ds_read_b64_tr_b16 v[166:167], v205 offset:1024
    ds_read_b128 v[144:147], v192 offset:0
    ds_read_b128 v[148:151], v192 offset:6144
    ds_read_b128 v[152:155], v192 offset:12288
    ds_read_b128 v[156:159], v192 offset:18432
    s_waitcnt lgkmcnt(0)
    v_mfma_f32_32x32x16_bf16 v[16:31], v[144:147], v[160:163], 0
    ds_read_b64_tr_b16 v[184:185], v204 offset:12288
    ds_read_b64_tr_b16 v[186:187], v204 offset:13312
    v_mfma_f32_32x32x16_bf16 v[32:47], v[144:147], v[164:167], 0
    ds_read_b64_tr_b16 v[188:189], v205 offset:12288
    ds_read_b64_tr_b16 v[190:191], v205 offset:13312
    v_mfma_f32_32x32x16_bf16 v[48:63], v[148:151], v[160:163], 0
    ds_read_b128 v[168:171], v193 offset:0
    ds_read_b128 v[172:175], v193 offset:6144
    v_mfma_f32_32x32x16_bf16 v[64:79], v[148:151], v[164:167], 0
    ds_read_b128 v[176:179], v193 offset:12288
    ds_read_b128 v[180:183], v193 offset:18432
    v_mfma_f32_32x32x16_bf16 v[80:95], v[152:155], v[160:163], 0
    v_mfma_f32_32x32x16_bf16 v[96:111], v[152:155], v[164:167], 0
    v_mfma_f32_32x32x16_bf16 v[112:127], v[156:159], v[160:163], 0
    v_mfma_f32_32x32x16_bf16 v[128:143], v[156:159], v[164:167], 0
    s_waitcnt lgkmcnt(0)
    v_mfma_f32_32x32x16_bf16 v[16:31], v[168:171], v[184:187], v[16:31]
    ds_read_b64_tr_b16 v[160:161], v204 offset:24576
    ds_read_b64_tr_b16 v[162:163], v204 offset:25600
    v_mfma_f32_32x32x16_bf16 v[32:47], v[168:171], v[188:191], v[32:47]
    ds_read_b64_tr_b16 v[164:165], v205 offset:24576
    ds_read_b64_tr_b16 v[166:167], v205 offset:25600
    v_mfma_f32_32x32x16_bf16 v[48:63], v[172:175], v[184:187], v[48:63]
    ds_read_b128 v[144:147], v194 offset:0
    ds_read_b128 v[148:151], v194 offset:6144
    v_mfma_f32_32x32x16_bf16 v[64:79], v[172:175], v[188:191], v[64:79]
    ds_read_b128 v[152:155], v194 offset:12288
    ds_read_b128 v[156:159], v194 offset:18432
    v_mfma_f32_32x32x16_bf16 v[80:95], v[176:179], v[184:187], v[80:95]
    v_mfma_f32_32x32x16_bf16 v[96:111], v[176:179], v[188:191], v[96:111]
    v_mfma_f32_32x32x16_bf16 v[112:127], v[180:183], v[184:187], v[112:127]
    v_mfma_f32_32x32x16_bf16 v[128:143], v[180:183], v[188:191], v[128:143]
    s_waitcnt lgkmcnt(0)
    v_mfma_f32_32x32x16_bf16 v[16:31], v[144:147], v[160:163], v[16:31]
    ds_read_b64_tr_b16 v[184:185], v204 offset:36864
    ds_read_b64_tr_b16 v[186:187], v204 offset:37888
    v_mfma_f32_32x32x16_bf16 v[32:47], v[144:147], v[164:167], v[32:47]
    ds_read_b64_tr_b16 v[188:189], v205 offset:36864
    ds_read_b64_tr_b16 v[190:191], v205 offset:37888
    v_mfma_f32_32x32x16_bf16 v[48:63], v[148:151], v[160:163], v[48:63]
    ds_read_b128 v[168:171], v195 offset:0
    ds_read_b128 v[172:175], v195 offset:6144
    v_mfma_f32_32x32x16_bf16 v[64:79], v[148:151], v[164:167], v[64:79]
    ds_read_b128 v[176:179], v195 offset:12288
    ds_read_b128 v[180:183], v195 offset:18432
    v_mfma_f32_32x32x16_bf16 v[80:95], v[152:155], v[160:163], v[80:95]
    v_mfma_f32_32x32x16_bf16 v[96:111], v[152:155], v[164:167], v[96:111]
    v_mfma_f32_32x32x16_bf16 v[112:127], v[156:159], v[160:163], v[112:127]
    v_mfma_f32_32x32x16_bf16 v[128:143], v[156:159], v[164:167], v[128:143]
    s_waitcnt lgkmcnt(0)
    s_barrier
    v_mfma_f32_32x32x16_bf16 v[16:31], v[168:171], v[184:187], v[16:31]
    ds_read_b64_tr_b16 v[160:161], v206 offset:0
    ds_read_b64_tr_b16 v[162:163], v206 offset:1024
    v_mfma_f32_32x32x16_bf16 v[32:47], v[168:171], v[188:191], v[32:47]
    ds_read_b64_tr_b16 v[164:165], v207 offset:0
    ds_read_b64_tr_b16 v[166:167], v207 offset:1024
    v_mfma_f32_32x32x16_bf16 v[48:63], v[172:175], v[184:187], v[48:63]
    ds_read_b128 v[144:147], v196 offset:0
    ds_read_b128 v[148:151], v196 offset:6144
    v_mfma_f32_32x32x16_bf16 v[64:79], v[172:175], v[188:191], v[64:79]
    ds_read_b128 v[152:155], v196 offset:12288
    ds_read_b128 v[156:159], v196 offset:18432
    v_mfma_f32_32x32x16_bf16 v[80:95], v[176:179], v[184:187], v[80:95]
    v_mfma_f32_32x32x16_bf16 v[96:111], v[176:179], v[188:191], v[96:111]
    v_mfma_f32_32x32x16_bf16 v[112:127], v[180:183], v[184:187], v[112:127]
    v_mfma_f32_32x32x16_bf16 v[128:143], v[180:183], v[188:191], v[128:143]
    s_waitcnt lgkmcnt(0)
    v_mfma_f32_32x32x16_bf16 v[16:31], v[144:147], v[160:163], v[16:31]
    ds_read_b64_tr_b16 v[184:185], v206 offset:12288
    ds_read_b64_tr_b16 v[186:187], v206 offset:13312
    v_mfma_f32_32x32x16_bf16 v[32:47], v[144:147], v[164:167], v[32:47]
    ds_read_b64_tr_b16 v[188:189], v207 offset:12288
    ds_read_b64_tr_b16 v[190:191], v207 offset:13312
    v_mfma_f32_32x32x16_bf16 v[48:63], v[148:151], v[160:163], v[48:63]
    ds_read_b128 v[168:171], v197 offset:0
    ds_read_b128 v[172:175], v197 offset:6144
    v_mfma_f32_32x32x16_bf16 v[64:79], v[148:151], v[164:167], v[64:79]
    ds_read_b128 v[176:179], v197 offset:12288
    ds_read_b128 v[180:183], v197 offset:18432
    v_mfma_f32_32x32x16_bf16 v[80:95], v[152:155], v[160:163], v[80:95]
    v_mfma_f32_32x32x16_bf16 v[96:111], v[152:155], v[164:167], v[96:111]
    v_mfma_f32_32x32x16_bf16 v[112:127], v[156:159], v[160:163], v[112:127]
    v_mfma_f32_32x32x16_bf16 v[128:143], v[156:159], v[164:167], v[128:143]
    s_waitcnt lgkmcnt(0)
    v_mfma_f32_32x32x16_bf16 v[16:31], v[168:171], v[184:187], v[16:31]
    ds_read_b64_tr_b16 v[160:161], v206 offset:24576
    ds_read_b64_tr_b16 v[162:163], v206 offset:25600
    v_mfma_f32_32x32x16_bf16 v[32:47], v[168:171], v[188:191], v[32:47]
    ds_read_b64_tr_b16 v[164:165], v207 offset:24576
    ds_read_b64_tr_b16 v[166:167], v207 offset:25600
    v_mfma_f32_32x32x16_bf16 v[48:63], v[172:175], v[184:187], v[48:63]
    ds_read_b128 v[144:147], v198 offset:0
    ds_read_b128 v[148:151], v198 offset:6144
    v_mfma_f32_32x32x16_bf16 v[64:79], v[172:175], v[188:191], v[64:79]
    ds_read_b128 v[152:155], v198 offset:12288
    ds_read_b128 v[156:159], v198 offset:18432
    v_mfma_f32_32x32x16_bf16 v[80:95], v[176:179], v[184:187], v[80:95]
    v_mfma_f32_32x32x16_bf16 v[96:111], v[176:179], v[188:191], v[96:111]
    v_mfma_f32_32x32x16_bf16 v[112:127], v[180:183], v[184:187], v[112:127]
    v_mfma_f32_32x32x16_bf16 v[128:143], v[180:183], v[188:191], v[128:143]
    s_waitcnt lgkmcnt(0)
    v_mfma_f32_32x32x16_bf16 v[16:31], v[144:147], v[160:163], v[16:31]
    ds_read_b64_tr_b16 v[184:185], v206 offset:36864
    ds_read_b64_tr_b16 v[186:187], v206 offset:37888
    v_mfma_f32_32x32x16_bf16 v[32:47], v[144:147], v[164:167], v[32:47]
    ds_read_b64_tr_b16 v[188:189], v207 offset:36864
    ds_read_b64_tr_b16 v[190:191], v207 offset:37888
    v_mfma_f32_32x32x16_bf16 v[48:63], v[148:151], v[160:163], v[48:63]
    ds_read_b128 v[168:171], v199 offset:0
    ds_read_b128 v[172:175], v199 offset:6144
    v_mfma_f32_32x32x16_bf16 v[64:79], v[148:151], v[164:167], v[64:79]
    ds_read_b128 v[176:179], v199 offset:12288
    ds_read_b128 v[180:183], v199 offset:18432
    v_mfma_f32_32x32x16_bf16 v[80:95], v[152:155], v[160:163], v[80:95]
    v_mfma_f32_32x32x16_bf16 v[96:111], v[152:155], v[164:167], v[96:111]
    v_mfma_f32_32x32x16_bf16 v[112:127], v[156:159], v[160:163], v[112:127]
    v_mfma_f32_32x32x16_bf16 v[128:143], v[156:159], v[164:167], v[128:143]
    s_waitcnt lgkmcnt(0)
    s_barrier
    v_mfma_f32_32x32x16_bf16 v[16:31], v[168:171], v[184:187], v[16:31]
    ds_read_b64_tr_b16 v[160:161], v208 offset:0
    ds_read_b64_tr_b16 v[162:163], v208 offset:1024
    v_mfma_f32_32x32x16_bf16 v[32:47], v[168:171], v[188:191], v[32:47]
    ds_read_b64_tr_b16 v[164:165], v209 offset:0
    ds_read_b64_tr_b16 v[166:167], v209 offset:1024
    v_mfma_f32_32x32x16_bf16 v[48:63], v[172:175], v[184:187], v[48:63]
    ds_read_b128 v[144:147], v200 offset:0
    ds_read_b128 v[148:151], v200 offset:6144
    v_mfma_f32_32x32x16_bf16 v[64:79], v[172:175], v[188:191], v[64:79]
    ds_read_b128 v[152:155], v200 offset:12288
    ds_read_b128 v[156:159], v200 offset:18432
    v_mfma_f32_32x32x16_bf16 v[80:95], v[176:179], v[184:187], v[80:95]
    v_mfma_f32_32x32x16_bf16 v[96:111], v[176:179], v[188:191], v[96:111]
    v_mfma_f32_32x32x16_bf16 v[112:127], v[180:183], v[184:187], v[112:127]
    v_mfma_f32_32x32x16_bf16 v[128:143], v[180:183], v[188:191], v[128:143]
    s_waitcnt lgkmcnt(0)
    v_mfma_f32_32x32x16_bf16 v[16:31], v[144:147], v[160:163], v[16:31]
    ds_read_b64_tr_b16 v[184:185], v208 offset:12288
    ds_read_b64_tr_b16 v[186:187], v208 offset:13312
    v_mfma_f32_32x32x16_bf16 v[32:47], v[144:147], v[164:167], v[32:47]
    ds_read_b64_tr_b16 v[188:189], v209 offset:12288
    ds_read_b64_tr_b16 v[190:191], v209 offset:13312
    v_mfma_f32_32x32x16_bf16 v[48:63], v[148:151], v[160:163], v[48:63]
    ds_read_b128 v[168:171], v201 offset:0
    ds_read_b128 v[172:175], v201 offset:6144
    v_mfma_f32_32x32x16_bf16 v[64:79], v[148:151], v[164:167], v[64:79]
    ds_read_b128 v[176:179], v201 offset:12288
    ds_read_b128 v[180:183], v201 offset:18432
    v_mfma_f32_32x32x16_bf16 v[80:95], v[152:155], v[160:163], v[80:95]
    v_mfma_f32_32x32x16_bf16 v[96:111], v[152:155], v[164:167], v[96:111]
    v_mfma_f32_32x32x16_bf16 v[112:127], v[156:159], v[160:163], v[112:127]
    v_mfma_f32_32x32x16_bf16 v[128:143], v[156:159], v[164:167], v[128:143]
    s_waitcnt lgkmcnt(0)
    v_mfma_f32_32x32x16_bf16 v[16:31], v[168:171], v[184:187], v[16:31]
    ds_read_b64_tr_b16 v[160:161], v208 offset:24576
    ds_read_b64_tr_b16 v[162:163], v208 offset:25600
    v_mfma_f32_32x32x16_bf16 v[32:47], v[168:171], v[188:191], v[32:47]
    ds_read_b64_tr_b16 v[164:165], v209 offset:24576
    ds_read_b64_tr_b16 v[166:167], v209 offset:25600
    v_mfma_f32_32x32x16_bf16 v[48:63], v[172:175], v[184:187], v[48:63]
    ds_read_b128 v[144:147], v202 offset:0
    ds_read_b128 v[148:151], v202 offset:6144
    v_mfma_f32_32x32x16_bf16 v[64:79], v[172:175], v[188:191], v[64:79]
    ds_read_b128 v[152:155], v202 offset:12288
    ds_read_b128 v[156:159], v202 offset:18432
    v_mfma_f32_32x32x16_bf16 v[80:95], v[176:179], v[184:187], v[80:95]
    v_mfma_f32_32x32x16_bf16 v[96:111], v[176:179], v[188:191], v[96:111]
    v_mfma_f32_32x32x16_bf16 v[112:127], v[180:183], v[184:187], v[112:127]
    v_mfma_f32_32x32x16_bf16 v[128:143], v[180:183], v[188:191], v[128:143]
    s_waitcnt lgkmcnt(0)
    v_mfma_f32_32x32x16_bf16 v[16:31], v[144:147], v[160:163], v[16:31]
    ds_read_b64_tr_b16 v[184:185], v208 offset:36864
    ds_read_b64_tr_b16 v[186:187], v208 offset:37888
    v_mfma_f32_32x32x16_bf16 v[32:47], v[144:147], v[164:167], v[32:47]
    ds_read_b64_tr_b16 v[188:189], v209 offset:36864
    ds_read_b64_tr_b16 v[190:191], v209 offset:37888
    v_mfma_f32_32x32x16_bf16 v[48:63], v[148:151], v[160:163], v[48:63]
    ds_read_b128 v[168:171], v203 offset:0
    ds_read_b128 v[172:175], v203 offset:6144
    v_mfma_f32_32x32x16_bf16 v[64:79], v[148:151], v[164:167], v[64:79]
    ds_read_b128 v[176:179], v203 offset:12288
    ds_read_b128 v[180:183], v203 offset:18432
    v_mfma_f32_32x32x16_bf16 v[80:95], v[152:155], v[160:163], v[80:95]
    v_mfma_f32_32x32x16_bf16 v[96:111], v[152:155], v[164:167], v[96:111]
    v_mfma_f32_32x32x16_bf16 v[112:127], v[156:159], v[160:163], v[112:127]
    v_mfma_f32_32x32x16_bf16 v[128:143], v[156:159], v[164:167], v[128:143]
    s_waitcnt lgkmcnt(0)
    s_barrier
    v_mfma_f32_32x32x16_bf16 v[16:31], v[168:171], v[184:187], v[16:31]
    ds_read_b64_tr_b16 v[160:161], v204 offset:0
    ds_read_b64_tr_b16 v[162:163], v204 offset:1024
    v_mfma_f32_32x32x16_bf16 v[32:47], v[168:171], v[188:191], v[32:47]
    ds_read_b64_tr_b16 v[164:165], v205 offset:0
    ds_read_b64_tr_b16 v[166:167], v205 offset:1024
    v_mfma_f32_32x32x16_bf16 v[48:63], v[172:175], v[184:187], v[48:63]
    ds_read_b128 v[144:147], v192 offset:0
    ds_read_b128 v[148:151], v192 offset:6144
    v_mfma_f32_32x32x16_bf16 v[64:79], v[172:175], v[188:191], v[64:79]
    ds_read_b128 v[152:155], v192 offset:12288
    ds_read_b128 v[156:159], v192 offset:18432
    v_mfma_f32_32x32x16_bf16 v[80:95], v[176:179], v[184:187], v[80:95]
    v_mfma_f32_32x32x16_bf16 v[96:111], v[176:179], v[188:191], v[96:111]
    v_mfma_f32_32x32x16_bf16 v[112:127], v[180:183], v[184:187], v[112:127]
    v_mfma_f32_32x32x16_bf16 v[128:143], v[180:183], v[188:191], v[128:143]
    s_waitcnt lgkmcnt(0)
    v_mfma_f32_32x32x16_bf16 v[16:31], v[144:147], v[160:163], v[16:31]
    ds_read_b64_tr_b16 v[184:185], v204 offset:12288
    ds_read_b64_tr_b16 v[186:187], v204 offset:13312
    v_mfma_f32_32x32x16_bf16 v[32:47], v[144:147], v[164:167], v[32:47]
    ds_read_b64_tr_b16 v[188:189], v205 offset:12288
    ds_read_b64_tr_b16 v[190:191], v205 offset:13312
    v_mfma_f32_32x32x16_bf16 v[48:63], v[148:151], v[160:163], v[48:63]
    ds_read_b128 v[168:171], v193 offset:0
    ds_read_b128 v[172:175], v193 offset:6144
    v_mfma_f32_32x32x16_bf16 v[64:79], v[148:151], v[164:167], v[64:79]
    ds_read_b128 v[176:179], v193 offset:12288
    ds_read_b128 v[180:183], v193 offset:18432
    v_mfma_f32_32x32x16_bf16 v[80:95], v[152:155], v[160:163], v[80:95]
    v_mfma_f32_32x32x16_bf16 v[96:111], v[152:155], v[164:167], v[96:111]
    v_mfma_f32_32x32x16_bf16 v[112:127], v[156:159], v[160:163], v[112:127]
    v_mfma_f32_32x32x16_bf16 v[128:143], v[156:159], v[164:167], v[128:143]
    s_waitcnt lgkmcnt(0)
    v_mfma_f32_32x32x16_bf16 v[16:31], v[168:171], v[184:187], v[16:31]
    ds_read_b64_tr_b16 v[160:161], v204 offset:24576
    ds_read_b64_tr_b16 v[162:163], v204 offset:25600
    v_mfma_f32_32x32x16_bf16 v[32:47], v[168:171], v[188:191], v[32:47]
    ds_read_b64_tr_b16 v[164:165], v205 offset:24576
    ds_read_b64_tr_b16 v[166:167], v205 offset:25600
    v_mfma_f32_32x32x16_bf16 v[48:63], v[172:175], v[184:187], v[48:63]
    ds_read_b128 v[144:147], v194 offset:0
    ds_read_b128 v[148:151], v194 offset:6144
    v_mfma_f32_32x32x16_bf16 v[64:79], v[172:175], v[188:191], v[64:79]
    ds_read_b128 v[152:155], v194 offset:12288
    ds_read_b128 v[156:159], v194 offset:18432
    v_mfma_f32_32x32x16_bf16 v[80:95], v[176:179], v[184:187], v[80:95]
    v_mfma_f32_32x32x16_bf16 v[96:111], v[176:179], v[188:191], v[96:111]
    v_mfma_f32_32x32x16_bf16 v[112:127], v[180:183], v[184:187], v[112:127]
    v_mfma_f32_32x32x16_bf16 v[128:143], v[180:183], v[188:191], v[128:143]
    s_waitcnt lgkmcnt(0)
    v_mfma_f32_32x32x16_bf16 v[16:31], v[144:147], v[160:163], v[16:31]
    ds_read_b64_tr_b16 v[184:185], v204 offset:36864
    ds_read_b64_tr_b16 v[186:187], v204 offset:37888
    v_mfma_f32_32x32x16_bf16 v[32:47], v[144:147], v[164:167], v[32:47]
    ds_read_b64_tr_b16 v[188:189], v205 offset:36864
    ds_read_b64_tr_b16 v[190:191], v205 offset:37888
    v_mfma_f32_32x32x16_bf16 v[48:63], v[148:151], v[160:163], v[48:63]
    ds_read_b128 v[168:171], v195 offset:0
    ds_read_b128 v[172:175], v195 offset:6144
    v_mfma_f32_32x32x16_bf16 v[64:79], v[148:151], v[164:167], v[64:79]
    ds_read_b128 v[176:179], v195 offset:12288
    ds_read_b128 v[180:183], v195 offset:18432
    v_mfma_f32_32x32x16_bf16 v[80:95], v[152:155], v[160:163], v[80:95]
    v_mfma_f32_32x32x16_bf16 v[96:111], v[152:155], v[164:167], v[96:111]
    v_mfma_f32_32x32x16_bf16 v[112:127], v[156:159], v[160:163], v[112:127]
    v_mfma_f32_32x32x16_bf16 v[128:143], v[156:159], v[164:167], v[128:143]
    s_waitcnt lgkmcnt(0)
    s_barrier
    v_mfma_f32_32x32x16_bf16 v[16:31], v[168:171], v[184:187], v[16:31]
    v_mov_b32 v254, 0
    buffer_load_dwordx2 v[250:251], v254, s[40:43], 0 offen sc1
    ds_read_b64_tr_b16 v[160:161], v206 offset:0
    ds_read_b64_tr_b16 v[162:163], v206 offset:1024
    v_mfma_f32_32x32x16_bf16 v[32:47], v[168:171], v[188:191], v[32:47]
    ds_read_b64_tr_b16 v[164:165], v207 offset:0
    ds_read_b64_tr_b16 v[166:167], v207 offset:1024
    v_mfma_f32_32x32x16_bf16 v[48:63], v[172:175], v[184:187], v[48:63]
    ds_read_b128 v[144:147], v196 offset:0
    ds_read_b128 v[148:151], v196 offset:6144
    v_mfma_f32_32x32x16_bf16 v[64:79], v[172:175], v[188:191], v[64:79]
    ds_read_b128 v[152:155], v196 offset:12288
    ds_read_b128 v[156:159], v196 offset:18432
    v_mfma_f32_32x32x16_bf16 v[80:95], v[176:179], v[184:187], v[80:95]
    v_mfma_f32_32x32x16_bf16 v[96:111], v[176:179], v[188:191], v[96:111]
    v_mfma_f32_32x32x16_bf16 v[112:127], v[180:183], v[184:187], v[112:127]
    v_mfma_f32_32x32x16_bf16 v[128:143], v[180:183], v[188:191], v[128:143]
    s_waitcnt lgkmcnt(0)
    v_mfma_f32_32x32x16_bf16 v[16:31], v[144:147], v[160:163], v[16:31]
    ds_read_b64_tr_b16 v[184:185], v206 offset:12288
    ds_read_b64_tr_b16 v[186:187], v206 offset:13312
    v_mfma_f32_32x32x16_bf16 v[32:47], v[144:147], v[164:167], v[32:47]
    ds_read_b64_tr_b16 v[188:189], v207 offset:12288
    ds_read_b64_tr_b16 v[190:191], v207 offset:13312
    v_mfma_f32_32x32x16_bf16 v[48:63], v[148:151], v[160:163], v[48:63]
    ds_read_b128 v[168:171], v197 offset:0
    ds_read_b128 v[172:175], v197 offset:6144
    v_mfma_f32_32x32x16_bf16 v[64:79], v[148:151], v[164:167], v[64:79]
    ds_read_b128 v[176:179], v197 offset:12288
    ds_read_b128 v[180:183], v197 offset:18432
    v_mfma_f32_32x32x16_bf16 v[80:95], v[152:155], v[160:163], v[80:95]
    v_mfma_f32_32x32x16_bf16 v[96:111], v[152:155], v[164:167], v[96:111]
    v_mfma_f32_32x32x16_bf16 v[112:127], v[156:159], v[160:163], v[112:127]
    v_mfma_f32_32x32x16_bf16 v[128:143], v[156:159], v[164:167], v[128:143]
    s_waitcnt lgkmcnt(0)
    v_mfma_f32_32x32x16_bf16 v[16:31], v[168:171], v[184:187], v[16:31]
    ds_read_b64_tr_b16 v[160:161], v206 offset:24576
    ds_read_b64_tr_b16 v[162:163], v206 offset:25600
    v_mfma_f32_32x32x16_bf16 v[32:47], v[168:171], v[188:191], v[32:47]
    ds_read_b64_tr_b16 v[164:165], v207 offset:24576
    ds_read_b64_tr_b16 v[166:167], v207 offset:25600
    v_mfma_f32_32x32x16_bf16 v[48:63], v[172:175], v[184:187], v[48:63]
    ds_read_b128 v[144:147], v198 offset:0
    ds_read_b128 v[148:151], v198 offset:6144
    v_mfma_f32_32x32x16_bf16 v[64:79], v[172:175], v[188:191], v[64:79]
    ds_read_b128 v[152:155], v198 offset:12288
    ds_read_b128 v[156:159], v198 offset:18432
    v_mfma_f32_32x32x16_bf16 v[80:95], v[176:179], v[184:187], v[80:95]
    v_mfma_f32_32x32x16_bf16 v[96:111], v[176:179], v[188:191], v[96:111]
    v_mfma_f32_32x32x16_bf16 v[112:127], v[180:183], v[184:187], v[112:127]
    v_mfma_f32_32x32x16_bf16 v[128:143], v[180:183], v[188:191], v[128:143]
    s_waitcnt lgkmcnt(0)
    v_mfma_f32_32x32x16_bf16 v[16:31], v[144:147], v[160:163], v[16:31]
    ds_read_b64_tr_b16 v[184:185], v206 offset:36864
    ds_read_b64_tr_b16 v[186:187], v206 offset:37888
    v_mfma_f32_32x32x16_bf16 v[32:47], v[144:147], v[164:167], v[32:47]
    ds_read_b64_tr_b16 v[188:189], v207 offset:36864
    ds_read_b64_tr_b16 v[190:191], v207 offset:37888
    v_mfma_f32_32x32x16_bf16 v[48:63], v[148:151], v[160:163], v[48:63]
    ds_read_b128 v[168:171], v199 offset:0
    ds_read_b128 v[172:175], v199 offset:6144
    v_mfma_f32_32x32x16_bf16 v[64:79], v[148:151], v[164:167], v[64:79]
    ds_read_b128 v[176:179], v199 offset:12288
    ds_read_b128 v[180:183], v199 offset:18432
    v_mfma_f32_32x32x16_bf16 v[80:95], v[152:155], v[160:163], v[80:95]
    v_mfma_f32_32x32x16_bf16 v[96:111], v[152:155], v[164:167], v[96:111]
    v_mfma_f32_32x32x16_bf16 v[112:127], v[156:159], v[160:163], v[112:127]
    v_mfma_f32_32x32x16_bf16 v[128:143], v[156:159], v[164:167], v[128:143]
    s_waitcnt lgkmcnt(0)
    s_barrier
    v_mfma_f32_32x32x16_bf16 v[16:31], v[168:171], v[184:187], v[16:31]
    s_waitcnt vmcnt(0)
    v_mov_b32 v254, 0
    s_mov_b32 s97, 400000
nl_43:
    v_readfirstlane_b32 s50, v250
    v_readfirstlane_b32 s51, v251
    s_cmp_lg_u32 s50, 0
    s_cbranch_scc1 ok_44
    s_sleep 2
    buffer_load_dwordx2 v[250:251], v254, s[40:43], 0 offen sc1
    s_waitcnt vmcnt(0)
    s_sub_u32 s97, s97, 1
    s_cbranch_scc0 nl_43
    v_mov_b32 v14, 48
    v_mov_b32 v15, 232
    buffer_store_dword v15, v14, s[40:43], 0 offen
ok_44:
    ds_read_b64_tr_b16 v[160:161], v208 offset:0
    ds_read_b64_tr_b16 v[162:163], v208 offset:1024
    v_mfma_f32_32x32x16_bf16 v[32:47], v[168:171], v[188:191], v[32:47]
    ds_read_b64_tr_b16 v[164:165], v209 offset:0
    ds_read_b64_tr_b16 v[166:167], v209 offset:1024
    v_mfma_f32_32x32x16_bf16 v[48:63], v[172:175], v[184:187], v[48:63]
    ds_read_b128 v[144:147], v200 offset:0
    ds_read_b128 v[148:151], v200 offset:6144
    v_mfma_f32_32x32x16_bf16 v[64:79], v[172:175], v[188:191], v[64:79]
    ds_read_b128 v[152:155], v200 offset:12288
    ds_read_b128 v[156:159], v200 offset:18432
    v_mfma_f32_32x32x16_bf16 v[80:95], v[176:179], v[184:187], v[80:95]
    v_mfma_f32_32x32x16_bf16 v[96:111], v[176:179], v[188:191], v[96:111]
    v_mfma_f32_32x32x16_bf16 v[112:127], v[180:183], v[184:187], v[112:127]
    v_mfma_f32_32x32x16_bf16 v[128:143], v[180:183], v[188:191], v[128:143]
    s_waitcnt lgkmcnt(0)
    v_mfma_f32_32x32x16_bf16 v[16:31], v[144:147], v[160:163], v[16:31]
    ds_read_b64_tr_b16 v[184:185], v208 offset:12288
    ds_read_b64_tr_b16 v[186:187], v208 offset:13312
    v_mfma_f32_32x32x16_bf16 v[32:47], v[144:147], v[164:167], v[32:47]
    ds_read_b64_tr_b16 v[188:189], v209 offset:12288
    ds_read_b64_tr_b16 v[190:191], v209 offset:13312
    v_mfma_f32_32x32x16_bf16 v[48:63], v[148:151], v[160:163], v[48:63]
    ds_read_b128 v[168:171], v201 offset:0
    ds_read_b128 v[172:175], v201 offset:6144
    v_mfma_f32_32x32x16_bf16 v[64:79], v[148:151], v[164:167], v[64:79]
    ds_read_b128 v[176:179], v201 offset:12288
    ds_read_b128 v[180:183], v201 offset:18432
    v_mfma_f32_32x32x16_bf16 v[80:95], v[152:155], v[160:163], v[80:95]
    v_mfma_f32_32x32x16_bf16 v[96:111], v[152:155], v[164:167], v[96:111]
    v_mfma_f32_32x32x16_bf16 v[112:127], v[156:159], v[160:163], v[112:127]
    v_mfma_f32_32x32x16_bf16 v[128:143], v[156:159], v[164:167], v[128:143]
    s_waitcnt lgkmcnt(0)
    v_mfma_f32_32x32x16_bf16 v[16:31], v[168:171], v[184:187], v[16:31]
    ds_read_b64_tr_b16 v[160:161], v208 offset:24576
    ds_read_b64_tr_b16 v[162:163], v208 offset:25600
    v_mfma_f32_32x32x16_bf16 v[32:47], v[168:171], v[188:191], v[32:47]
    ds_read_b64_tr_b16 v[164:165], v209 offset:24576
    ds_read_b64_tr_b16 v[166:167], v209 offset:25600
    v_mfma_f32_32x32x16_bf16 v[48:63], v[172:175], v[184:187], v[48:63]
    ds_read_b128 v[144:147], v202 offset:0
    ds_read_b128 v[148:151], v202 offset:6144
    v_mfma_f32_32x32x16_bf16 v[64:79], v[172:175], v[188:191], v[64:79]
    ds_read_b128 v[152:155], v202 offset:12288
    ds_read_b128 v[156:159], v202 offset:18432
    v_mfma_f32_32x32x16_bf16 v[80:95], v[176:179], v[184:187], v[80:95]
    v_mfma_f32_32x32x16_bf16 v[96:111], v[176:179], v[188:191], v[96:111]
    v_mfma_f32_32x32x16_bf16 v[112:127], v[180:183], v[184:187], v[112:127]
    v_mfma_f32_32x32x16_bf16 v[128:143], v[180:183], v[188:191], v[128:143]
    s_waitcnt lgkmcnt(0)
    v_mfma_f32_32x32x16_bf16 v[16:31], v[144:147], v[160:163], v[16:31]
    ds_read_b64_tr_b16 v[184:185], v208 offset:36864
    ds_read_b64_tr_b16 v[186:187], v208 offset:37888
    v_mfma_f32_32x32x16_bf16 v[32:47], v[144:147], v[164:167], v[32:47]
    ds_read_b64_tr_b16 v[188:189], v209 offset:36864
    ds_read_b64_tr_b16 v[190:191], v209 offset:37888
    v_mfma_f32_32x32x16_bf16 v[48:63], v[148:151], v[160:163], v[48:63]
    ds_read_b128 v[168:171], v203 offset:0
    ds_read_b128 v[172:175], v203 offset:6144
    v_mfma_f32_32x32x16_bf16 v[64:79], v[148:151], v[164:167], v[64:79]
    ds_read_b128 v[176:179], v203 offset:12288
    ds_read_b128 v[180:183], v203 offset:18432
    v_mfma_f32_32x32x16_bf16 v[80:95], v[152:155], v[160:163], v[80:95]
    v_mfma_f32_32x32x16_bf16 v[96:111], v[152:155], v[164:167], v[96:111]
    v_mfma_f32_32x32x16_bf16 v[112:127], v[156:159], v[160:163], v[112:127]
    v_mfma_f32_32x32x16_bf16 v[128:143], v[156:159], v[164:167], v[128:143]
    s_waitcnt lgkmcnt(0)
    s_barrier
    v_mfma_f32_32x32x16_bf16 v[16:31], v[168:171], v[184:187], v[16:31]
    ds_read_b64_tr_b16 v[160:161], v204 offset:0
    ds_read_b64_tr_b16 v[162:163], v204 offset:1024
    v_mfma_f32_32x32x16_bf16 v[32:47], v[168:171], v[188:191], v[32:47]
    ds_read_b64_tr_b16 v[164:165], v205 offset:0
    ds_read_b64_tr_b16 v[166:167], v205 offset:1024
    v_mfma_f32_32x32x16_bf16 v[48:63], v[172:175], v[184:187], v[48:63]
    ds_read_b128 v[144:147], v192 offset:0
    ds_read_b128 v[148:151], v192 offset:6144
    v_mfma_f32_32x32x16_bf16 v[64:79], v[172:175], v[188:191], v[64:79]
    ds_read_b128 v[152:155], v192 offset:12288
    ds_read_b128 v[156:159], v192 offset:18432
    v_mfma_f32_32x32x16_bf16 v[80:95], v[176:179], v[184:187], v[80:95]
    v_mfma_f32_32x32x16_bf16 v[96:111], v[176:179], v[188:191], v[96:111]
    v_mfma_f32_32x32x16_bf16 v[112:127], v[180:183], v[184:187], v[112:127]
    v_mfma_f32_32x32x16_bf16 v[128:143], v[180:183], v[188:191], v[128:143]
    s_waitcnt lgkmcnt(0)
    v_mfma_f32_32x32x16_bf16 v[16:31], v[144:147], v[160:163], v[16:31]
    ds_read_b64_tr_b16 v[184:185], v204 offset:12288
    ds_read_b64_tr_b16 v[186:187], v204 offset:13312
    v_mfma_f32_32x32x16_bf16 v[32:47], v[144:147], v[164:167], v[32:47]
    ds_read_b64_tr_b16 v[188:189], v205 offset:12288
    ds_read_b64_tr_b16 v[190:191], v205 offset:13312
    v_mfma_f32_32x32x16_bf16 v[48:63], v[148:151], v[160:163], v[48:63]
    ds_read_b128 v[168:171], v193 offset:0
    ds_read_b128 v[172:175], v193 offset:6144
    v_mfma_f32_32x32x16_bf16 v[64:79], v[148:151], v[164:167], v[64:79]
    ds_read_b128 v[176:179], v193 offset:12288
    ds_read_b128 v[180:183], v193 offset:18432
    v_mfma_f32_32x32x16_bf16 v[80:95], v[152:155], v[160:163], v[80:95]
    v_mfma_f32_32x32x16_bf16 v[96:111], v[152:155], v[164:167], v[96:111]
    v_mfma_f32_32x32x16_bf16 v[112:127], v[156:159], v[160:163], v[112:127]
    v_mfma_f32_32x32x16_bf16 v[128:143], v[156:159], v[164:167], v[128:143]
    s_waitcnt lgkmcnt(0)
    v_mfma_f32_32x32x16_bf16 v[16:31], v[168:171], v[184:187], v[16:31]
    ds_read_b64_tr_b16 v[160:161], v204 offset:24576
    ds_read_b64_tr_b16 v[162:163], v204 offset:25600
    v_mfma_f32_32x32x16_bf16 v[32:47], v[168:171], v[188:191], v[32:47]
    ds_read_b64_tr_b16 v[164:165], v205 offset:24576
    ds_read_b64_tr_b16 v[166:167], v205 offset:25600
    v_mfma_f32_32x32x16_bf16 v[48:63], v[172:175], v[184:187], v[48:63]
    ds_read_b128 v[144:147], v194 offset:0
    ds_read_b128 v[148:151], v194 offset:6144
    v_mfma_f32_32x32x16_bf16 v[64:79], v[172:175], v[188:191], v[64:79]
    ds_read_b128 v[152:155], v194 offset:12288
    ds_read_b128 v[156:159], v194 offset:18432
    v_mfma_f32_32x32x16_bf16 v[80:95], v[176:179], v[184:187], v[80:95]
    v_mfma_f32_32x32x16_bf16 v[96:111], v[176:179], v[188:191], v[96:111]
    v_mfma_f32_32x32x16_bf16 v[112:127], v[180:183], v[184:187], v[112:127]
    v_mfma_f32_32x32x16_bf16 v[128:143], v[180:183], v[188:191], v[128:143]
    s_waitcnt lgkmcnt(0)
    v_mfma_f32_32x32x16_bf16 v[16:31], v[144:147], v[160:163], v[16:31]
    ds_read_b64_tr_b16 v[184:185], v204 offset:36864
    ds_read_b64_tr_b16 v[186:187], v204 offset:37888
    v_mfma_f32_32x32x16_bf16 v[32:47], v[144:147], v[164:167], v[32:47]
    ds_read_b64_tr_b16 v[188:189], v205 offset:36864
    ds_read_b64_tr_b16 v[190:191], v205 offset:37888
    v_mfma_f32_32x32x16_bf16 v[48:63], v[148:151], v[160:163], v[48:63]
    ds_read_b128 v[168:171], v195 offset:0
    ds_read_b128 v[172:175], v195 offset:6144
    v_mfma_f32_32x32x16_bf16 v[64:79], v[148:151], v[164:167], v[64:79]
    ds_read_b128 v[176:179], v195 offset:12288
    ds_read_b128 v[180:183], v195 offset:18432
    v_mfma_f32_32x32x16_bf16 v[80:95], v[152:155], v[160:163], v[80:95]
    v_mfma_f32_32x32x16_bf16 v[96:111], v[152:155], v[164:167], v[96:111]
    v_mfma_f32_32x32x16_bf16 v[112:127], v[156:159], v[160:163], v[112:127]
    v_mfma_f32_32x32x16_bf16 v[128:143], v[156:159], v[164:167], v[128:143]
    s_waitcnt lgkmcnt(0)
    s_barrier
    v_mfma_f32_32x32x16_bf16 v[16:31], v[168:171], v[184:187], v[16:31]
    ds_read_b64_tr_b16 v[160:161], v206 offset:0
    ds_read_b64_tr_b16 v[162:163], v206 offset:1024
    v_mfma_f32_32x32x16_bf16 v[32:47], v[168:171], v[188:191], v[32:47]
    ds_read_b64_tr_b16 v[164:165], v207 offset:0
    ds_read_b64_tr_b16 v[166:167], v207 offset:1024
    v_mfma_f32_32x32x16_bf16 v[48:63], v[172:175], v[184:187], v[48:63]
    ds_read_b128 v[144:147], v196 offset:0
    ds_read_b128 v[148:151], v196 offset:6144
    v_mfma_f32_32x32x16_bf16 v[64:79], v[172:175], v[188:191], v[64:79]
    ds_read_b128 v[152:155], v196 offset:12288
    ds_read_b128 v[156:159], v196 offset:18432
    v_mfma_f32_32x32x16_bf16 v[80:95], v[176:179], v[184:187], v[80:95]
    v_mfma_f32_32x32x16_bf16 v[96:111], v[176:179], v[188:191], v[96:111]
    v_mfma_f32_32x32x16_bf16 v[112:127], v[180:183], v[184:187], v[112:127]
    v_mfma_f32_32x32x16_bf16 v[128:143], v[180:183], v[188:191], v[128:143]
    s_waitcnt lgkmcnt(0)
    v_mfma_f32_32x32x16_bf16 v[16:31], v[144:147], v[160:163], v[16:31]
    ds_read_b64_tr_b16 v[184:185], v206 offset:12288
    ds_read_b64_tr_b16 v[186:187], v206 offset:13312
    v_mfma_f32_32x32x16_bf16 v[32:47], v[144:147], v[164:167], v[32:47]
    ds_read_b64_tr_b16 v[188:189], v207 offset:12288
    ds_read_b64_tr_b16 v[190:191], v207 offset:13312
    v_mfma_f32_32x32x16_bf16 v[48:63], v[148:151], v[160:163], v[48:63]
    ds_read_b128 v[168:171], v197 offset:0
    ds_read_b128 v[172:175], v197 offset:6144
    v_mfma_f32_32x32x16_bf16 v[64:79], v[148:151], v[164:167], v[64:79]
    ds_read_b128 v[176:179], v197 offset:12288
    ds_read_b128 v[180:183], v197 offset:18432
    v_mfma_f32_32x32x16_bf16 v[80:95], v[152:155], v[160:163], v[80:95]
    v_mfma_f32_32x32x16_bf16 v[96:111], v[152:155], v[164:167], v[96:111]
    v_mfma_f32_32x32x16_bf16 v[112:127], v[156:159], v[160:163], v[112:127]
    v_mfma_f32_32x32x16_bf16 v[128:143], v[156:159], v[164:167], v[128:143]
    s_waitcnt lgkmcnt(0)
    v_mfma_f32_32x32x16_bf16 v[16:31], v[168:171], v[184:187], v[16:31]
    ds_read_b64_tr_b16 v[160:161], v206 offset:24576
    ds_read_b64_tr_b16 v[162:163], v206 offset:25600
    v_mfma_f32_32x32x16_bf16 v[32:47], v[168:171], v[188:191], v[32:47]
    ds_read_b64_tr_b16 v[164:165], v207 offset:24576
    ds_read_b64_tr_b16 v[166:167], v207 offset:25600
    v_mfma_f32_32x32x16_bf16 v[48:63], v[172:175], v[184:187], v[48:63]
    ds_read_b128 v[144:147], v198 offset:0
    ds_read_b128 v[148:151], v198 offset:6144
    v_mfma_f32_32x32x16_bf16 v[64:79], v[172:175], v[188:191], v[64:79]
    ds_read_b128 v[152:155], v198 offset:12288
    ds_read_b128 v[156:159], v198 offset:18432
    v_mfma_f32_32x32x16_bf16 v[80:95], v[176:179], v[184:187], v[80:95]
    v_mfma_f32_32x32x16_bf16 v[96:111], v[176:179], v[188:191], v[96:111]
    v_mfma_f32_32x32x16_bf16 v[112:127], v[180:183], v[184:187], v[112:127]
    v_mfma_f32_32x32x16_bf16 v[128:143], v[180:183], v[188:191], v[128:143]
    s_waitcnt lgkmcnt(0)
    v_mfma_f32_32x32x16_bf16 v[16:31], v[144:147], v[160:163], v[16:31]
    ds_read_b64_tr_b16 v[184:185], v206 offset:36864
    ds_read_b64_tr_b16 v[186:187], v206 offset:37888
    v_mfma_f32_32x32x16_bf16 v[32:47], v[144:147], v[164:167], v[32:47]
    ds_read_b64_tr_b16 v[188:189], v207 offset:36864
    ds_read_b64_tr_b16 v[190:191], v207 offset:37888
    v_mfma_f32_32x32x16_bf16 v[48:63], v[148:151], v[160:163], v[48:63]
    ds_read_b128 v[168:171], v199 offset:0
    ds_read_b128 v[172:175], v199 offset:6144
    v_mfma_f32_32x32x16_bf16 v[64:79], v[148:151], v[164:167], v[64:79]
    ds_read_b128 v[176:179], v199 offset:12288
    ds_read_b128 v[180:183], v199 offset:18432
    v_mfma_f32_32x32x16_bf16 v[80:95], v[152:155], v[160:163], v[80:95]
    v_mfma_f32_32x32x16_bf16 v[96:111], v[152:155], v[164:167], v[96:111]
    v_mfma_f32_32x32x16_bf16 v[112:127], v[156:159], v[160:163], v[112:127]
    v_mfma_f32_32x32x16_bf16 v[128:143], v[156:159], v[164:167], v[128:143]
    s_waitcnt lgkmcnt(0)
    s_barrier
    v_mfma_f32_32x32x16_bf16 v[16:31], v[168:171], v[184:187], v[16:31]
    ds_read_b64_tr_b16 v[160:161], v208 offset:0
    ds_read_b64_tr_b16 v[162:163], v208 offset:1024
    v_mfma_f32_32x32x16_bf16 v[32:47], v[168:171], v[188:191], v[32:47]
    ds_read_b64_tr_b16 v[164:165], v209 offset:0
    ds_read_b64_tr_b16 v[166:167], v209 offset:1024
    v_mfma_f32_32x32x16_bf16 v[48:63], v[172:175], v[184:187], v[48:63]
    ds_read_b128 v[144:147], v200 offset:0
    ds_read_b128 v[148:151], v200 offset:6144
    v_mfma_f32_32x32x16_bf16 v[64:79], v[172:175], v[188:191], v[64:79]
    ds_read_b128 v[152:155], v200 offset:12288
    ds_read_b128 v[156:159], v200 offset:18432
    v_mfma_f32_32x32x16_bf16 v[80:95], v[176:179], v[184:187], v[80:95]
    v_mfma_f32_32x32x16_bf16 v[96:111], v[176:179], v[188:191], v[96:111]
    v_mfma_f32_32x32x16_bf16 v[112:127], v[180:183], v[184:187], v[112:127]
    v_mfma_f32_32x32x16_bf16 v[128:143], v[180:183], v[188:191], v[128:143]
    s_waitcnt lgkmcnt(0)
    v_mfma_f32_32x32x16_bf16 v[16:31], v[144:147], v[160:163], v[16:31]
    ds_read_b64_tr_b16 v[184:185], v208 offset:12288
    ds_read_b64_tr_b16 v[186:187], v208 offset:13312
    v_mfma_f32_32x32x16_bf16 v[32:47], v[144:147], v[164:167], v[32:47]
    ds_read_b64_tr_b16 v[188:189], v209 offset:12288
    ds_read_b64_tr_b16 v[190:191], v209 offset:13312
    v_mfma_f32_32x32x16_bf16 v[48:63], v[148:151], v[160:163], v[48:63]
    ds_read_b128 v[168:171], v201 offset:0
    ds_read_b128 v[172:175], v201 offset:6144
    v_mfma_f32_32x32x16_bf16 v[64:79], v[148:151], v[164:167], v[64:79]
    ds_read_b128 v[176:179], v201 offset:12288
    ds_read_b128 v[180:183], v201 offset:18432
    v_mfma_f32_32x32x16_bf16 v[80:95], v[152:155], v[160:163], v[80:95]
    v_mfma_f32_32x32x16_bf16 v[96:111], v[152:155], v[164:167], v[96:111]
    v_mfma_f32_32x32x16_bf16 v[112:127], v[156:159], v[160:163], v[112:127]
    v_mfma_f32_32x32x16_bf16 v[128:143], v[156:159], v[164:167], v[128:143]
    s_waitcnt lgkmcnt(0)
    v_mfma_f32_32x32x16_bf16 v[16:31], v[168:171], v[184:187], v[16:31]
    ds_read_b64_tr_b16 v[160:161], v208 offset:24576
    ds_read_b64_tr_b16 v[162:163], v208 offset:25600
    v_mfma_f32_32x32x16_bf16 v[32:47], v[168:171], v[188:191], v[32:47]
    ds_read_b64_tr_b16 v[164:165], v209 offset:24576
    ds_read_b64_tr_b16 v[166:167], v209 offset:25600
    v_mfma_f32_32x32x16_bf16 v[48:63], v[172:175], v[184:187], v[48:63]
    ds_read_b128 v[144:147], v202 offset:0
    ds_read_b128 v[148:151], v202 offset:6144
    v_mfma_f32_32x32x16_bf16 v[64:79], v[172:175], v[188:191], v[64:79]
    ds_read_b128 v[152:155], v202 offset:12288
    ds_read_b128 v[156:159], v202 offset:18432
    v_mfma_f32_32x32x16_bf16 v[80:95], v[176:179], v[184:187], v[80:95]
    v_mfma_f32_32x32x16_bf16 v[96:111], v[176:179], v[188:191], v[96:111]
    v_mfma_f32_32x32x16_bf16 v[112:127], v[180:183], v[184:187], v[112:127]
    v_mfma_f32_32x32x16_bf16 v[128:143], v[180:183], v[188:191], v[128:143]
    s_waitcnt lgkmcnt(0)
    v_mfma_f32_32x32x16_bf16 v[16:31], v[144:147], v[160:163], v[16:31]
    ds_read_b64_tr_b16 v[184:185], v208 offset:36864
    ds_read_b64_tr_b16 v[186:187], v208 offset:37888
    v_mfma_f32_32x32x16_bf16 v[32:47], v[144:147], v[164:167], v[32:47]
    ds_read_b64_tr_b16 v[188:189], v209 offset:36864
    ds_read_b64_tr_b16 v[190:191], v209 offset:37888
    v_mfma_f32_32x32x16_bf16 v[48:63], v[148:151], v[160:163], v[48:63]
    ds_read_b128 v[168:171], v203 offset:0
    ds_read_b128 v[172:175], v203 offset:6144
    v_mfma_f32_32x32x16_bf16 v[64:79], v[148:151], v[164:167], v[64:79]
    ds_read_b128 v[176:179], v203 offset:12288
    ds_read_b128 v[180:183], v203 offset:18432
    v_mfma_f32_32x32x16_bf16 v[80:95], v[152:155], v[160:163], v[80:95]
    v_mfma_f32_32x32x16_bf16 v[96:111], v[152:155], v[164:167], v[96:111]
    v_mfma_f32_32x32x16_bf16 v[112:127], v[156:159], v[160:163], v[112:127]
    v_mfma_f32_32x32x16_bf16 v[128:143], v[156:159], v[164:167], v[128:143]
    s_waitcnt lgkmcnt(0)
    s_barrier
    v_mfma_f32_32x32x16_bf16 v[16:31], v[168:171], v[184:187], v[16:31]
    ds_read_b64_tr_b16 v[160:161], v204 offset:0
    ds_read_b64_tr_b16 v[162:163], v204 offset:1024
    v_mfma_f32_32x32x16_bf16 v[32:47], v[168:171], v[188:191], v[32:47]
    ds_read_b64_tr_b16 v[164:165], v205 offset:0
    ds_read_b64_tr_b16 v[166:167], v205 offset:1024
    v_mfma_f32_32x32x16_bf16 v[48:63], v[172:175], v[184:187], v[48:63]
    ds_read_b128 v[144:147], v192 offset:0
    ds_read_b128 v[148:151], v192 offset:6144
    v_mfma_f32_32x32x16_bf16 v[64:79], v[172:175], v[188:191], v[64:79]
    ds_read_b128 v[152:155], v192 offset:12288
    ds_read_b128 v[156:159], v192 offset:18432
    v_mfma_f32_32x32x16_bf16 v[80:95], v[176:179], v[184:187], v[80:95]
    buffer_load_dwordx4 v[212:215], v210, s[12:15], 0 offen offset:0 sc1
    v_mfma_f32_32x32x16_bf16 v[96:111], v[176:179], v[188:191], v[96:111]
    buffer_load_dwordx4 v[216:219], v210, s[12:15], 0 offen offset:512 sc1
    v_mfma_f32_32x32x16_bf16 v[112:127], v[180:183], v[184:187], v[112:127]
    buffer_load_dwordx4 v[220:223], v210, s[12:15], 0 offen offset:1024 sc1
    v_mfma_f32_32x32x16_bf16 v[128:143], v[180:183], v[188:191], v[128:143]
    buffer_load_dwordx4 v[224:227], v210, s[12:15], 0 offen offset:1536 sc1
    s_waitcnt lgkmcnt(0)
    v_mfma_f32_32x32x16_bf16 v[16:31], v[144:147], v[160:163], v[16:31]
    ds_read_b64_tr_b16 v[184:185], v204 offset:12288
    ds_read_b64_tr_b16 v[186:187], v204 offset:13312
    v_mfma_f32_32x32x16_bf16 v[32:47], v[144:147], v[164:167], v[32:47]
    ds_read_b64_tr_b16 v[188:189], v205 offset:12288
    ds_read_b64_tr_b16 v[190:191], v205 offset:13312
    v_mfma_f32_32x32x16_bf16 v[48:63], v[148:151], v[160:163], v[48:63]
    ds_read_b128 v[168:171], v193 offset:0
    ds_read_b128 v[172:175], v193 offset:6144
    v_mfma_f32_32x32x16_bf16 v[64:79], v[148:151], v[164:167], v[64:79]
    ds_read_b128 v[176:179], v193 offset:12288
    ds_read_b128 v[180:183], v193 offset:18432
    v_mfma_f32_32x32x16_bf16 v[80:95], v[152:155], v[160:163], v[80:95]
    v_mfma_f32_32x32x16_bf16 v[96:111], v[152:155], v[164:167], v[96:111]
    v_mfma_f32_32x32x16_bf16 v[112:127], v[156:159], v[160:163], v[112:127]
    v_mfma_f32_32x32x16_bf16 v[128:143], v[156:159], v[164:167], v[128:143]
    s_waitcnt lgkmcnt(0)
    v_mfma_f32_32x32x16_bf16 v[16:31], v[168:171], v[184:187], v[16:31]
    ds_read_b64_tr_b16 v[160:161], v204 offset:24576
    ds_read_b64_tr_b16 v[162:163], v204 offset:25600
    v_mfma_f32_32x32x16_bf16 v[32:47], v[168:171], v[188:191], v[32:47]
    ds_read_b64_tr_b16 v[164:165], v205 offset:24576
    ds_read_b64_tr_b16 v[166:167], v205 offset:25600
    v_mfma_f32_32x32x16_bf16 v[48:63], v[172:175], v[184:187], v[48:63]
    ds_read_b128 v[144:147], v194 offset:0
    ds_read_b128 v[148:151], v194 offset:6144
    v_mfma_f32_32x32x16_bf16 v[64:79], v[172:175], v[188:191], v[64:79]
    ds_read_b128 v[152:155], v194 offset:12288
    ds_read_b128 v[156:159], v194 offset:18432
    v_mfma_f32_32x32x16_bf16 v[80:95], v[176:179], v[184:187], v[80:95]
    v_mfma_f32_32x32x16_bf16 v[96:111], v[176:179], v[188:191], v[96:111]
    v_mfma_f32_32x32x16_bf16 v[112:127], v[180:183], v[184:187], v[112:127]
    v_mfma_f32_32x32x16_bf16 v[128:143], v[180:183], v[188:191], v[128:143]
    s_waitcnt lgkmcnt(0)
    v_mfma_f32_32x32x16_bf16 v[16:31], v[144:147], v[160:163], v[16:31]
    ds_read_b64_tr_b16 v[184:185], v204 offset:36864
    ds_read_b64_tr_b16 v[186:187], v204 offset:37888
    v_mfma_f32_32x32x16_bf16 v[32:47], v[144:147], v[164:167], v[32:47]
    ds_read_b64_tr_b16 v[188:189], v205 offset:36864
    ds_read_b64_tr_b16 v[190:191], v205 offset:37888
    v_mfma_f32_32x32x16_bf16 v[48:63], v[148:151], v[160:163], v[48:63]
    ds_read_b128 v[168:171], v195 offset:0
    ds_read_b128 v[172:175], v195 offset:6144
    v_mfma_f32_32x32x16_bf16 v[64:79], v[148:151], v[164:167], v[64:79]
    ds_read_b128 v[176:179], v195 offset:12288
    ds_read_b128 v[180:183], v195 offset:18432
    v_mfma_f32_32x32x16_bf16 v[80:95], v[152:155], v[160:163], v[80:95]
    v_mfma_f32_32x32x16_bf16 v[96:111], v[152:155], v[164:167], v[96:111]
    v_mfma_f32_32x32x16_bf16 v[112:127], v[156:159], v[160:163], v[112:127]
    v_mfma_f32_32x32x16_bf16 v[128:143], v[156:159], v[164:167], v[128:143]
    s_waitcnt lgkmcnt(0)
    s_barrier
    v_mfma_f32_32x32x16_bf16 v[16:31], v[168:171], v[184:187], v[16:31]
    v_mfma_f32_32x32x16_bf16 v[32:47], v[168:171], v[188:191], v[32:47]
    v_mfma_f32_32x32x16_bf16 v[48:63], v[172:175], v[184:187], v[48:63]
    v_mfma_f32_32x32x16_bf16 v[64:79], v[172:175], v[188:191], v[64:79]
    v_mfma_f32_32x32x16_bf16 v[80:95], v[176:179], v[184:187], v[80:95]
    v_mfma_f32_32x32x16_bf16 v[96:111], v[176:179], v[188:191], v[96:111]
    v_mfma_f32_32x32x16_bf16 v[112:127], v[180:183], v[184:187], v[112:127]
    v_mfma_f32_32x32x16_bf16 v[128:143], v[180:183], v[188:191], v[128:143]
    s_lshl_b32 s57, s47, 1
    s_add_u32 s57, s57, s60
    s_mul_i32 s57, s57, 163840
    v_lshrrev_b32 v4, 5, v1
    v_cmp_eq_u32 s[64:65], 0, v4
    s_lshl_b32 s58, s62, 10
    s_add_u32 s58, s58, 147456
    v_lshl_add_u32 v6, v1, 2, s58
    v_lshl_add_u32 v5, v4, 4, s58
    v_and_b32 v8, 31, v1
    s_lshl_b32 s58, s61, 8
    s_add_u32 s58, s58, 159744
    v_lshl_add_u32 v7, v8, 2, s58
    ds_read_b32 v12, v7
    ds_read_b32 v13, v7 offset:128
    s_sub_u32 s59, s48, 10
    s_lshl_b32 s59, s59, 1
    s_add_u32 s59, s59, s61
    s_lshl_b32 s59, s59, 10
    s_add_u32 s57, s57, s59
    s_add_u32 s57, s57, 9502720
    v_mul_u32_u24 v9, 10240, v4
    v_lshl_add_u32 v9, v8, 4, v9
    s_waitcnt vmcnt(0)
    v_cmp_ne_u64 vcc, v[214:215], s[50:51]
    v_cmp_ne_u64 s[98:99], v[218:219], s[50:51]
    s_or_b64 vcc, vcc, s[98:99]
    v_cmp_ne_u64 s[98:99], v[222:223], s[50:51]
    s_or_b64 vcc, vcc, s[98:99]
    v_cmp_ne_u64 s[98:99], v[226:227], s[50:51]
    s_or_b64 vcc, vcc, s[98:99]
    s_and_b64 vcc, vcc, exec
    s_cbranch_scc0 ok_45
    s_mov_b32 s97, 400000
sp_46:
    s_sleep 2
    buffer_load_dwordx4 v[212:215], v210, s[12:15], 0 offen offset:0 sc1
    buffer_load_dwordx4 v[216:219], v210, s[12:15], 0 offen offset:512 sc1
    buffer_load_dwordx4 v[220:223], v210, s[12:15], 0 offen offset:1024 sc1
    buffer_load_dwordx4 v[224:227], v210, s[12:15], 0 offen offset:1536 sc1
    s_waitcnt vmcnt(0)
    v_cmp_ne_u64 vcc, v[214:215], s[50:51]
    v_cmp_ne_u64 s[98:99], v[218:219], s[50:51]
    s_or_b64 vcc, vcc, s[98:99]
    v_cmp_ne_u64 s[98:99], v[222:223], s[50:51]
    s_or_b64 vcc, vcc, s[98:99]
    v_cmp_ne_u64 s[98:99], v[226:227], s[50:51]
    s_or_b64 vcc, vcc, s[98:99]
    s_and_b64 vcc, vcc, exec
    s_cbranch_scc0 ok_45
    s_sub_u32 s97, s97, 1
    s_cbranch_scc0 sp_46
    v_mov_b32 v14, 20
    v_mov_b32 v15, 225
    buffer_store_dword v15, v14, s[40:43], 0 offen
ok_45:
    v_cndmask_b32 v7, v213, v212, s[64:65]
    ds_write_b32 v6, v7 offset:0
    v_cndmask_b32 v7, v217, v216, s[64:65]
    ds_write_b32 v6, v7 offset:256
    v_cndmask_b32 v7, v221, v220, s[64:65]
    ds_write_b32 v6, v7 offset:512
    v_cndmask_b32 v7, v225, v224, s[64:65]
    ds_write_b32 v6, v7 offset:768
    ds_read_b128 v[144:147], v5 offset:0
    ds_read_b128 v[160:163], v5 offset:128
    ds_read_b128 v[148:151], v5 offset:32
    ds_read_b128 v[164:167], v5 offset:160
    ds_read_b128 v[152:155], v5 offset:64
    ds_read_b128 v[168:171], v5 offset:192
    ds_read_b128 v[156:159], v5 offset:96
    ds_read_b128 v[172:175], v5 offset:224
    ds_read_b128 v[176:179], v5 offset:256
    ds_read_b128 v[192:195], v5 offset:384
    ds_read_b128 v[180:183], v5 offset:288
    ds_read_b128 v[196:199], v5 offset:416
    ds_read_b128 v[184:187], v5 offset:320
    ds_read_b128 v[200:203], v5 offset:448
    ds_read_b128 v[188:191], v5 offset:352
    ds_read_b128 v[204:207], v5 offset:480
    s_waitcnt lgkmcnt(12)
    v_pk_fma_f32 v[16:17], v[144:145], v[12:13], v[16:17] op_sel:[0,0,0] op_sel_hi:[1,0,1] neg_lo:[1,0,0] neg_hi:[1,0,0]
    v_pk_fma_f32 v[18:19], v[146:147], v[12:13], v[18:19] op_sel:[0,0,0] op_sel_hi:[1,0,1] neg_lo:[1,0,0] neg_hi:[1,0,0]
    v_pk_fma_f32 v[20:21], v[148:149], v[12:13], v[20:21] op_sel:[0,0,0] op_sel_hi:[1,0,1] neg_lo:[1,0,0] neg_hi:[1,0,0]
    v_pk_fma_f32 v[22:23], v[150:151], v[12:13], v[22:23] op_sel:[0,0,0] op_sel_hi:[1,0,1] neg_lo:[1,0,0] neg_hi:[1,0,0]
    v_pk_mul_f32 v[16:17], v[16:17], v[160:161]
    v_pk_mul_f32 v[18:19], v[18:19], v[162:163]
    v_pk_mul_f32 v[20:21], v[20:21], v[164:165]
    v_pk_mul_f32 v[22:23], v[22:23], v[166:167]
    v_cvt_pk_bf16_f32 v16, v16, v17
    v_cvt_pk_bf16_f32 v17, v18, v19
    v_cvt_pk_bf16_f32 v18, v20, v21
    v_cvt_pk_bf16_f32 v19, v22, v23
    buffer_store_dwordx4 v[16:19], v9, s[12:15], s57 offen offset:0 sc1
    v_pk_fma_f32 v[32:33], v[144:145], v[12:13], v[32:33] op_sel:[0,1,0] op_sel_hi:[1,1,1] neg_lo:[1,0,0] neg_hi:[1,0,0]
    v_pk_fma_f32 v[34:35], v[146:147], v[12:13], v[34:35] op_sel:[0,1,0] op_sel_hi:[1,1,1] neg_lo:[1,0,0] neg_hi:[1,0,0]
    v_pk_fma_f32 v[36:37], v[148:149], v[12:13], v[36:37] op_sel:[0,1,0] op_sel_hi:[1,1,1] neg_lo:[1,0,0] neg_hi:[1,0,0]
    v_pk_fma_f32 v[38:39], v[150:151], v[12:13], v[38:39] op_sel:[0,1,0] op_sel_hi:[1,1,1] neg_lo:[1,0,0] neg_hi:[1,0,0]
    v_pk_mul_f32 v[32:33], v[32:33], v[160:161]
    v_pk_mul_f32 v[34:35], v[34:35], v[162:163]
    v_pk_mul_f32 v[36:37], v[36:37], v[164:165]
    v_pk_mul_f32 v[38:39], v[38:39], v[166:167]
    v_cvt_pk_bf16_f32 v32, v32, v33
    v_cvt_pk_bf16_f32 v33, v34, v35
    v_cvt_pk_bf16_f32 v34, v36, v37
    v_cvt_pk_bf16_f32 v35, v38, v39
    buffer_store_dwordx4 v[32:35], v9, s[12:15], s57 offen offset:512 sc1
    s_add_u32 s57, s57, 20480
    s_waitcnt lgkmcnt(8)
    v_pk_fma_f32 v[24:25], v[152:153], v[12:13], v[24:25] op_sel:[0,0,0] op_sel_hi:[1,0,1] neg_lo:[1,0,0] neg_hi:[1,0,0]
    v_pk_fma_f32 v[26:27], v[154:155], v[12:13], v[26:27] op_sel:[0,0,0] op_sel_hi:[1,0,1] neg_lo:[1,0,0] neg_hi:[1,0,0]
    v_pk_fma_f32 v[28:29], v[156:157], v[12:13], v[28:29] op_sel:[0,0,0] op_sel_hi:[1,0,1] neg_lo:[1,0,0] neg_hi:[1,0,0]
    v_pk_fma_f32 v[30:31], v[158:159], v[12:13], v[30:31] op_sel:[0,0,0] op_sel_hi:[1,0,1] neg_lo:[1,0,0] neg_hi:[1,0,0]
    v_pk_mul_f32 v[24:25], v[24:25], v[168:169]
    v_pk_mul_f32 v[26:27], v[26:27], v[170:171]
    v_pk_mul_f32 v[28:29], v[28:29], v[172:173]
    v_pk_mul_f32 v[30:31], v[30:31], v[174:175]
    v_cvt_pk_bf16_f32 v24, v24, v25
    v_cvt_pk_bf16_f32 v25, v26, v27
    v_cvt_pk_bf16_f32 v26, v28, v29
    v_cvt_pk_bf16_f32 v27, v30, v31
    buffer_store_dwordx4 v[24:27], v9, s[12:15], s57 offen offset:0 sc1
    v_pk_fma_f32 v[40:41], v[152:153], v[12:13], v[40:41] op_sel:[0,1,0] op_sel_hi:[1,1,1] neg_lo:[1,0,0] neg_hi:[1,0,0]
    v_pk_fma_f32 v[42:43], v[154:155], v[12:13], v[42:43] op_sel:[0,1,0] op_sel_hi:[1,1,1] neg_lo:[1,0,0] neg_hi:[1,0,0]
    v_pk_fma_f32 v[44:45], v[156:157], v[12:13], v[44:45] op_sel:[0,1,0] op_sel_hi:[1,1,1] neg_lo:[1,0,0] neg_hi:[1,0,0]
    v_pk_fma_f32 v[46:47], v[158:159], v[12:13], v[46:47] op_sel:[0,1,0] op_sel_hi:[1,1,1] neg_lo:[1,0,0] neg_hi:[1,0,0]
    v_pk_mul_f32 v[40:41], v[40:41], v[168:169]
    v_pk_mul_f32 v[42:43], v[42:43], v[170:171]
    v_pk_mul_f32 v[44:45], v[44:45], v[172:173]
    v_pk_mul_f32 v[46:47], v[46:47], v[174:175]
    v_cvt_pk_bf16_f32 v40, v40, v41
    v_cvt_pk_bf16_f32 v41, v42, v43
    v_cvt_pk_bf16_f32 v42, v44, v45
    v_cvt_pk_bf16_f32 v43, v46, v47
    buffer_store_dwordx4 v[40:43], v9, s[12:15], s57 offen offset:512 sc1
    s_add_u32 s57, s57, 20480
    ds_read_b128 v[144:147], v5 offset:512
    ds_read_b128 v[160:163], v5 offset:640
    ds_read_b128 v[148:151], v5 offset:544
    ds_read_b128 v[164:167], v5 offset:672
    ds_read_b128 v[152:155], v5 offset:576
    ds_read_b128 v[168:171], v5 offset:704
    ds_read_b128 v[156:159], v5 offset:608
    ds_read_b128 v[172:175], v5 offset:736
    s_waitcnt lgkmcnt(12)
    v_pk_fma_f32 v[48:49], v[176:177], v[12:13], v[48:49] op_sel:[0,0,0] op_sel_hi:[1,0,1] neg_lo:[1,0,0] neg_hi:[1,0,0]
    v_pk_fma_f32 v[50:51], v[178:179], v[12:13], v[50:51] op_sel:[0,0,0] op_sel_hi:[1,0,1] neg_lo:[1,0,0] neg_hi:[1,0,0]
    v_pk_fma_f32 v[52:53], v[180:181], v[12:13], v[52:53] op_sel:[0,0,0] op_sel_hi:[1,0,1] neg_lo:[1,0,0] neg_hi:[1,0,0]
    v_pk_fma_f32 v[54:55], v[182:183], v[12:13], v[54:55] op_sel:[0,0,0] op_sel_hi:[1,0,1] neg_lo:[1,0,0] neg_hi:[1,0,0]
    v_pk_mul_f32 v[48:49], v[48:49], v[192:193]
    v_pk_mul_f32 v[50:51], v[50:51], v[194:195]
    v_pk_mul_f32 v[52:53], v[52:53], v[196:197]
    v_pk_mul_f32 v[54:55], v[54:55], v[198:199]
    v_cvt_pk_bf16_f32 v48, v48, v49
    v_cvt_pk_bf16_f32 v49, v50, v51
    v_cvt_pk_bf16_f32 v50, v52, v53
    v_cvt_pk_bf16_f32 v51, v54, v55
    buffer_store_dwordx4 v[48:51], v9, s[12:15], s57 offen offset:0 sc1
    v_pk_fma_f32 v[64:65], v[176:177], v[12:13], v[64:65] op_sel:[0,1,0] op_sel_hi:[1,1,1] neg_lo:[1,0,0] neg_hi:[1,0,0]
    v_pk_fma_f32 v[66:67], v[178:179], v[12:13], v[66:67] op_sel:[0,1,0] op_sel_hi:[1,1,1] neg_lo:[1,0,0] neg_hi:[1,0,0]
    v_pk_fma_f32 v[68:69], v[180:181], v[12:13], v[68:69] op_sel:[0,1,0] op_sel_hi:[1,1,1] neg_lo:[1,0,0] neg_hi:[1,0,0]
    v_pk_fma_f32 v[70:71], v[182:183], v[12:13], v[70:71] op_sel:[0,1,0] op_sel_hi:[1,1,1] neg_lo:[1,0,0] neg_hi:[1,0,0]
    v_pk_mul_f32 v[64:65], v[64:65], v[192:193]
    v_pk_mul_f32 v[66:67], v[66:67], v[194:195]
    v_pk_mul_f32 v[68:69], v[68:69], v[196:197]
    v_pk_mul_f32 v[70:71], v[70:71], v[198:199]
    v_cvt_pk_bf16_f32 v64, v64, v65
    v_cvt_pk_bf16_f32 v65, v66, v67
    v_cvt_pk_bf16_f32 v66, v68, v69
    v_cvt_pk_bf16_f32 v67, v70, v71
    buffer_store_dwordx4 v[64:67], v9, s[12:15], s57 offen offset:512 sc1
    s_add_u32 s57, s57, 20480
    s_waitcnt lgkmcnt(8)
    v_pk_fma_f32 v[56:57], v[184:185], v[12:13], v[56:57] op_sel:[0,0,0] op_sel_hi:[1,0,1] neg_lo:[1,0,0] neg_hi:[1,0,0]
    v_pk_fma_f32 v[58:59], v[186:187], v[12:13], v[58:59] op_sel:[0,0,0] op_sel_hi:[1,0,1] neg_lo:[1,0,0] neg_hi:[1,0,0]
    v_pk_fma_f32 v[60:61], v[188:189], v[12:13], v[60:61] op_sel:[0,0,0] op_sel_hi:[1,0,1] neg_lo:[1,0,0] neg_hi:[1,0,0]
    v_pk_fma_f32 v[62:63], v[190:191], v[12:13], v[62:63] op_sel:[0,0,0] op_sel_hi:[1,0,1] neg_lo:[1,0,0] neg_hi:[1,0,0]
    v_pk_mul_f32 v[56:57], v[56:57], v[200:201]
    v_pk_mul_f32 v[58:59], v[58:59], v[202:203]
    v_pk_mul_f32 v[60:61], v[60:61], v[204:205]
    v_pk_mul_f32 v[62:63], v[62:63], v[206:207]
    v_cvt_pk_bf16_f32 v56, v56, v57
    v_cvt_pk_bf16_f32 v57, v58, v59
    v_cvt_pk_bf16_f32 v58, v60, v61
    v_cvt_pk_bf16_f32 v59, v62, v63
    buffer_store_dwordx4 v[56:59], v9, s[12:15], s57 offen offset:0 sc1
    v_pk_fma_f32 v[72:73], v[184:185], v[12:13], v[72:73] op_sel:[0,1,0] op_sel_hi:[1,1,1] neg_lo:[1,0,0] neg_hi:[1,0,0]
    v_pk_fma_f32 v[74:75], v[186:187], v[12:13], v[74:75] op_sel:[0,1,0] op_sel_hi:[1,1,1] neg_lo:[1,0,0] neg_hi:[1,0,0]
    v_pk_fma_f32 v[76:77], v[188:189], v[12:13], v[76:77] op_sel:[0,1,0] op_sel_hi:[1,1,1] neg_lo:[1,0,0] neg_hi:[1,0,0]
    v_pk_fma_f32 v[78:79], v[190:191], v[12:13], v[78:79] op_sel:[0,1,0] op_sel_hi:[1,1,1] neg_lo:[1,0,0] neg_hi:[1,0,0]
    v_pk_mul_f32 v[72:73], v[72:73], v[200:201]
    v_pk_mul_f32 v[74:75], v[74:75], v[202:203]
    v_pk_mul_f32 v[76:77], v[76:77], v[204:205]
    v_pk_mul_f32 v[78:79], v[78:79], v[206:207]
    v_cvt_pk_bf16_f32 v72, v72, v73
    v_cvt_pk_bf16_f32 v73, v74, v75
    v_cvt_pk_bf16_f32 v74, v76, v77
    v_cvt_pk_bf16_f32 v75, v78, v79
    buffer_store_dwordx4 v[72:75], v9, s[12:15], s57 offen offset:512 sc1
    s_add_u32 s57, s57, 20480
    ds_read_b128 v[176:179], v5 offset:768
    ds_read_b128 v[192:195], v5 offset:896
    ds_read_b128 v[180:183], v5 offset:800
    ds_read_b128 v[196:199], v5 offset:928
    ds_read_b128 v[184:187], v5 offset:832
    ds_read_b128 v[200:203], v5 offset:960
    ds_read_b128 v[188:191], v5 offset:864
    ds_read_b128 v[204:207], v5 offset:992
    s_waitcnt lgkmcnt(12)
    v_pk_fma_f32 v[80:81], v[144:145], v[12:13], v[80:81] op_sel:[0,0,0] op_sel_hi:[1,0,1] neg_lo:[1,0,0] neg_hi:[1,0,0]
    v_pk_fma_f32 v[82:83], v[146:147], v[12:13], v[82:83] op_sel:[0,0,0] op_sel_hi:[1,0,1] neg_lo:[1,0,0] neg_hi:[1,0,0]
    v_pk_fma_f32 v[84:85], v[148:149], v[12:13], v[84:85] op_sel:[0,0,0] op_sel_hi:[1,0,1] neg_lo:[1,0,0] neg_hi:[1,0,0]
    v_pk_fma_f32 v[86:87], v[150:151], v[12:13], v[86:87] op_sel:[0,0,0] op_sel_hi:[1,0,1] neg_lo:[1,0,0] neg_hi:[1,0,0]
    v_pk_mul_f32 v[80:81], v[80:81], v[160:161]
    v_pk_mul_f32 v[82:83], v[82:83], v[162:163]
    v_pk_mul_f32 v[84:85], v[84:85], v[164:165]
    v_pk_mul_f32 v[86:87], v[86:87], v[166:167]
    v_cvt_pk_bf16_f32 v80, v80, v81
    v_cvt_pk_bf16_f32 v81, v82, v83
    v_cvt_pk_bf16_f32 v82, v84, v85
    v_cvt_pk_bf16_f32 v83, v86, v87
    buffer_store_dwordx4 v[80:83], v9, s[12:15], s57 offen offset:0 sc1
    v_pk_fma_f32 v[96:97], v[144:145], v[12:13], v[96:97] op_sel:[0,1,0] op_sel_hi:[1,1,1] neg_lo:[1,0,0] neg_hi:[1,0,0]
    v_pk_fma_f32 v[98:99], v[146:147], v[12:13], v[98:99] op_sel:[0,1,0] op_sel_hi:[1,1,1] neg_lo:[1,0,0] neg_hi:[1,0,0]
    v_pk_fma_f32 v[100:101], v[148:149], v[12:13], v[100:101] op_sel:[0,1,0] op_sel_hi:[1,1,1] neg_lo:[1,0,0] neg_hi:[1,0,0]
    v_pk_fma_f32 v[102:103], v[150:151], v[12:13], v[102:103] op_sel:[0,1,0] op_sel_hi:[1,1,1] neg_lo:[1,0,0] neg_hi:[1,0,0]
    v_pk_mul_f32 v[96:97], v[96:97], v[160:161]
    v_pk_mul_f32 v[98:99], v[98:99], v[162:163]
    v_pk_mul_f32 v[100:101], v[100:101], v[164:165]
    v_pk_mul_f32 v[102:103], v[102:103], v[166:167]
    v_cvt_pk_bf16_f32 v96, v96, v97
    v_cvt_pk_bf16_f32 v97, v98, v99
    v_cvt_pk_bf16_f32 v98, v100, v101
    v_cvt_pk_bf16_f32 v99, v102, v103
    buffer_store_dwordx4 v[96:99], v9, s[12:15], s57 offen offset:512 sc1
    s_add_u32 s57, s57, 20480
    s_waitcnt lgkmcnt(8)
    v_pk_fma_f32 v[88:89], v[152:153], v[12:13], v[88:89] op_sel:[0,0,0] op_sel_hi:[1,0,1] neg_lo:[1,0,0] neg_hi:[1,0,0]
    v_pk_fma_f32 v[90:91], v[154:155], v[12:13], v[90:91] op_sel:[0,0,0] op_sel_hi:[1,0,1] neg_lo:[1,0,0] neg_hi:[1,0,0]
    v_pk_fma_f32 v[92:93], v[156:157], v[12:13], v[92:93] op_sel:[0,0,0] op_sel_hi:[1,0,1] neg_lo:[1,0,0] neg_hi:[1,0,0]
    v_pk_fma_f32 v[94:95], v[158:159], v[12:13], v[94:95] op_sel:[0,0,0] op_sel_hi:[1,0,1] neg_lo:[1,0,0] neg_hi:[1,0,0]
    v_pk_mul_f32 v[88:89], v[88:89], v[168:169]
    v_pk_mul_f32 v[90:91], v[90:91], v[170:171]
    v_pk_mul_f32 v[92:93], v[92:93], v[172:173]
    v_pk_mul_f32 v[94:95], v[94:95], v[174:175]
    v_cvt_pk_bf16_f32 v88, v88, v89
    v_cvt_pk_bf16_f32 v89, v90, v91
    v_cvt_pk_bf16_f32 v90, v92, v93
    v_cvt_pk_bf16_f32 v91, v94, v95
    buffer_store_dwordx4 v[88:91], v9, s[12:15], s57 offen offset:0 sc1
    v_pk_fma_f32 v[104:105], v[152:153], v[12:13], v[104:105] op_sel:[0,1,0] op_sel_hi:[1,1,1] neg_lo:[1,0,0] neg_hi:[1,0,0]
    v_pk_fma_f32 v[106:107], v[154:155], v[12:13], v[106:107] op_sel:[0,1,0] op_sel_hi:[1,1,1] neg_lo:[1,0,0] neg_hi:[1,0,0]
    v_pk_fma_f32 v[108:109], v[156:157], v[12:13], v[108:109] op_sel:[0,1,0] op_sel_hi:[1,1,1] neg_lo:[1,0,0] neg_hi:[1,0,0]
    v_pk_fma_f32 v[110:111], v[158:159], v[12:13], v[110:111] op_sel:[0,1,0] op_sel_hi:[1,1,1] neg_lo:[1,0,0] neg_hi:[1,0,0]
    v_pk_mul_f32 v[104:105], v[104:105], v[168:169]
    v_pk_mul_f32 v[106:107], v[106:107], v[170:171]
    v_pk_mul_f32 v[108:109], v[108:109], v[172:173]
    v_pk_mul_f32 v[110:111], v[110:111], v[174:175]
    v_cvt_pk_bf16_f32 v104, v104, v105
    v_cvt_pk_bf16_f32 v105, v106, v107
    v_cvt_pk_bf16_f32 v106, v108, v109
    v_cvt_pk_bf16_f32 v107, v110, v111
    buffer_store_dwordx4 v[104:107], v9, s[12:15], s57 offen offset:512 sc1
    s_add_u32 s57, s57, 20480
    s_waitcnt lgkmcnt(4)
    v_pk_fma_f32 v[112:113], v[176:177], v[12:13], v[112:113] op_sel:[0,0,0] op_sel_hi:[1,0,1] neg_lo:[1,0,0] neg_hi:[1,0,0]
    v_pk_fma_f32 v[114:115], v[178:179], v[12:13], v[114:115] op_sel:[0,0,0] op_sel_hi:[1,0,1] neg_lo:[1,0,0] neg_hi:[1,0,0]
    v_pk_fma_f32 v[116:117], v[180:181], v[12:13], v[116:117] op_sel:[0,0,0] op_sel_hi:[1,0,1] neg_lo:[1,0,0] neg_hi:[1,0,0]
    v_pk_fma_f32 v[118:119], v[182:183], v[12:13], v[118:119] op_sel:[0,0,0] op_sel_hi:[1,0,1] neg_lo:[1,0,0] neg_hi:[1,0,0]
    v_pk_mul_f32 v[112:113], v[112:113], v[192:193]
    v_pk_mul_f32 v[114:115], v[114:115], v[194:195]
    v_pk_mul_f32 v[116:117], v[116:117], v[196:197]
    v_pk_mul_f32 v[118:119], v[118:119], v[198:199]
    v_cvt_pk_bf16_f32 v112, v112, v113
    v_cvt_pk_bf16_f32 v113, v114, v115
    v_cvt_pk_bf16_f32 v114, v116, v117
    v_cvt_pk_bf16_f32 v115, v118, v119
    buffer_store_dwordx4 v[112:115], v9, s[12:15], s57 offen offset:0 sc1
    v_pk_fma_f32 v[128:129], v[176:177], v[12:13], v[128:129] op_sel:[0,1,0] op_sel_hi:[1,1,1] neg_lo:[1,0,0] neg_hi:[1,0,0]
    v_pk_fma_f32 v[130:131], v[178:179], v[12:13], v[130:131] op_sel:[0,1,0] op_sel_hi:[1,1,1] neg_lo:[1,0,0] neg_hi:[1,0,0]
    v_pk_fma_f32 v[132:133], v[180:181], v[12:13], v[132:133] op_sel:[0,1,0] op_sel_hi:[1,1,1] neg_lo:[1,0,0] neg_hi:[1,0,0]
    v_pk_fma_f32 v[134:135], v[182:183], v[12:13], v[134:135] op_sel:[0,1,0] op_sel_hi:[1,1,1] neg_lo:[1,0,0] neg_hi:[1,0,0]
    v_pk_mul_f32 v[128:129], v[128:129], v[192:193]
    v_pk_mul_f32 v[130:131], v[130:131], v[194:195]
    v_pk_mul_f32 v[132:133], v[132:133], v[196:197]
    v_pk_mul_f32 v[134:135], v[134:135], v[198:199]
    v_cvt_pk_bf16_f32 v128, v128, v129
    v_cvt_pk_bf16_f32 v129, v130, v131
    v_cvt_pk_bf16_f32 v130, v132, v133
    v_cvt_pk_bf16_f32 v131, v134, v135
    buffer_store_dwordx4 v[128:131], v9, s[12:15], s57 offen offset:512 sc1
    s_add_u32 s57, s57, 20480
    s_waitcnt lgkmcnt(0)
    v_pk_fma_f32 v[120:121], v[184:185], v[12:13], v[120:121] op_sel:[0,0,0] op_sel_hi:[1,0,1] neg_lo:[1,0,0] neg_hi:[1,0,0]
    v_pk_fma_f32 v[122:123], v[186:187], v[12:13], v[122:123] op_sel:[0,0,0] op_sel_hi:[1,0,1] neg_lo:[1,0,0] neg_hi:[1,0,0]
    v_pk_fma_f32 v[124:125], v[188:189], v[12:13], v[124:125] op_sel:[0,0,0] op_sel_hi:[1,0,1] neg_lo:[1,0,0] neg_hi:[1,0,0]
    v_pk_fma_f32 v[126:127], v[190:191], v[12:13], v[126:127] op_sel:[0,0,0] op_sel_hi:[1,0,1] neg_lo:[1,0,0] neg_hi:[1,0,0]
    v_pk_mul_f32 v[120:121], v[120:121], v[200:201]
    v_pk_mul_f32 v[122:123], v[122:123], v[202:203]
    v_pk_mul_f32 v[124:125], v[124:125], v[204:205]
    v_pk_mul_f32 v[126:127], v[126:127], v[206:207]
    v_cvt_pk_bf16_f32 v120, v120, v121
    v_cvt_pk_bf16_f32 v121, v122, v123
    v_cvt_pk_bf16_f32 v122, v124, v125
    v_cvt_pk_bf16_f32 v123, v126, v127
    buffer_store_dwordx4 v[120:123], v9, s[12:15], s57 offen offset:0 sc1
    v_pk_fma_f32 v[136:137], v[184:185], v[12:13], v[136:137] op_sel:[0,1,0] op_sel_hi:[1,1,1] neg_lo:[1,0,0] neg_hi:[1,0,0]
    v_pk_fma_f32 v[138:139], v[186:187], v[12:13], v[138:139] op_sel:[0,1,0] op_sel_hi:[1,1,1] neg_lo:[1,0,0] neg_hi:[1,0,0]
    v_pk_fma_f32 v[140:141], v[188:189], v[12:13], v[140:141] op_sel:[0,1,0] op_sel_hi:[1,1,1] neg_lo:[1,0,0] neg_hi:[1,0,0]
    v_pk_fma_f32 v[142:143], v[190:191], v[12:13], v[142:143] op_sel:[0,1,0] op_sel_hi:[1,1,1] neg_lo:[1,0,0] neg_hi:[1,0,0]
    v_pk_mul_f32 v[136:137], v[136:137], v[200:201]
    v_pk_mul_f32 v[138:139], v[138:139], v[202:203]
    v_pk_mul_f32 v[140:141], v[140:141], v[204:205]
    v_pk_mul_f32 v[142:143], v[142:143], v[206:207]
    v_cvt_pk_bf16_f32 v136, v136, v137
    v_cvt_pk_bf16_f32 v137, v138, v139
    v_cvt_pk_bf16_f32 v138, v140, v141
    v_cvt_pk_bf16_f32 v139, v142, v143
    buffer_store_dwordx4 v[136:139], v9, s[12:15], s57 offen offset:512 sc1
    s_add_u32 s57, s57, 20480
    s_branch L_qdone
L_qdone:
    s_mul_i32 s57, s48, 52
    s_lshr_b32 s57, s57, 8
    s_mul_i32 s58, s57, 5
    s_sub_u32 s58, s48, s58
    s_cmp_eq_u32 s57, 0
    s_cselect_b32 s57, 4, 8
    s_lshl_b32 s56, s47, 2
    s_sub_u32 s59, 32, s56
    s_min_u32 s57, s57, s59
    s_mul_i32 s59, s58, 13
    s_lshr_b32 s59, s59, 3
    s_and_b32 s58, s58, 1
    s_add_u32 s58, s58, 2
    v_mul_u32_u24 v11, 86, v1
    v_lshrrev_b32 v11, 8, v11
    v_mul_u32_u24 v12, 3, v11
    v_sub_u32 v12, v1, v12
    v_cmp_gt_u32 vcc, s57, v11
    v_cmp_gt_u32 s[98:99], s58, v12
    s_and_b64 vcc, vcc, s[98:99]
    v_add_u32 v11, s56, v11
    v_add_u32 v12, s59, v12
    v_lshl_add_u32 v11, v11, 3, v12
    v_lshlrev_b32 v11, 10, v11
    v_add_u32 v11, 393216, v11
    v_mov_b32 v12, 0x7f000000
    v_cndmask_b32 v13, v12, v11, vcc
    s_waitcnt vmcnt(0)
    v_mov_b32 v10, 160448
    v_mov_b32 v11, 1
    s_mov_b64 exec, 1
    ds_add_rtn_u32 v12, v10, v11
    s_mov_b64 exec, -1
    s_waitcnt lgkmcnt(0)
    v_readfirstlane_b32 s100, v12
    s_cmp_eq_u32 s100, 3
    s_cbranch_scc0 L_47
    v_mov_b32 v10, 1
    buffer_atomic_add v10, v13, s[12:15], 0 offen sc1
L_47:
L_att2:
    s_setprio 2
    v_and_b32 v5, 31, v1
    v_lshrrev_b32 v6, 5, v1
    v_mov_b32 v8, s96
    v_lshlrev_b32 v247, 4, v5
    v_lshl_add_u32 v246, v6, 9, v247
    v_mul_u32_u24 v248, 10240, v6
    v_add_u32 v248, v248, v247
    v_mov_b32 v160, 0
    v_mov_b32 v161, 0
    v_mov_b32 v162, 0
    v_mov_b32 v163, 1.0
    v_mov_b32 v168, 0
    v_mov_b32 v169, 0
    v_mov_b32 v170, 0
    v_mov_b32 v171, 1.0
    s_lshl_b32 s56, s46, 1
    s_sub_i32 s56, s56, 8
    s_movk_i32 s58, 0x3f80
    s_cmp_ge_i32 s56, 0
    s_cselect_b32 s57, s58, 0xf14a3f80
    v_mov_b32 v20, v8
    v_mov_b32 v21, s57
    s_cmp_ge_i32 s56, -1
    s_cselect_b32 s57, s58, 0xf14a3f80
    v_mov_b32 v26, v8
    v_mov_b32 v27, s57
    s_cmp_ge_i32 s56, -2
    s_cselect_b32 s57, s58, 0xf14a3f80
    v_mov_b32 v32, v8
    v_mov_b32 v33, s57
    s_cmp_ge_i32 s56, -3
    s_cselect_b32 s57, s58, 0xf14a3f80
    v_mov_b32 v38, v8
    v_mov_b32 v39, s57
    s_cmp_ge_i32 s56, -4
    s_cselect_b32 s57, s58, 0xf14a3f80
    v_mov_b32 v44, v8
    v_mov_b32 v45, s57
    s_cmp_ge_i32 s56, -5
    s_cselect_b32 s57, s58, 0xf14a3f80
    v_mov_b32 v50, v8
    v_mov_b32 v51, s57
    s_cmp_ge_i32 s56, -6
    s_cselect_b32 s57, s58, 0xf14a3f80
    v_mov_b32 v56, v8
    v_mov_b32 v57, s57
    s_cmp_ge_i32 s56, -7
    s_cselect_b32 s57, s58, 0xf14a3f80
    v_mov_b32 v62, v8
    v_mov_b32 v63, s57
    s_cmp_ge_i32 s56, -8
    s_cselect_b32 s57, s58, 0xf14a3f80
    v_mov_b32 v68, v8
    v_mov_b32 v69, s57
    s_cmp_ge_i32 s56, -9
    s_cselect_b32 s57, s58, 0xf14a3f80
    v_mov_b32 v74, v8
    v_mov_b32 v75, s57
    s_lshl_b32 s55, s45, 2
    s_add_u32 s55, s55, s62
    s_mul_i32 s57, s55, 5
    s_add_u32 s57, s57, 1
    s_lshr_b32 s57, s57, 1
    s_lshl_b32 s57, s57, 9
    s_movk_i32 s58, 1024
    s_bitcmp1_b32 s55, 0
    s_cselect_b32 s58, 0xfffffe08, s58
    s_mul_i32 s59, s56, 40960
    s_lshr_b32 s60, s55, 3
    s_mul_i32 s60, s60, 5
    s_bfe_u32 s61, s55, 0x20001
    s_add_u32 s100, s60, s61
    s_lshl_b32 s100, s100, 10
    s_and_b32 s101, s55, 1
    s_lshl_b32 s97, s101, 9
    s_add_u32 s100, s100, s97
    v_bfe_u32 v9, v1, 4, 1
    v_mul_u32_u24 v9, 20480, v9
    v_and_b32 v13, 15, v1
    v_lshl_add_u32 v9, v13, 4, v9
    v_lshl_add_u32 v13, v6, 8, v9
    v_add_u32 v249, s100, v13
    s_add_u32 s100, s60, 4
    s_lshl_b32 s100, s100, 10
    s_lshl_b32 s61, s61, 8
    s_add_u32 s100, s100, s61
    s_lshl_b32 s101, s101, 7
    s_add_u32 s100, s100, s101
    v_and_b32 v13, 15, v1
    v_lshlrev_b32 v13, 3, v13
    v_sub_u32 v9, v9, v13
    v_add_u32 v250, s100, v9
    s_lshr_b32 s60, s46, 2
    s_min_u32 s60, s60, 1
    s_lshl_b32 s60, s60, 1
    s_add_u32 s60, s60, 3
    s_lshr_b32 s61, 0x5a, s45
    s_and_b32 s61, s61, 1
    s_lshl_b32 s60, s60, s61
    s_lshl_b32 s61, s46, 3
    s_add_u32 s61, s61, s45
    s_lshl_b32 s61, s61, 10
    s_add_u32 s61, s61, 393216
    s_load_dword s101, s[12:13], s61 glc
    s_waitcnt lgkmcnt(0)
    s_cmp_ge_u32 s101, s60
    s_cbranch_scc1 ok_49
    s_mov_b32 s97, 400000
sp_48:
    s_sleep 1
    s_load_dword s101, s[12:13], s61 glc
    s_waitcnt lgkmcnt(0)
    s_cmp_ge_u32 s101, s60
    s_cbranch_scc1 ok_49
    s_sub_u32 s97, s97, 1
    s_cbranch_scc0 sp_48
    v_mov_b32 v14, 44
    v_mov_b32 v15, 231
    buffer_store_dword v15, v14, s[40:43], 0 offen
ok_49:
    s_add_u32 s60, s59, 0x460000
    s_add_u32 s60, s60, s57
    buffer_load_dwordx4 v[156:159], v246, s[12:15], s60 offen sc1
    s_add_u32 s60, s59, 0x46a000
    s_add_u32 s60, s60, s57
    buffer_load_dwordx4 v[164:167], v246, s[12:15], s60 offen sc1
    s_add_u32 s60, s59, 0x690000
    s_add_u32 s60, s60, s57
    s_cmp_ge_i32 s56, 0
    s_cselect_b32 s60, s60, 0x7f000000
    buffer_load_dwordx4 v[16:19], v246, s[12:15], s60 offen sc1
    s_add_u32 s60, s59, 0x69a000
    s_add_u32 s60, s60, s57
    s_cmp_ge_i32 s56, -1
    s_cselect_b32 s60, s60, 0x7f000000
    buffer_load_dwordx4 v[22:25], v246, s[12:15], s60 offen sc1
    s_add_u32 s60, s59, 0x6a4000
    s_add_u32 s60, s60, s57
    s_cmp_ge_i32 s56, -2
    s_cselect_b32 s60, s60, 0x7f000000
    buffer_load_dwordx4 v[28:31], v246, s[12:15], s60 offen sc1
    s_add_u32 s60, s59, 0x6ae000
    s_add_u32 s60, s60, s57
    s_cmp_ge_i32 s56, -3
    s_cselect_b32 s60, s60, 0x7f000000
    buffer_load_dwordx4 v[34:37], v246, s[12:15], s60 offen sc1
    s_add_u32 s60, s59, 0x6b8000
    s_add_u32 s60, s60, s57
    s_cmp_ge_i32 s56, -4
    s_cselect_b32 s60, s60, 0x7f000000
    buffer_load_dwordx4 v[40:43], v246, s[12:15], s60 offen sc1
    s_add_u32 s60, s59, 0x6c2000
    s_add_u32 s60, s60, s57
    s_cmp_ge_i32 s56, -5
    s_cselect_b32 s60, s60, 0x7f000000
    buffer_load_dwordx4 v[46:49], v246, s[12:15], s60 offen sc1
    s_add_u32 s60, s59, 0x6cc000
    s_add_u32 s60, s60, s57
    s_cmp_ge_i32 s56, -6
    s_cselect_b32 s60, s60, 0x7f000000
    buffer_load_dwordx4 v[52:55], v246, s[12:15], s60 offen sc1
    s_add_u32 s60, s59, 0x6d6000
    s_add_u32 s60, s60, s57
    s_cmp_ge_i32 s56, -7
    s_cselect_b32 s60, s60, 0x7f000000
    buffer_load_dwordx4 v[58:61], v246, s[12:15], s60 offen sc1
    s_add_u32 s60, s59, 0x6e0000
    s_add_u32 s60, s60, s57
    buffer_load_dwordx4 v[64:67], v246, s[12:15], s60 offen sc1
    s_add_u32 s60, s59, 0x6ea000
    s_add_u32 s60, s60, s57
    buffer_load_dwordx4 v[70:73], v246, s[12:15], s60 offen sc1
    s_add_u32 s57, s57, s58
    s_mov_b32 exec_hi, 0
    s_add_u32 s60, s59, 0x460000
    s_add_u32 s60, s60, s57
    buffer_load_dwordx2 v[162:163], v247, s[12:15], s60 offen sc1
    s_add_u32 s60, s59, 0x46a000
    s_add_u32 s60, s60, s57
    buffer_load_dwordx2 v[170:171], v247, s[12:15], s60 offen sc1
    s_add_u32 s60, s59, 0x690000
    s_add_u32 s60, s60, s57
    s_cmp_ge_i32 s56, 0
    s_cselect_b32 s60, s60, 0x7f000000
    buffer_load_dwordx2 v[20:21], v247, s[12:15], s60 offen sc1
    s_add_u32 s60, s59, 0x69a000
    s_add_u32 s60, s60, s57
    s_cmp_ge_i32 s56, -1
    s_cselect_b32 s60, s60, 0x7f000000
    buffer_load_dwordx2 v[26:27], v247, s[12:15], s60 offen sc1
    s_add_u32 s60, s59, 0x6a4000
    s_add_u32 s60, s60, s57
    s_cmp_ge_i32 s56, -2
    s_cselect_b32 s60, s60, 0x7f000000
    buffer_load_dwordx2 v[32:33], v247, s[12:15], s60 offen sc1
    s_add_u32 s60, s59, 0x6ae000
    s_add_u32 s60, s60, s57
    s_cmp_ge_i32 s56, -3
    s_cselect_b32 s60, s60, 0x7f000000
    buffer_load_dwordx2 v[38:39], v247, s[12:15], s60 offen sc1
    s_add_u32 s60, s59, 0x6b8000
    s_add_u32 s60, s60, s57
    s_cmp_ge_i32 s56, -4
    s_cselect_b32 s60, s60, 0x7f000000
    buffer_load_dwordx2 v[44:45], v247, s[12:15], s60 offen sc1
    s_add_u32 s60, s59, 0x6c2000
    s_add_u32 s60, s60, s57
    s_cmp_ge_i32 s56, -5
    s_cselect_b32 s60, s60, 0x7f000000
    buffer_load_dwordx2 v[50:51], v247, s[12:15], s60 offen sc1
    s_add_u32 s60, s59, 0x6cc000
    s_add_u32 s60, s60, s57
    s_cmp_ge_i32 s56, -6
    s_cselect_b32 s60, s60, 0x7f000000
    buffer_load_dwordx2 v[56:57], v247, s[12:15], s60 offen sc1
    s_add_u32 s60, s59, 0x6d6000
    s_add_u32 s60, s60, s57
    s_cmp_ge_i32 s56, -7
    s_cselect_b32 s60, s60, 0x7f000000
    buffer_load_dwordx2 v[62:63], v247, s[12:15], s60 offen sc1
    s_add_u32 s60, s59, 0x6e0000
    s_add_u32 s60, s60, s57
    buffer_load_dwordx2 v[68:69], v247, s[12:15], s60 offen sc1
    s_add_u32 s60, s59, 0x6ea000
    s_add_u32 s60, s60, s57
    buffer_load_dwordx2 v[74:75], v247, s[12:15], s60 offen sc1
    s_mov_b32 exec_hi, -1
    s_mul_i32 s57, s55, 320
    s_mov_b32 s64, 0xffffffff
    s_mov_b32 s65, 0xfffffff0
    s_mov_b32 s66, 0xfffffffe
    s_mov_b32 s67, 0xffffffe0
    s_mov_b32 s68, 0xfffffffc
    s_mov_b32 s69, 0xffffffc0
    s_mov_b32 s70, 0xfffffff8
    s_mov_b32 s71, 0xffffff80
    s_mov_b32 s72, 0xffffff00
    s_mov_b32 s73, 0xfffff000
    s_mov_b32 s74, 0xfffffe00
    s_mov_b32 s75, 0xffffe000
    s_mov_b32 s76, 0xfffffc00
    s_mov_b32 s77, 0xffffc000
    s_mov_b32 s78, 0xfffff800
    s_mov_b32 s79, 0xffff8000
    s_mov_b32 s80, 0xffff0000
    s_mov_b32 s81, 0xfff00000
    s_mov_b32 s82, 0xfffe0000
    s_mov_b32 s83, 0xffe00000
    s_mov_b32 s84, 0xfffc0000
    s_mov_b32 s85, 0xffc00000
    s_mov_b32 s86, 0xfff80000
    s_mov_b32 s87, 0xff800000
    s_mov_b32 s88, 0xff000000
    s_mov_b32 s89, 0xf0000000
    s_mov_b32 s90, 0xfe000000
    s_mov_b32 s91, 0xe0000000
    s_mov_b32 s92, 0xfc000000
    s_mov_b32 s93, 0xc0000000
    s_mov_b32 s94, 0xf8000000
    s_mov_b32 s95, 0x80000000
    v_mov_b32 v2, 0
    v_mov_b32 v3, 0xffff
    v_mov_b32 v4, 0xffff0000
    v_and_b32 v5, 31, v1
    v_cmp_eq_u32 vcc, 20, v5
    v_cmp_eq_u32 s[98:99], 24, v5
    s_or_b64 vcc, vcc, s[98:99]
    v_cndmask_b32 v7, v2, v8, vcc
    v_mov_b32 v76, v7
    v_mov_b32 v77, v7
    v_mov_b32 v78, v7
    v_mov_b32 v79, v7
    v_mov_b32 v80, v7
    v_mov_b32 v81, v7
    v_mov_b32 v82, v7
    v_mov_b32 v83, v7
    v_mov_b32 v84, v7
    v_mov_b32 v85, v7
    v_mov_b32 v86, v7
    v_mov_b32 v87, v7
    v_mov_b32 v88, v7
    v_mov_b32 v89, v7
    v_mov_b32 v90, v7
    v_mov_b32 v91, v7
    v_mov_b32 v92, v7
    v_mov_b32 v93, v7
    v_mov_b32 v94, v7
    v_mov_b32 v95, v7
    v_mov_b32 v96, v7
    v_mov_b32 v97, v7
    v_mov_b32 v98, v7
    v_mov_b32 v99, v7
    v_mov_b32 v100, v7
    v_mov_b32 v101, v7
    v_mov_b32 v102, v7
    v_mov_b32 v103, v7
    v_mov_b32 v104, v7
    v_mov_b32 v105, v7
    v_mov_b32 v106, v7
    v_mov_b32 v107, v7
    v_mov_b32 v108, v7
    v_mov_b32 v109, v7
    v_mov_b32 v110, v7
    v_mov_b32 v111, v7
    v_mov_b32 v112, v7
    v_mov_b32 v113, v7
    v_mov_b32 v114, v7
    v_mov_b32 v115, v7
    v_mov_b32 v116, v7
    v_mov_b32 v117, v7
    v_mov_b32 v118, v7
    v_mov_b32 v119, v7
    v_mov_b32 v120, v7
    v_mov_b32 v121, v7
    v_mov_b32 v122, v7
    v_mov_b32 v123, v7
    v_mov_b32 v124, v7
    v_mov_b32 v125, v7
    v_mov_b32 v126, v7
    v_mov_b32 v127, v7
    v_mov_b32 v128, v7
    v_mov_b32 v129, v7
    v_mov_b32 v130, v7
    v_mov_b32 v131, v7
    v_mov_b32 v132, v7
    v_mov_b32 v133, v7
    v_mov_b32 v134, v7
    v_mov_b32 v135, v7
    v_mov_b32 v136, v7
    v_mov_b32 v137, v7
    v_mov_b32 v138, v7
    v_mov_b32 v139, v7
    v_mov_b32 v140, v7
    v_mov_b32 v141, v7
    v_mov_b32 v142, v7
    v_mov_b32 v143, v7
    v_mov_b32 v144, v7
    v_mov_b32 v145, v7
    v_mov_b32 v146, v7
    v_mov_b32 v147, v7
    v_mov_b32 v148, v7
    v_mov_b32 v149, v7
    v_mov_b32 v150, v7
    v_mov_b32 v151, v7
    v_mov_b32 v152, v7
    v_mov_b32 v153, v7
    v_mov_b32 v154, v7
    v_mov_b32 v155, v7
    s_mov_b32 s61, 0x07060302
    s_mov_b32 exec_lo, 0xfffff
    s_mov_b32 exec_hi, 0xfffff
    s_add_u32 s60, s59, 0x910000
    s_add_u32 s60, s60, s57
    s_cmp_ge_i32 s56, 0
    s_cselect_b32 s60, s60, 0x7f000000
    buffer_load_dwordx4 v[76:79], v248, s[12:15], s60 offen sc1
    s_mov_b64 exec, -1
    s_mov_b32 exec_lo, 0xfffff
    s_mov_b32 exec_hi, 0xfffff
    s_add_u32 s60, s59, 0x915000
    s_add_u32 s60, s60, s57
    s_cmp_ge_i32 s56, 0
    s_cselect_b32 s60, s60, 0x7f000000
    buffer_load_dwordx4 v[80:83], v248, s[12:15], s60 offen sc1
    s_mov_b64 exec, -1
    s_mov_b32 exec_lo, 0xfffff
    s_mov_b32 exec_hi, 0xfffff
    s_add_u32 s60, s59, 0x960000
    s_add_u32 s60, s60, s57
    buffer_load_dwordx4 v[140:143], v248, s[12:15], s60 offen sc1
    s_mov_b64 exec, -1
    s_mov_b32 exec_lo, 0xfffff
    s_mov_b32 exec_hi, 0xfffff
    s_add_u32 s60, s59, 0x965000
    s_add_u32 s60, s60, s57
    buffer_load_dwordx4 v[144:147], v248, s[12:15], s60 offen sc1
    s_mov_b64 exec, -1
    s_mov_b32 exec_lo, 0xfffff
    s_mov_b32 exec_hi, 0xfffff
    s_add_u32 s60, s59, 0x91a000
    s_add_u32 s60, s60, s57
    s_cmp_ge_i32 s56, -1
    s_cselect_b32 s60, s60, 0x7f000000
    buffer_load_dwordx4 v[84:87], v248, s[12:15], s60 offen sc1
    s_mov_b64 exec, -1
    s_mov_b32 exec_lo, 0xfffff
    s_mov_b32 exec_hi, 0xfffff
    s_add_u32 s60, s59, 0x91f000
    s_add_u32 s60, s60, s57
    s_cmp_ge_i32 s56, -1
    s_cselect_b32 s60, s60, 0x7f000000
    buffer_load_dwordx4 v[88:91], v248, s[12:15], s60 offen sc1
    s_mov_b64 exec, -1
    s_mov_b32 exec_lo, 0xfffff
    s_mov_b32 exec_hi, 0xfffff
    s_add_u32 s60, s59, 0x924000
    s_add_u32 s60, s60, s57
    s_cmp_ge_i32 s56, -2
    s_cselect_b32 s60, s60, 0x7f000000
    buffer_load_dwordx4 v[92:95], v248, s[12:15], s60 offen sc1
    s_mov_b64 exec, -1
    s_mov_b32 exec_lo, 0xfffff
    s_mov_b32 exec_hi, 0xfffff
    s_add_u32 s60, s59, 0x929000
    s_add_u32 s60, s60, s57
    s_cmp_ge_i32 s56, -2
    s_cselect_b32 s60, s60, 0x7f000000
    buffer_load_dwordx4 v[96:99], v248, s[12:15], s60 offen sc1
    s_mov_b64 exec, -1
    s_mov_b32 exec_lo, 0xfffff
    s_mov_b32 exec_hi, 0xfffff
    s_add_u32 s60, s59, 0x92e000
    s_add_u32 s60, s60, s57
    s_cmp_ge_i32 s56, -3
    s_cselect_b32 s60, s60, 0x7f000000
    buffer_load_dwordx4 v[100:103], v248, s[12:15], s60 offen sc1
    s_mov_b64 exec, -1
    s_mov_b32 exec_lo, 0xfffff
    s_mov_b32 exec_hi, 0xfffff
    s_add_u32 s60, s59, 0x933000
    s_add_u32 s60, s60, s57
    s_cmp_ge_i32 s56, -3
    s_cselect_b32 s60, s60, 0x7f000000
    buffer_load_dwordx4 v[104:107], v248, s[12:15], s60 offen sc1
    s_mov_b64 exec, -1
    s_mov_b32 exec_lo, 0xfffff
    s_mov_b32 exec_hi, 0xfffff
    s_add_u32 s60, s59, 0x938000
    s_add_u32 s60, s60, s57
    s_cmp_ge_i32 s56, -4
    s_cselect_b32 s60, s60, 0x7f000000
    buffer_load_dwordx4 v[108:111], v248, s[12:15], s60 offen sc1
    s_mov_b64 exec, -1
    s_mov_b32 exec_lo, 0xfffff
    s_mov_b32 exec_hi, 0xfffff
    s_add_u32 s60, s59, 0x93d000
    s_add_u32 s60, s60, s57
    s_cmp_ge_i32 s56, -4
    s_cselect_b32 s60, s60, 0x7f000000
    buffer_load_dwordx4 v[112:115], v248, s[12:15], s60 offen sc1
    s_mov_b64 exec, -1
    s_mov_b32 exec_lo, 0xfffff
    s_mov_b32 exec_hi, 0xfffff
    s_add_u32 s60, s59, 0x942000
    s_add_u32 s60, s60, s57
    s_cmp_ge_i32 s56, -5
    s_cselect_b32 s60, s60, 0x7f000000
    buffer_load_dwordx4 v[116:119], v248, s[12:15], s60 offen sc1
    s_mov_b64 exec, -1
    s_mov_b32 exec_lo, 0xfffff
    s_mov_b32 exec_hi, 0xfffff
    s_add_u32 s60, s59, 0x947000
    s_add_u32 s60, s60, s57
    s_cmp_ge_i32 s56, -5
    s_cselect_b32 s60, s60, 0x7f000000
    buffer_load_dwordx4 v[120:123], v248, s[12:15], s60 offen sc1
    s_mov_b64 exec, -1
    s_mov_b32 exec_lo, 0xfffff
    s_mov_b32 exec_hi, 0xfffff
    s_add_u32 s60, s59, 0x94c000
    s_add_u32 s60, s60, s57
    s_cmp_ge_i32 s56, -6
    s_cselect_b32 s60, s60, 0x7f000000
    buffer_load_dwordx4 v[124:127], v248, s[12:15], s60 offen sc1
    s_mov_b64 exec, -1
    s_mov_b32 exec_lo, 0xfffff
    s_mov_b32 exec_hi, 0xfffff
    s_add_u32 s60, s59, 0x951000
    s_add_u32 s60, s60, s57
    s_cmp_ge_i32 s56, -6
    s_cselect_b32 s60, s60, 0x7f000000
    buffer_load_dwordx4 v[128:131], v248, s[12:15], s60 offen sc1
    s_mov_b64 exec, -1
    s_mov_b32 exec_lo, 0xfffff
    s_mov_b32 exec_hi, 0xfffff
    s_add_u32 s60, s59, 0x956000
    s_add_u32 s60, s60, s57
    s_cmp_ge_i32 s56, -7
    s_cselect_b32 s60, s60, 0x7f000000
    buffer_load_dwordx4 v[132:135], v248, s[12:15], s60 offen sc1
    s_mov_b64 exec, -1
    s_mov_b32 exec_lo, 0xfffff
    s_mov_b32 exec_hi, 0xfffff
    s_add_u32 s60, s59, 0x95b000
    s_add_u32 s60, s60, s57
    s_cmp_ge_i32 s56, -7
    s_cselect_b32 s60, s60, 0x7f000000
    buffer_load_dwordx4 v[136:139], v248, s[12:15], s60 offen sc1
    s_mov_b64 exec, -1
    s_mov_b32 exec_lo, 0xfffff
    s_mov_b32 exec_hi, 0xfffff
    s_add_u32 s60, s59, 0x96a000
    s_add_u32 s60, s60, s57
    buffer_load_dwordx4 v[148:151], v248, s[12:15], s60 offen sc1
    s_mov_b64 exec, -1
    s_mov_b32 exec_lo, 0xfffff
    s_mov_b32 exec_hi, 0xfffff
    s_add_u32 s60, s59, 0x96f000
    s_add_u32 s60, s60, s57
    buffer_load_dwordx4 v[152:155], v248, s[12:15], s60 offen sc1
    s_mov_b64 exec, -1
    v_mov_b32 v10, 160452
    v_mov_b32 v11, 1
    s_mov_b64 exec, 1
    ds_add_u32 v10, v11
    s_mov_b64 exec, -1
    v_cndmask_b32 v5, v2, v3, s[64:65]
    v_cndmask_b32 v7, v2, v4, s[66:67]
    v_or_b32 v236, v5, v7
    v_cndmask_b32 v5, v2, v3, s[68:69]
    v_cndmask_b32 v7, v2, v4, s[70:71]
    v_or_b32 v237, v5, v7
    v_cndmask_b32 v5, v2, v3, s[72:73]
    v_cndmask_b32 v7, v2, v4, s[74:75]
    v_or_b32 v238, v5, v7
    v_cndmask_b32 v5, v2, v3, s[76:77]
    v_cndmask_b32 v7, v2, v4, s[78:79]
    v_or_b32 v239, v5, v7
    v_cndmask_b32 v5, v2, v3, s[80:81]
    v_cndmask_b32 v7, v2, v4, s[82:83]
    v_or_b32 v240, v5, v7
    v_cndmask_b32 v5, v2, v3, s[84:85]
    v_cndmask_b32 v7, v2, v4, s[86:87]
    v_or_b32 v241, v5, v7
    v_cndmask_b32 v5, v2, v3, s[88:89]
    v_cndmask_b32 v7, v2, v4, s[90:91]
    v_or_b32 v242, v5, v7
    v_cndmask_b32 v5, v2, v3, s[92:93]
    v_cndmask_b32 v7, v2, v4, s[94:95]
    v_or_b32 v243, v5, v7
    s_setprio 0
    s_waitcnt vmcnt(20)
    v_mfma_f32_32x32x16_bf16 v[188:203], v[16:19], v[156:159], 0
    v_mfma_f32_32x32x16_bf16 v[188:203], v[18:21], v[160:163], v[188:203]
    v_mfma_f32_32x32x16_bf16 v[204:219], v[64:67], v[156:159], 0
    v_mfma_f32_32x32x16_bf16 v[204:219], v[66:69], v[160:163], v[204:219]
    s_nop 11
    v_cndmask_b32 v188, v188, v204, s[64:65]
    v_cndmask_b32 v189, v189, v205, s[66:67]
    v_cndmask_b32 v190, v190, v206, s[68:69]
    v_cndmask_b32 v191, v191, v207, s[70:71]
    v_cndmask_b32 v192, v192, v208, s[72:73]
    v_cndmask_b32 v193, v193, v209, s[74:75]
    v_cndmask_b32 v194, v194, v210, s[76:77]
    v_cndmask_b32 v195, v195, v211, s[78:79]
    v_cndmask_b32 v196, v196, v212, s[80:81]
    v_cndmask_b32 v197, v197, v213, s[82:83]
    v_cndmask_b32 v198, v198, v214, s[84:85]
    v_cndmask_b32 v199, v199, v215, s[86:87]
    v_cndmask_b32 v200, v200, v216, s[88:89]
    v_cndmask_b32 v201, v201, v217, s[90:91]
    v_cndmask_b32 v202, v202, v218, s[92:93]
    v_cndmask_b32 v203, v203, v219, s[94:95]
    v_mfma_f32_32x32x16_bf16 v[204:219], v[22:25], v[156:159], 0
    v_mfma_f32_32x32x16_bf16 v[204:219], v[24:27], v[160:163], v[204:219]
    v_max3_f32 v244, v188, v189, v190
    v_max3_f32 v245, v191, v192, v193
    v_max3_f32 v244, v194, v195, v244
    v_max3_f32 v245, v196, v197, v245
    v_max3_f32 v244, v198, v199, v244
    v_max3_f32 v245, v200, v201, v245
    v_max3_f32 v244, v202, v203, v244
    v_mfma_f32_32x32x16_bf16 v[188:203], v[28:31], v[156:159], 0
    v_mfma_f32_32x32x16_bf16 v[188:203], v[30:33], v[160:163], v[188:203]
    s_nop 2
    v_max3_f32 v244, v204, v205, v244
    v_max3_f32 v245, v206, v207, v245
    v_max3_f32 v244, v208, v209, v244
    v_max3_f32 v245, v210, v211, v245
    v_max3_f32 v244, v212, v213, v244
    v_max3_f32 v245, v214, v215, v245
    v_max3_f32 v244, v216, v217, v244
    v_max3_f32 v245, v218, v219, v245
    v_mfma_f32_32x32x16_bf16 v[204:219], v[34:37], v[156:159], 0
    v_mfma_f32_32x32x16_bf16 v[204:219], v[36:39], v[160:163], v[204:219]
    v_max3_f32 v244, v188, v189, v244
    v_max3_f32 v245, v190, v191, v245
    v_max3_f32 v244, v192, v193, v244
    v_max3_f32 v245, v194, v195, v245
    v_max3_f32 v244, v196, v197, v244
    v_max3_f32 v245, v198, v199, v245
    v_max3_f32 v244, v200, v201, v244
    v_max3_f32 v245, v202, v203, v245
    v_mfma_f32_32x32x16_bf16 v[188:203], v[40:43], v[156:159], 0
    v_mfma_f32_32x32x16_bf16 v[188:203], v[42:45], v[160:163], v[188:203]
    s_nop 1
    v_max3_f32 v244, v204, v205, v244
    v_max3_f32 v245, v206, v207, v245
    v_max3_f32 v244, v208, v209, v244
    v_max3_f32 v245, v210, v211, v245
    v_max3_f32 v244, v212, v213, v244
    v_max3_f32 v245, v214, v215, v245
    v_max3_f32 v244, v216, v217, v244
    v_max3_f32 v245, v218, v219, v245
    v_mfma_f32_32x32x16_bf16 v[204:219], v[46:49], v[156:159], 0
    v_mfma_f32_32x32x16_bf16 v[204:219], v[48:51], v[160:163], v[204:219]
    v_max3_f32 v244, v188, v189, v244
    v_max3_f32 v245, v190, v191, v245
    v_max3_f32 v244, v192, v193, v244
    v_max3_f32 v245, v194, v195, v245
    v_max3_f32 v244, v196, v197, v244
    v_max3_f32 v245, v198, v199, v245
    v_max3_f32 v244, v200, v201, v244
    v_max3_f32 v245, v202, v203, v245
    v_mfma_f32_32x32x16_bf16 v[188:203], v[52:55], v[156:159], 0
    v_mfma_f32_32x32x16_bf16 v[188:203], v[54:57], v[160:163], v[188:203]
    s_nop 1
    v_max3_f32 v244, v204, v205, v244
    v_max3_f32 v245, v206, v207, v245
    v_max3_f32 v244, v208, v209, v244
    v_max3_f32 v245, v210, v211, v245
    v_max3_f32 v244, v212, v213, v244
    v_max3_f32 v245, v214, v215, v245
    v_max3_f32 v244, v216, v217, v244
    v_max3_f32 v245, v218, v219, v245
    v_mfma_f32_32x32x16_bf16 v[204:219], v[58:61], v[156:159], 0
    v_mfma_f32_32x32x16_bf16 v[204:219], v[60:63], v[160:163], v[204:219]
    v_max3_f32 v244, v188, v189, v244
    v_max3_f32 v245, v190, v191, v245
    v_max3_f32 v244, v192, v193, v244
    v_max3_f32 v245, v194, v195, v245
    v_max3_f32 v244, v196, v197, v244
    v_max3_f32 v245, v198, v199, v245
    v_max3_f32 v244, v200, v201, v244
    v_max3_f32 v245, v202, v203, v245
    s_nop 3
    v_max3_f32 v244, v204, v205, v244
    v_max3_f32 v245, v206, v207, v245
    v_max3_f32 v244, v208, v209, v244
    v_max3_f32 v245, v210, v211, v245
    v_max3_f32 v244, v212, v213, v244
    v_max3_f32 v245, v214, v215, v245
    v_max3_f32 v244, v216, v217, v244
    v_max3_f32 v245, v218, v219, v245
    v_max_f32 v244, v244, v245
    v_mov_b32 v2, v244
    s_nop 1
    v_permlane32_swap_b32 v244, v2
    v_max_f32 v2, v244, v2
    v_xor_b32 v2, 0x80000000, v2
    v_and_b32 v3, 0xffff0000, v2
    v_sub_f32 v4, v2, v3
    v_and_b32 v5, 0xffff0000, v4
    v_sub_f32 v5, v4, v5
    v_mov_b32 v6, 1.0
    s_mov_b32 exec_lo, 0
    v_perm_b32 v162, v4, v3, s61
    v_perm_b32 v163, v6, v5, s61
    s_mov_b32 exec_lo, -1
    v_mfma_f32_32x32x16_bf16 v[188:203], v[16:19], v[156:159], 0
    v_mfma_f32_32x32x16_bf16 v[188:203], v[18:21], v[160:163], v[188:203]
    v_mfma_f32_32x32x16_bf16 v[204:219], v[64:67], v[156:159], 0
    v_mfma_f32_32x32x16_bf16 v[204:219], v[66:69], v[160:163], v[204:219]
    s_nop 11
    v_cndmask_b32 v188, v188, v204, s[64:65]
    v_cndmask_b32 v189, v189, v205, s[66:67]
    v_cndmask_b32 v190, v190, v206, s[68:69]
    v_cndmask_b32 v191, v191, v207, s[70:71]
    v_cndmask_b32 v192, v192, v208, s[72:73]
    v_cndmask_b32 v193, v193, v209, s[74:75]
    v_cndmask_b32 v194, v194, v210, s[76:77]
    v_cndmask_b32 v195, v195, v211, s[78:79]
    v_cndmask_b32 v196, v196, v212, s[80:81]
    v_cndmask_b32 v197, v197, v213, s[82:83]
    v_cndmask_b32 v198, v198, v214, s[84:85]
    v_cndmask_b32 v199, v199, v215, s[86:87]
    v_cndmask_b32 v200, v200, v216, s[88:89]
    v_cndmask_b32 v201, v201, v217, s[90:91]
    v_cndmask_b32 v202, v202, v218, s[92:93]
    v_cndmask_b32 v203, v203, v219, s[94:95]
    v_mfma_f32_32x32x16_bf16 v[204:219], v[22:25], v[156:159], 0
    v_mfma_f32_32x32x16_bf16 v[204:219], v[24:27], v[160:163], v[204:219]
    v_exp_f32 v188, v188
    v_exp_f32 v189, v189
    v_exp_f32 v190, v190
    v_exp_f32 v191, v191
    v_exp_f32 v192, v192
    v_exp_f32 v193, v193
    v_exp_f32 v194, v194
    v_exp_f32 v195, v195
    v_cvt_pk_bf16_f32 v220, v188, v189
    v_cvt_pk_bf16_f32 v221, v190, v191
    v_cvt_pk_bf16_f32 v222, v192, v193
    v_cvt_pk_bf16_f32 v223, v194, v195
    v_bfi_b32 v228, v236, 0, v220
    v_and_b32 v220, v236, v220
    v_bfi_b32 v229, v237, 0, v221
    v_and_b32 v221, v237, v221
    v_bfi_b32 v230, v238, 0, v222
    v_and_b32 v222, v238, v222
    v_bfi_b32 v231, v239, 0, v223
    v_and_b32 v223, v239, v223
    s_waitcnt vmcnt(18)
    v_mfma_f32_32x32x16_bf16 v[172:187], v[76:79], v[228:231], 0
    s_waitcnt vmcnt(16)
    v_mfma_f32_32x32x16_bf16 v[172:187], v[140:143], v[220:223], v[172:187]
    v_exp_f32 v196, v196
    v_exp_f32 v197, v197
    v_exp_f32 v198, v198
    v_exp_f32 v199, v199
    v_exp_f32 v200, v200
    v_exp_f32 v201, v201
    v_exp_f32 v202, v202
    v_exp_f32 v203, v203
    v_cvt_pk_bf16_f32 v224, v196, v197
    v_cvt_pk_bf16_f32 v225, v198, v199
    v_cvt_pk_bf16_f32 v226, v200, v201
    v_cvt_pk_bf16_f32 v227, v202, v203
    v_bfi_b32 v232, v240, 0, v224
    v_and_b32 v224, v240, v224
    v_bfi_b32 v233, v241, 0, v225
    v_and_b32 v225, v241, v225
    v_bfi_b32 v234, v242, 0, v226
    v_and_b32 v226, v242, v226
    v_bfi_b32 v235, v243, 0, v227
    v_and_b32 v227, v243, v227
    s_nop 0
    v_mfma_f32_32x32x16_bf16 v[172:187], v[80:83], v[232:235], v[172:187]
    v_mfma_f32_32x32x16_bf16 v[172:187], v[144:147], v[224:227], v[172:187]
    v_mfma_f32_32x32x16_bf16 v[188:203], v[28:31], v[156:159], 0
    v_mfma_f32_32x32x16_bf16 v[188:203], v[30:33], v[160:163], v[188:203]
    v_exp_f32 v204, v204
    v_exp_f32 v205, v205
    v_exp_f32 v206, v206
    v_exp_f32 v207, v207
    v_exp_f32 v208, v208
    v_exp_f32 v209, v209
    v_exp_f32 v210, v210
    v_exp_f32 v211, v211
    v_cvt_pk_bf16_f32 v220, v204, v205
    v_cvt_pk_bf16_f32 v221, v206, v207
    v_cvt_pk_bf16_f32 v222, v208, v209
    v_cvt_pk_bf16_f32 v223, v210, v211
    v_exp_f32 v212, v212
    v_exp_f32 v213, v213
    s_waitcnt vmcnt(14)
    v_mfma_f32_32x32x16_bf16 v[172:187], v[84:87], v[220:223], v[172:187]
    v_exp_f32 v214, v214
    v_exp_f32 v215, v215
    v_exp_f32 v216, v216
    v_exp_f32 v217, v217
    v_exp_f32 v218, v218
    v_exp_f32 v219, v219
    v_cvt_pk_bf16_f32 v224, v212, v213
    v_cvt_pk_bf16_f32 v225, v214, v215
    v_cvt_pk_bf16_f32 v226, v216, v217
    v_cvt_pk_bf16_f32 v227, v218, v219
    v_mfma_f32_32x32x16_bf16 v[204:219], v[34:37], v[156:159], 0
    v_mfma_f32_32x32x16_bf16 v[204:219], v[36:39], v[160:163], v[204:219]
    v_exp_f32 v188, v188
    v_exp_f32 v189, v189
    v_mfma_f32_32x32x16_bf16 v[172:187], v[88:91], v[224:227], v[172:187]
    v_exp_f32 v190, v190
    v_exp_f32 v191, v191
    v_exp_f32 v192, v192
    v_exp_f32 v193, v193
    v_exp_f32 v194, v194
    v_exp_f32 v195, v195
    v_cvt_pk_bf16_f32 v220, v188, v189
    v_cvt_pk_bf16_f32 v221, v190, v191
    v_cvt_pk_bf16_f32 v222, v192, v193
    v_cvt_pk_bf16_f32 v223, v194, v195
    v_exp_f32 v196, v196
    v_exp_f32 v197, v197
    s_waitcnt vmcnt(12)
    v_mfma_f32_32x32x16_bf16 v[172:187], v[92:95], v[220:223], v[172:187]
    v_exp_f32 v198, v198
    v_exp_f32 v199, v199
    v_exp_f32 v200, v200
    v_exp_f32 v201, v201
    v_exp_f32 v202, v202
    v_exp_f32 v203, v203
    v_cvt_pk_bf16_f32 v224, v196, v197
    v_cvt_pk_bf16_f32 v225, v198, v199
    v_cvt_pk_bf16_f32 v226, v200, v201
    v_cvt_pk_bf16_f32 v227, v202, v203
    v_mfma_f32_32x32x16_bf16 v[188:203], v[40:43], v[156:159], 0
    v_mfma_f32_32x32x16_bf16 v[188:203], v[42:45], v[160:163], v[188:203]
    v_exp_f32 v204, v204
    v_exp_f32 v205, v205
    v_mfma_f32_32x32x16_bf16 v[172:187], v[96:99], v[224:227], v[172:187]
    v_exp_f32 v206, v206
    v_exp_f32 v207, v207
    v_exp_f32 v208, v208
    v_exp_f32 v209, v209
    v_exp_f32 v210, v210
    v_exp_f32 v211, v211
    v_cvt_pk_bf16_f32 v220, v204, v205
    v_cvt_pk_bf16_f32 v221, v206, v207
    v_cvt_pk_bf16_f32 v222, v208, v209
    v_cvt_pk_bf16_f32 v223, v210, v211
    v_exp_f32 v212, v212
    v_exp_f32 v213, v213
    s_waitcnt vmcnt(10)
    v_mfma_f32_32x32x16_bf16 v[172:187], v[100:103], v[220:223], v[172:187]
    v_exp_f32 v214, v214
    v_exp_f32 v215, v215
    v_exp_f32 v216, v216
    v_exp_f32 v217, v217
    v_exp_f32 v218, v218
    v_exp_f32 v219, v219
    v_cvt_pk_bf16_f32 v224, v212, v213
    v_cvt_pk_bf16_f32 v225, v214, v215
    v_cvt_pk_bf16_f32 v226, v216, v217
    v_cvt_pk_bf16_f32 v227, v218, v219
    v_mfma_f32_32x32x16_bf16 v[204:219], v[46:49], v[156:159], 0
    v_mfma_f32_32x32x16_bf16 v[204:219], v[48:51], v[160:163], v[204:219]
    v_exp_f32 v188, v188
    v_exp_f32 v189, v189
    v_mfma_f32_32x32x16_bf16 v[172:187], v[104:107], v[224:227], v[172:187]
    v_exp_f32 v190, v190
    v_exp_f32 v191, v191
    v_exp_f32 v192, v192
    v_exp_f32 v193, v193
    v_exp_f32 v194, v194
    v_exp_f32 v195, v195
    v_cvt_pk_bf16_f32 v220, v188, v189
    v_cvt_pk_bf16_f32 v221, v190, v191
    v_cvt_pk_bf16_f32 v222, v192, v193
    v_cvt_pk_bf16_f32 v223, v194, v195
    v_exp_f32 v196, v196
    v_exp_f32 v197, v197
    s_waitcnt vmcnt(8)
    v_mfma_f32_32x32x16_bf16 v[172:187], v[108:111], v[220:223], v[172:187]
    v_exp_f32 v198, v198
    v_exp_f32 v199, v199
    v_exp_f32 v200, v200
    v_exp_f32 v201, v201
    v_exp_f32 v202, v202
    v_exp_f32 v203, v203
    v_cvt_pk_bf16_f32 v224, v196, v197
    v_cvt_pk_bf16_f32 v225, v198, v199
    v_cvt_pk_bf16_f32 v226, v200, v201
    v_cvt_pk_bf16_f32 v227, v202, v203
    v_mfma_f32_32x32x16_bf16 v[188:203], v[52:55], v[156:159], 0
    v_mfma_f32_32x32x16_bf16 v[188:203], v[54:57], v[160:163], v[188:203]
    v_exp_f32 v204, v204
    v_exp_f32 v205, v205
    v_mfma_f32_32x32x16_bf16 v[172:187], v[112:115], v[224:227], v[172:187]
    v_exp_f32 v206, v206
    v_exp_f32 v207, v207
    v_exp_f32 v208, v208
    v_exp_f32 v209, v209
    v_exp_f32 v210, v210
    v_exp_f32 v211, v211
    v_cvt_pk_bf16_f32 v220, v204, v205
    v_cvt_pk_bf16_f32 v221, v206, v207
    v_cvt_pk_bf16_f32 v222, v208, v209
    v_cvt_pk_bf16_f32 v223, v210, v211
    v_exp_f32 v212, v212
    v_exp_f32 v213, v213
    s_waitcnt vmcnt(6)
    v_mfma_f32_32x32x16_bf16 v[172:187], v[116:119], v[220:223], v[172:187]
    v_exp_f32 v214, v214
    v_exp_f32 v215, v215
    v_exp_f32 v216, v216
    v_exp_f32 v217, v217
    v_exp_f32 v218, v218
    v_exp_f32 v219, v219
    v_cvt_pk_bf16_f32 v224, v212, v213
    v_cvt_pk_bf16_f32 v225, v214, v215
    v_cvt_pk_bf16_f32 v226, v216, v217
    v_cvt_pk_bf16_f32 v227, v218, v219
    v_mfma_f32_32x32x16_bf16 v[204:219], v[58:61], v[156:159], 0
    v_mfma_f32_32x32x16_bf16 v[204:219], v[60:63], v[160:163], v[204:219]
    v_exp_f32 v188, v188
    v_exp_f32 v189, v189
    v_mfma_f32_32x32x16_bf16 v[172:187], v[120:123], v[224:227], v[172:187]
    v_exp_f32 v190, v190
    v_exp_f32 v191, v191
    v_exp_f32 v192, v192
    v_exp_f32 v193, v193
    v_exp_f32 v194, v194
    v_exp_f32 v195, v195
    v_cvt_pk_bf16_f32 v220, v188, v189
    v_cvt_pk_bf16_f32 v221, v190, v191
    v_cvt_pk_bf16_f32 v222, v192, v193
    v_cvt_pk_bf16_f32 v223, v194, v195
    v_exp_f32 v196, v196
    v_exp_f32 v197, v197
    s_waitcnt vmcnt(4)
    v_mfma_f32_32x32x16_bf16 v[172:187], v[124:127], v[220:223], v[172:187]
    v_exp_f32 v198, v198
    v_exp_f32 v199, v199
    v_exp_f32 v200, v200
    v_exp_f32 v201, v201
    v_exp_f32 v202, v202
    v_exp_f32 v203, v203
    v_cvt_pk_bf16_f32 v224, v196, v197
    v_cvt_pk_bf16_f32 v225, v198, v199
    v_cvt_pk_bf16_f32 v226, v200, v201
    v_cvt_pk_bf16_f32 v227, v202, v203
    v_exp_f32 v204, v204
    v_exp_f32 v205, v205
    v_mfma_f32_32x32x16_bf16 v[172:187], v[128:131], v[224:227], v[172:187]
    v_exp_f32 v206, v206
    v_exp_f32 v207, v207
    v_exp_f32 v208, v208
    v_exp_f32 v209, v209
    v_exp_f32 v210, v210
    v_exp_f32 v211, v211
    v_cvt_pk_bf16_f32 v220, v204, v205
    v_cvt_pk_bf16_f32 v221, v206, v207
    v_cvt_pk_bf16_f32 v222, v208, v209
    v_cvt_pk_bf16_f32 v223, v210, v211
    v_exp_f32 v212, v212
    v_exp_f32 v213, v213
    s_waitcnt vmcnt(2)
    v_mfma_f32_32x32x16_bf16 v[172:187], v[132:135], v[220:223], v[172:187]
    v_exp_f32 v214, v214
    v_exp_f32 v215, v215
    v_exp_f32 v216, v216
    v_exp_f32 v217, v217
    v_exp_f32 v218, v218
    v_exp_f32 v219, v219
    v_cvt_pk_bf16_f32 v224, v212, v213
    v_cvt_pk_bf16_f32 v225, v214, v215
    v_cvt_pk_bf16_f32 v226, v216, v217
    v_cvt_pk_bf16_f32 v227, v218, v219
    s_nop 1
    v_mfma_f32_32x32x16_bf16 v[172:187], v[136:139], v[224:227], v[172:187]
    s_mul_i32 s58, s46, 81920
    s_add_u32 s58, s58, 12124160
    s_mov_b32 vcc_lo, 0
    s_mov_b32 vcc_hi, -1
    s_nop 7
    v_cndmask_b32 v2, v184, v180, vcc
    v_rcp_f32 v2, v2
    s_nop 0
    v_mul_f32 v172, v172, v2
    v_mul_f32 v173, v173, v2
    v_mul_f32 v174, v174, v2
    v_mul_f32 v175, v175, v2
    v_mul_f32 v176, v176, v2
    v_mul_f32 v177, v177, v2
    v_mul_f32 v178, v178, v2
    v_mul_f32 v179, v179, v2
    v_mul_f32 v180, v180, v2
    v_mul_f32 v181, v181, v2
    v_mul_f32 v182, v182, v2
    v_mul_f32 v183, v183, v2
    v_cvt_pk_bf16_f32 v4, v172, v173
    v_cvt_pk_bf16_f32 v5, v174, v175
    v_cvt_pk_bf16_f32 v6, v176, v177
    v_cvt_pk_bf16_f32 v7, v178, v179
    v_cvt_pk_bf16_f32 v8, v180, v181
    v_cvt_pk_bf16_f32 v9, v182, v183
    s_setprio 2
    buffer_store_dwordx4 v[4:7], v249, s[12:15], s58 offen sc1
    s_setprio 0
    s_mov_b32 exec_hi, 0
    s_setprio 2
    buffer_store_dwordx2 v[8:9], v250, s[12:15], s58 offen sc1
    s_setprio 0
    s_mov_b32 exec_hi, -1
    v_mfma_f32_32x32x16_bf16 v[188:203], v[22:25], v[164:167], 0
    v_mfma_f32_32x32x16_bf16 v[188:203], v[24:27], v[168:171], v[188:203]
    v_mfma_f32_32x32x16_bf16 v[204:219], v[70:73], v[164:167], 0
    v_mfma_f32_32x32x16_bf16 v[204:219], v[72:75], v[168:171], v[204:219]
    s_nop 11
    v_cndmask_b32 v188, v188, v204, s[64:65]
    v_cndmask_b32 v189, v189, v205, s[66:67]
    v_cndmask_b32 v190, v190, v206, s[68:69]
    v_cndmask_b32 v191, v191, v207, s[70:71]
    v_cndmask_b32 v192, v192, v208, s[72:73]
    v_cndmask_b32 v193, v193, v209, s[74:75]
    v_cndmask_b32 v194, v194, v210, s[76:77]
    v_cndmask_b32 v195, v195, v211, s[78:79]
    v_cndmask_b32 v196, v196, v212, s[80:81]
    v_cndmask_b32 v197, v197, v213, s[82:83]
    v_cndmask_b32 v198, v198, v214, s[84:85]
    v_cndmask_b32 v199, v199, v215, s[86:87]
    v_cndmask_b32 v200, v200, v216, s[88:89]
    v_cndmask_b32 v201, v201, v217, s[90:91]
    v_cndmask_b32 v202, v202, v218, s[92:93]
    v_cndmask_b32 v203, v203, v219, s[94:95]
    v_mfma_f32_32x32x16_bf16 v[204:219], v[28:31], v[164:167], 0
    v_mfma_f32_32x32x16_bf16 v[204:219], v[30:33], v[168:171], v[204:219]
    v_max3_f32 v244, v188, v189, v190
    v_max3_f32 v245, v191, v192, v193
    v_max3_f32 v244, v194, v195, v244
    v_max3_f32 v245, v196, v197, v245
    v_max3_f32 v244, v198, v199, v244
    v_max3_f32 v245, v200, v201, v245
    v_max3_f32 v244, v202, v203, v244
    v_mfma_f32_32x32x16_bf16 v[188:203], v[34:37], v[164:167], 0
    v_mfma_f32_32x32x16_bf16 v[188:203], v[36:39], v[168:171], v[188:203]
    s_nop 2
    v_max3_f32 v244, v204, v205, v244
    v_max3_f32 v245, v206, v207, v245
    v_max3_f32 v244, v208, v209, v244
    v_max3_f32 v245, v210, v211, v245
    v_max3_f32 v244, v212, v213, v244
    v_max3_f32 v245, v214, v215, v245
    v_max3_f32 v244, v216, v217, v244
    v_max3_f32 v245, v218, v219, v245
    v_mfma_f32_32x32x16_bf16 v[204:219], v[40:43], v[164:167], 0
    v_mfma_f32_32x32x16_bf16 v[204:219], v[42:45], v[168:171], v[204:219]
    v_max3_f32 v244, v188, v189, v244
    v_max3_f32 v245, v190, v191, v245
    v_max3_f32 v244, v192, v193, v244
    v_max3_f32 v245, v194, v195, v245
    v_max3_f32 v244, v196, v197, v244
    v_max3_f32 v245, v198, v199, v245
    v_max3_f32 v244, v200, v201, v244
    v_max3_f32 v245, v202, v203, v245
    v_mfma_f32_32x32x16_bf16 v[188:203], v[46:49], v[164:167], 0
    v_mfma_f32_32x32x16_bf16 v[188:203], v[48:51], v[168:171], v[188:203]
    s_nop 1
    v_max3_f32 v244, v204, v205, v244
    v_max3_f32 v245, v206, v207, v245
    v_max3_f32 v244, v208, v209, v244
    v_max3_f32 v245, v210, v211, v245
    v_max3_f32 v244, v212, v213, v244
    v_max3_f32 v245, v214, v215, v245
    v_max3_f32 v244, v216, v217, v244
    v_max3_f32 v245, v218, v219, v245
    v_mfma_f32_32x32x16_bf16 v[204:219], v[52:55], v[164:167], 0
    v_mfma_f32_32x32x16_bf16 v[204:219], v[54:57], v[168:171], v[204:219]
    v_max3_f32 v244, v188, v189, v244
    v_max3_f32 v245, v190, v191, v245
    v_max3_f32 v244, v192, v193, v244
    v_max3_f32 v245, v194, v195, v245
    v_max3_f32 v244, v196, v197, v244
    v_max3_f32 v245, v198, v199, v245
    v_max3_f32 v244, v200, v201, v244
    v_max3_f32 v245, v202, v203, v245
    v_mfma_f32_32x32x16_bf16 v[188:203], v[58:61], v[164:167], 0
    v_mfma_f32_32x32x16_bf16 v[188:203], v[60:63], v[168:171], v[188:203]
    s_nop 1
    v_max3_f32 v244, v204, v205, v244
    v_max3_f32 v245, v206, v207, v245
    v_max3_f32 v244, v208, v209, v244
    v_max3_f32 v245, v210, v211, v245
    v_max3_f32 v244, v212, v213, v244
    v_max3_f32 v245, v214, v215, v245
    v_max3_f32 v244, v216, v217, v244
    v_max3_f32 v245, v218, v219, v245
    v_mfma_f32_32x32x16_bf16 v[204:219], v[64:67], v[164:167], 0
    v_mfma_f32_32x32x16_bf16 v[204:219], v[66:69], v[168:171], v[204:219]
    v_max3_f32 v244, v188, v189, v244
    v_max3_f32 v245, v190, v191, v245
    v_max3_f32 v244, v192, v193, v244
    v_max3_f32 v245, v194, v195, v245
    v_max3_f32 v244, v196, v197, v244
    v_max3_f32 v245, v198, v199, v245
    v_max3_f32 v244, v200, v201, v244
    v_max3_f32 v245, v202, v203, v245
    s_nop 3
    v_max3_f32 v244, v204, v205, v244
    v_max3_f32 v245, v206, v207, v245
    v_max3_f32 v244, v208, v209, v244
    v_max3_f32 v245, v210, v211, v245
    v_max3_f32 v244, v212, v213, v244
    v_max3_f32 v245, v214, v215, v245
    v_max3_f32 v244, v216, v217, v244
    v_max3_f32 v245, v218, v219, v245
    v_max_f32 v244, v244, v245
    v_mov_b32 v2, v244
    s_nop 1
    v_permlane32_swap_b32 v244, v2
    v_max_f32 v2, v244, v2
    v_xor_b32 v2, 0x80000000, v2
    v_and_b32 v3, 0xffff0000, v2
    v_sub_f32 v4, v2, v3
    v_and_b32 v5, 0xffff0000, v4
    v_sub_f32 v5, v4, v5
    v_mov_b32 v6, 1.0
    s_mov_b32 exec_lo, 0
    v_perm_b32 v170, v4, v3, s61
    v_perm_b32 v171, v6, v5, s61
    s_mov_b32 exec_lo, -1
    v_mfma_f32_32x32x16_bf16 v[188:203], v[22:25], v[164:167], 0
    v_mfma_f32_32x32x16_bf16 v[188:203], v[24:27], v[168:171], v[188:203]
    v_mfma_f32_32x32x16_bf16 v[204:219], v[70:73], v[164:167], 0
    v_mfma_f32_32x32x16_bf16 v[204:219], v[72:75], v[168:171], v[204:219]
    s_nop 11
    v_cndmask_b32 v188, v188, v204, s[64:65]
    v_cndmask_b32 v189, v189, v205, s[66:67]
    v_cndmask_b32 v190, v190, v206, s[68:69]
    v_cndmask_b32 v191, v191, v207, s[70:71]
    v_cndmask_b32 v192, v192, v208, s[72:73]
    v_cndmask_b32 v193, v193, v209, s[74:75]
    v_cndmask_b32 v194, v194, v210, s[76:77]
    v_cndmask_b32 v195, v195, v211, s[78:79]
    v_cndmask_b32 v196, v196, v212, s[80:81]
    v_cndmask_b32 v197, v197, v213, s[82:83]
    v_cndmask_b32 v198, v198, v214, s[84:85]
    v_cndmask_b32 v199, v199, v215, s[86:87]
    v_cndmask_b32 v200, v200, v216, s[88:89]
    v_cndmask_b32 v201, v201, v217, s[90:91]
    v_cndmask_b32 v202, v202, v218, s[92:93]
    v_cndmask_b32 v203, v203, v219, s[94:95]
    v_mfma_f32_32x32x16_bf16 v[204:219], v[28:31], v[164:167], 0
    v_mfma_f32_32x32x16_bf16 v[204:219], v[30:33], v[168:171], v[204:219]
    v_exp_f32 v188, v188
    v_exp_f32 v189, v189
    v_exp_f32 v190, v190
    v_exp_f32 v191, v191
    v_exp_f32 v192, v192
    v_exp_f32 v193, v193
    v_exp_f32 v194, v194
    v_exp_f32 v195, v195
    v_cvt_pk_bf16_f32 v220, v188, v189
    v_cvt_pk_bf16_f32 v221, v190, v191
    v_cvt_pk_bf16_f32 v222, v192, v193
    v_cvt_pk_bf16_f32 v223, v194, v195
    v_bfi_b32 v228, v236, 0, v220
    v_and_b32 v220, v236, v220
    v_bfi_b32 v229, v237, 0, v221
    v_and_b32 v221, v237, v221
    v_bfi_b32 v230, v238, 0, v222
    v_and_b32 v222, v238, v222
    v_bfi_b32 v231, v239, 0, v223
    v_and_b32 v223, v239, v223
    s_nop 0
    v_mfma_f32_32x32x16_bf16 v[172:187], v[84:87], v[228:231], 0
    s_waitcnt vmcnt(2)
    v_mfma_f32_32x32x16_bf16 v[172:187], v[148:151], v[220:223], v[172:187]
    v_exp_f32 v196, v196
    v_exp_f32 v197, v197
    v_exp_f32 v198, v198
    v_exp_f32 v199, v199
    v_exp_f32 v200, v200
    v_exp_f32 v201, v201
    v_exp_f32 v202, v202
    v_exp_f32 v203, v203
    v_cvt_pk_bf16_f32 v224, v196, v197
    v_cvt_pk_bf16_f32 v225, v198, v199
    v_cvt_pk_bf16_f32 v226, v200, v201
    v_cvt_pk_bf16_f32 v227, v202, v203
    v_bfi_b32 v232, v240, 0, v224
    v_and_b32 v224, v240, v224
    v_bfi_b32 v233, v241, 0, v225
    v_and_b32 v225, v241, v225
    v_bfi_b32 v234, v242, 0, v226
    v_and_b32 v226, v242, v226
    v_bfi_b32 v235, v243, 0, v227
    v_and_b32 v227, v243, v227
    s_nop 0
    v_mfma_f32_32x32x16_bf16 v[172:187], v[88:91], v[232:235], v[172:187]
    v_mfma_f32_32x32x16_bf16 v[172:187], v[152:155], v[224:227], v[172:187]
    v_mfma_f32_32x32x16_bf16 v[188:203], v[34:37], v[164:167], 0
    v_mfma_f32_32x32x16_bf16 v[188:203], v[36:39], v[168:171], v[188:203]
    v_exp_f32 v204, v204
    v_exp_f32 v205, v205
    v_exp_f32 v206, v206
    v_exp_f32 v207, v207
    v_exp_f32 v208, v208
    v_exp_f32 v209, v209
    v_exp_f32 v210, v210
    v_exp_f32 v211, v211
    v_cvt_pk_bf16_f32 v220, v204, v205
    v_cvt_pk_bf16_f32 v221, v206, v207
    v_cvt_pk_bf16_f32 v222, v208, v209
    v_cvt_pk_bf16_f32 v223, v210, v211
    v_exp_f32 v212, v212
    v_exp_f32 v213, v213
    v_mfma_f32_32x32x16_bf16 v[172:187], v[92:95], v[220:223], v[172:187]
    v_exp_f32 v214, v214
    v_exp_f32 v215, v215
    v_exp_f32 v216, v216
    v_exp_f32 v217, v217
    v_exp_f32 v218, v218
    v_exp_f32 v219, v219
    v_cvt_pk_bf16_f32 v224, v212, v213
    v_cvt_pk_bf16_f32 v225, v214, v215
    v_cvt_pk_bf16_f32 v226, v216, v217
    v_cvt_pk_bf16_f32 v227, v218, v219
    v_mfma_f32_32x32x16_bf16 v[204:219], v[40:43], v[164:167], 0
    v_mfma_f32_32x32x16_bf16 v[204:219], v[42:45], v[168:171], v[204:219]
    v_exp_f32 v188, v188
    v_exp_f32 v189, v189
    v_mfma_f32_32x32x16_bf16 v[172:187], v[96:99], v[224:227], v[172:187]
    v_exp_f32 v190, v190
    v_exp_f32 v191, v191
    v_exp_f32 v192, v192
    v_exp_f32 v193, v193
    v_exp_f32 v194, v194
    v_exp_f32 v195, v195
    v_cvt_pk_bf16_f32 v220, v188, v189
    v_cvt_pk_bf16_f32 v221, v190, v191
    v_cvt_pk_bf16_f32 v222, v192, v193
    v_cvt_pk_bf16_f32 v223, v194, v195
    v_exp_f32 v196, v196
    v_exp_f32 v197, v197
    v_mfma_f32_32x32x16_bf16 v[172:187], v[100:103], v[220:223], v[172:187]
    v_exp_f32 v198, v198
    v_exp_f32 v199, v199
    v_exp_f32 v200, v200
    v_exp_f32 v201, v201
    v_exp_f32 v202, v202
    v_exp_f32 v203, v203
    v_cvt_pk_bf16_f32 v224, v196, v197
    v_cvt_pk_bf16_f32 v225, v198, v199
    v_cvt_pk_bf16_f32 v226, v200, v201
    v_cvt_pk_bf16_f32 v227, v202, v203
    v_mfma_f32_32x32x16_bf16 v[188:203], v[46:49], v[164:167], 0
    v_mfma_f32_32x32x16_bf16 v[188:203], v[48:51], v[168:171], v[188:203]
    v_exp_f32 v204, v204
    v_exp_f32 v205, v205
    v_mfma_f32_32x32x16_bf16 v[172:187], v[104:107], v[224:227], v[172:187]
    v_exp_f32 v206, v206
    v_exp_f32 v207, v207
    v_exp_f32 v208, v208
    v_exp_f32 v209, v209
    v_exp_f32 v210, v210
    v_exp_f32 v211, v211
    v_cvt_pk_bf16_f32 v220, v204, v205
    v_cvt_pk_bf16_f32 v221, v206, v207
    v_cvt_pk_bf16_f32 v222, v208, v209
    v_cvt_pk_bf16_f32 v223, v210, v211
    v_exp_f32 v212, v212
    v_exp_f32 v213, v213
    v_mfma_f32_32x32x16_bf16 v[172:187], v[108:111], v[220:223], v[172:187]
    v_exp_f32 v214, v214
    v_exp_f32 v215, v215
    v_exp_f32 v216, v216
    v_exp_f32 v217, v217
    v_exp_f32 v218, v218
    v_exp_f32 v219, v219
    v_cvt_pk_bf16_f32 v224, v212, v213
    v_cvt_pk_bf16_f32 v225, v214, v215
    v_cvt_pk_bf16_f32 v226, v216, v217
    v_cvt_pk_bf16_f32 v227, v218, v219
    v_mfma_f32_32x32x16_bf16 v[204:219], v[52:55], v[164:167], 0
    v_mfma_f32_32x32x16_bf16 v[204:219], v[54:57], v[168:171], v[204:219]
    v_exp_f32 v188, v188
    v_exp_f32 v189, v189
    v_mfma_f32_32x32x16_bf16 v[172:187], v[112:115], v[224:227], v[172:187]
    v_exp_f32 v190, v190
    v_exp_f32 v191, v191
    v_exp_f32 v192, v192
    v_exp_f32 v193, v193
    v_exp_f32 v194, v194
    v_exp_f32 v195, v195
    v_cvt_pk_bf16_f32 v220, v188, v189
    v_cvt_pk_bf16_f32 v221, v190, v191
    v_cvt_pk_bf16_f32 v222, v192, v193
    v_cvt_pk_bf16_f32 v223, v194, v195
    v_exp_f32 v196, v196
    v_exp_f32 v197, v197
    v_mfma_f32_32x32x16_bf16 v[172:187], v[116:119], v[220:223], v[172:187]
    v_exp_f32 v198, v198
    v_exp_f32 v199, v199
    v_exp_f32 v200, v200
    v_exp_f32 v201, v201
    v_exp_f32 v202, v202
    v_exp_f32 v203, v203
    v_cvt_pk_bf16_f32 v224, v196, v197
    v_cvt_pk_bf16_f32 v225, v198, v199
    v_cvt_pk_bf16_f32 v226, v200, v201
    v_cvt_pk_bf16_f32 v227, v202, v203
    v_mfma_f32_32x32x16_bf16 v[188:203], v[58:61], v[164:167], 0
    v_mfma_f32_32x32x16_bf16 v[188:203], v[60:63], v[168:171], v[188:203]
    v_exp_f32 v204, v204
    v_exp_f32 v205, v205
    v_mfma_f32_32x32x16_bf16 v[172:187], v[120:123], v[224:227], v[172:187]
    v_exp_f32 v206, v206
    v_exp_f32 v207, v207
    v_exp_f32 v208, v208
    v_exp_f32 v209, v209
    v_exp_f32 v210, v210
    v_exp_f32 v211, v211
    v_cvt_pk_bf16_f32 v220, v204, v205
    v_cvt_pk_bf16_f32 v221, v206, v207
    v_cvt_pk_bf16_f32 v222, v208, v209
    v_cvt_pk_bf16_f32 v223, v210, v211
    v_exp_f32 v212, v212
    v_exp_f32 v213, v213
    v_mfma_f32_32x32x16_bf16 v[172:187], v[124:127], v[220:223], v[172:187]
    v_exp_f32 v214, v214
    v_exp_f32 v215, v215
    v_exp_f32 v216, v216
    v_exp_f32 v217, v217
    v_exp_f32 v218, v218
    v_exp_f32 v219, v219
    v_cvt_pk_bf16_f32 v224, v212, v213
    v_cvt_pk_bf16_f32 v225, v214, v215
    v_cvt_pk_bf16_f32 v226, v216, v217
    v_cvt_pk_bf16_f32 v227, v218, v219
    v_mfma_f32_32x32x16_bf16 v[204:219], v[64:67], v[164:167], 0
    v_mfma_f32_32x32x16_bf16 v[204:219], v[66:69], v[168:171], v[204:219]
    v_exp_f32 v188, v188
    v_exp_f32 v189, v189
    v_mfma_f32_32x32x16_bf16 v[172:187], v[128:131], v[224:227], v[172:187]
    v_exp_f32 v190, v190
    v_exp_f32 v191, v191
    v_exp_f32 v192, v192
    v_exp_f32 v193, v193
    v_exp_f32 v194, v194
    v_exp_f32 v195, v195
    v_cvt_pk_bf16_f32 v220, v188, v189
    v_cvt_pk_bf16_f32 v221, v190, v191
    v_cvt_pk_bf16_f32 v222, v192, v193
    v_cvt_pk_bf16_f32 v223, v194, v195
    v_exp_f32 v196, v196
    v_exp_f32 v197, v197
    v_mfma_f32_32x32x16_bf16 v[172:187], v[132:135], v[220:223], v[172:187]
    v_exp_f32 v198, v198
    v_exp_f32 v199, v199
    v_exp_f32 v200, v200
    v_exp_f32 v201, v201
    v_exp_f32 v202, v202
    v_exp_f32 v203, v203
    v_cvt_pk_bf16_f32 v224, v196, v197
    v_cvt_pk_bf16_f32 v225, v198, v199
    v_cvt_pk_bf16_f32 v226, v200, v201
    v_cvt_pk_bf16_f32 v227, v202, v203
    v_exp_f32 v204, v204
    v_exp_f32 v205, v205
    v_mfma_f32_32x32x16_bf16 v[172:187], v[136:139], v[224:227], v[172:187]
    v_exp_f32 v206, v206
    v_exp_f32 v207, v207
    v_exp_f32 v208, v208
    v_exp_f32 v209, v209
    v_exp_f32 v210, v210
    v_exp_f32 v211, v211
    v_cvt_pk_bf16_f32 v220, v204, v205
    v_cvt_pk_bf16_f32 v221, v206, v207
    v_cvt_pk_bf16_f32 v222, v208, v209
    v_cvt_pk_bf16_f32 v223, v210, v211
    v_exp_f32 v212, v212
    v_exp_f32 v213, v213
    v_mfma_f32_32x32x16_bf16 v[172:187], v[140:143], v[220:223], v[172:187]
    v_exp_f32 v214, v214
    v_exp_f32 v215, v215
    v_exp_f32 v216, v216
    v_exp_f32 v217, v217
    v_exp_f32 v218, v218
    v_exp_f32 v219, v219
    v_cvt_pk_bf16_f32 v224, v212, v213
    v_cvt_pk_bf16_f32 v225, v214, v215
    v_cvt_pk_bf16_f32 v226, v216, v217
    v_cvt_pk_bf16_f32 v227, v218, v219
    s_nop 1
    v_mfma_f32_32x32x16_bf16 v[172:187], v[144:147], v[224:227], v[172:187]
    s_mul_i32 s58, s46, 81920
    s_add_u32 s58, s58, 12165120
    s_mov_b32 vcc_lo, 0
    s_mov_b32 vcc_hi, -1
    s_nop 7
    v_cndmask_b32 v2, v184, v180, vcc
    v_rcp_f32 v2, v2
    s_nop 0
    v_mul_f32 v172, v172, v2
    v_mul_f32 v173, v173, v2
    v_mul_f32 v174, v174, v2
    v_mul_f32 v175, v175, v2
    v_mul_f32 v176, v176, v2
    v_mul_f32 v177, v177, v2
    v_mul_f32 v178, v178, v2
    v_mul_f32 v179, v179, v2
    v_mul_f32 v180, v180, v2
    v_mul_f32 v181, v181, v2
    v_mul_f32 v182, v182, v2
    v_mul_f32 v183, v183, v2
    v_cvt_pk_bf16_f32 v4, v172, v173
    v_cvt_pk_bf16_f32 v5, v174, v175
    v_cvt_pk_bf16_f32 v6, v176, v177
    v_cvt_pk_bf16_f32 v7, v178, v179
    v_cvt_pk_bf16_f32 v8, v180, v181
    v_cvt_pk_bf16_f32 v9, v182, v183
    s_setprio 2
    buffer_store_dwordx4 v[4:7], v249, s[12:15], s58 offen sc1
    s_setprio 0
    s_mov_b32 exec_hi, 0
    s_setprio 2
    buffer_store_dwordx2 v[8:9], v250, s[12:15], s58 offen sc1
    s_setprio 0
    s_mov_b32 exec_hi, -1
L_Yend:
    s_lshl_b32 s57, s46, 13
    s_lshr_b32 s58, s55, 3
    s_lshl_b32 s58, s58, 7
    s_add_u32 s57, s57, s58
    s_add_u32 s57, s57, 393472
    v_lshlrev_b32 v13, 10, v1
    v_add_u32 v13, s57, v13
    v_mov_b32 v12, 0x7f000000
    v_cmp_gt_u32 vcc, 8, v1
    s_nop 1
    v_cndmask_b32 v13, v12, v13, vcc
    s_waitcnt vmcnt(0)
    v_mov_b32 v10, 1
    s_setprio 2
    buffer_atomic_add v10, v13, s[12:15], 0 offen sc1
    s_setprio 0
L_end:
    s_endpgm
.section .rodata,"a"
.p2align 6
.amdhsa_kernel parallel_sum__sliding_block__mixer_token_mlp__prompt_kernel
  .amdhsa_next_free_vgpr 256
  .amdhsa_next_free_sgpr 102
  .amdhsa_accum_offset 256
  .amdhsa_group_segment_fixed_size 0
  .amdhsa_kernarg_size 88
  .amdhsa_user_sgpr_count 2
  .amdhsa_user_sgpr_kernarg_segment_ptr 1
  .amdhsa_system_sgpr_workgroup_id_x 1
.end_amdhsa_kernel
```
